```python
import torch

def _softmax(x, axis=-1):
    return torch.softmax(x, dim=axis)
def _gelu(x):
    return torch.nn.functional.gelu(x, approximate="tanh")
def _silu(x):
    return torch.nn.functional.silu(x)
def _sigmoid(x):
    return torch.sigmoid(x)
def _layernorm(x, axis=-1, eps=1e-5):
    m = x.mean(dim=axis, keepdim=True)
    v = x.var(dim=axis, keepdim=True, unbiased=False)
    return (x - m) / torch.sqrt(v + eps)
def _scatter_add(tgt, idx, src, axis=0):
    return tgt.clone().index_add_(axis, idx, src)
def _segment_sum(src, seg, n):
    out = torch.zeros((n,) + src.shape[1:], dtype=src.dtype)
    return out.index_add_(0, seg, src)
def _pad(x, pw):
    flat = tuple(v for pair in reversed(pw) for v in pair)
    return torch.nn.functional.pad(x, flat)

kernel_name = 'interleave_layers__ssm_conv_s4d__linear_kernel_hedgehog__prompt'

def setup_inputs():

    _w = (lambda a: (lambda t: t.to(torch.bfloat16) if t.is_floating_point() else t)(torch.as_tensor(a)))
    def _A_setup():
        Bsz, L, D, N = 1, 2048, 512, 128
        return {
            "u": _w((lambda *s: torch.randn(*s, dtype=torch.bfloat16) * 0.05)(Bsz, L, D)),
            "log_A_real": _w((lambda *s: torch.randn(*s, dtype=torch.bfloat16) * 3.2)(D, N) * 0.5),
            "A_imag": _w((lambda *s: torch.randn(*s, dtype=torch.bfloat16) * 0.05)(D, N) * 3.14),
            "C_real": _w((lambda *s: torch.randn(*s, dtype=torch.bfloat16) * 0.05)(D, N) / N ** 0.5),
            "C_imag": _w((lambda *s: torch.randn(*s, dtype=torch.bfloat16) * 0.05)(D, N) / N ** 0.5),
            "log_dt": _w((lambda *s: torch.randn(*s, dtype=torch.bfloat16) * 0.05)(D) * 0.5 - 4.0),
            "D_skip": _w((lambda *s: torch.randn(*s, dtype=torch.bfloat16) * 0.05)(D)),
        }
    _A_in = _A_setup()

    def _B_setup():
        B, S, D, H = 1, 2048, 512, 32
        Dh = D // H
        return {
            "x": _w((lambda *s: torch.randn(*s, dtype=torch.bfloat16) * 0.05)(B, S, D)),
            "wqkv": _w((lambda *s: torch.randn(*s, dtype=torch.bfloat16) * 0.4)(D, 3 * D)),
            "w_phi": _w((lambda *s: torch.randn(*s, dtype=torch.bfloat16) * 0.4)(H, Dh, Dh) * (Dh ** -0.5)),
            "wo": _w((lambda *s: torch.randn(*s, dtype=torch.bfloat16) * 0.05)(D, D)),
        }
    _B_in = _B_setup()

    return {
        "A_u": _A_in["u"],
        "A_log_A_real": _A_in["log_A_real"],
        "A_A_imag": _A_in["A_imag"],
        "A_C_real": _A_in["C_real"],
        "A_C_imag": _A_in["C_imag"],
        "A_log_dt": _A_in["log_dt"],
        "A_D_skip": _A_in["D_skip"],
        "B_x": _B_in["x"],
        "B_wqkv": _B_in["wqkv"],
        "B_w_phi": _B_in["w_phi"],
        "B_wo": _B_in["wo"],
    }

def reference(A_u, A_log_A_real, A_A_imag, A_C_real, A_C_imag, A_log_dt, A_D_skip, B_x, B_wqkv, B_w_phi, B_wo):
    def _A_ref(u, log_A_real, A_imag, C_real, C_imag, log_dt, D_skip):
        L = u.shape[1]
        dt = torch.exp(log_dt)
        A = -torch.exp(log_A_real) + 1j * A_imag
        C = (C_real + 1j * C_imag) * dt[:, None]
        pos = (lambda x, dt: x.to(dt))(torch.arange(L), log_dt.dtype)
        P = torch.exp((A * dt[:, None])[:, :, None] * pos[None, None, :])
        K = 2.0 * torch.einsum("dn,dnl->dl", C, P).real
        L2 = 2 * L
        u_t = (lambda x, *d: x.permute(*d))(u, 0, 2, 1)
        Kf = (lambda x, *a, **k: torch.fft.rfft(x.float(), *a, **k))(K, L2)
        Uf = (lambda x, *a, **k: torch.fft.rfft(x.float(), *a, **k))(u_t, L2)
        y = (lambda x, *a, **k: torch.fft.irfft(x, *a, **k).to(torch.bfloat16))(Uf * Kf[None, :, :], L2)[:, :, :L]
        y = (lambda x, *d: x.permute(*d))(y, 0, 2, 1)
        return y + u * D_skip[None, None, :]

    def _B_ref(x, wqkv, w_phi, wo):
        B, S, D = x.shape
        H = 32; Dh = D // H
        qkv = (lambda x, *d: x.permute(*d))((x @ wqkv).reshape(B, S, 3, H, Dh), 2, 0, 3, 1, 4)
        q, k, v = qkv[0], qkv[1], qkv[2]
        pq = torch.einsum("bhsd,hdf->bhsf", q, w_phi)
        pk = torch.einsum("bhsd,hdf->bhsf", k, w_phi)
        phi_q = torch.concatenate([_softmax(pq, axis=-1), _softmax(-pq, axis=-1)], axis=-1)
        phi_k = torch.concatenate([_softmax(pk, axis=-1), _softmax(-pk, axis=-1)], axis=-1)
        kv = torch.einsum("bhsf,bhsd->bhfd", phi_k, v)
        z  = torch.einsum("bhsf->bhf", phi_k)
        num = torch.einsum("bhqf,bhfd->bhqd", phi_q, kv)
        den = torch.einsum("bhqf,bhf->bhq", phi_q, z)[..., None] + 1e-6
        o = num / den
        return (lambda x, *d: x.permute(*d))(o, 0, 2, 1, 3).reshape(B, S, D) @ wo

    x = A_u
    x = x + _A_ref(_layernorm(x, axis=-1), A_log_A_real, A_A_imag, A_C_real, A_C_imag, A_log_dt, A_D_skip)
    x = x + _B_ref(_layernorm(x, axis=-1), B_wqkv, B_w_phi, B_wo)
    x = x + _A_ref(_layernorm(x, axis=-1), A_log_A_real, A_A_imag, A_C_real, A_C_imag, A_log_dt, A_D_skip)
    x = x + _B_ref(_layernorm(x, axis=-1), B_wqkv, B_w_phi, B_wo)
    return x
```

```asm
; @launch grid=(256,1,1) block=(256,1,1) lds=163840
.amdgcn_target "amdgcn-amd-amdhsa--gfx950"
.text
.globl interleave_layers__ssm_conv_s4d__linear_kernel_hedgehog__prompt_kernel
.p2align 8
.type interleave_layers__ssm_conv_s4d__linear_kernel_hedgehog__prompt_kernel,@function
interleave_layers__ssm_conv_s4d__linear_kernel_hedgehog__prompt_kernel:
    s_cmp_ge_u32 s2, 256
    s_cbranch_scc1 L_end
    s_load_dwordx4 s[64:67], s[0:1], 96
    s_load_dwordx16 s[44:59], s[0:1], 0
    s_load_dwordx8 s[68:75], s[0:1], 64
    v_lshrrev_b32 v2, 6, v0
    v_and_b32 v1, 63, v0
    v_readfirstlane_b32 s24, v2
    v_and_b32 v3, 15, v0
    v_bfe_u32 v4, v0, 4, 2
    s_getpc_b64 s[76:77]
L_pc:
    s_add_u32 s76, s76, L_main-L_pc
    s_addc_u32 s77, s77, 0
    s_lshr_b32 s78, s2, 3
    s_and_b32 s78, s78, 3
    s_mul_i32 s78, s78, 16384
    v_lshl_add_u32 v104, v0, 6, s78
    v_min_u32 v104, L_end-L_main, v104
    global_load_dword v105, v104, s[76:77]
    s_getreg_b32 s32, hwreg(HW_REG_XCC_ID, 0, 4)
    s_and_b32 s32, s32, 7
    s_and_b32 s18, s2, 7
    s_lshl_b32 s18, s18, 5
    s_lshr_b32 s25, s2, 3
    s_add_u32 s18, s18, s25
    s_lshl_b32 s39, s32, 8
    s_add_u32 s39, s39, 21430272
    s_add_u32 s38, s39, s2
    s_mul_i32 s40, s32, 256
    s_add_u32 s40, s40, 21434368
    s_mul_i32 s41, s32, 2048
    s_add_u32 s41, s41, 21434368
    s_mov_b32 s33, 0
    s_mov_b64 s[36:37], 0
    s_lshl_b32 s25, s18, 9
    v_lshl_add_u32 v5, v0, 1, s25
    s_lshr_b32 s26, s24, 1
    s_lshl_b32 s27, s18, 1
    s_add_u32 s27, s27, s26
    s_lshl_b32 s27, s27, 1
    v_mov_b32 v6, s27
    s_lshl_b32 s29, s2, 13
    v_lshlrev_b32 v7, 4, v1
    v_mov_b32 v8, 0
    s_lshl_b32 s30, s24, 11
    s_add_u32 s30, s30, s29
    v_add_u32 v9, s30, v7
    v_mov_b32 v56, 0
    v_mov_b32 v57, 0
    v_mov_b32 v58, 0
    v_mov_b32 v59, 0
    v_mov_b32 v191, 0
    s_and_b32 s19, s2, 15
    s_lshr_b32 s20, s2, 4
    s_cmp_lt_u32 s19, 12
    s_cselect_b32 s31, 3, 1
    s_cselect_b32 s27, 0, 12
    s_lshl_b32 s31, s31, 10
    s_sub_u32 s21, s19, s27
    s_cmp_lt_u32 s19, 12
    s_cselect_b32 s28, 0, 8
    s_cselect_b32 s23, 4, 3
    v_and_b32 v52, s28, v3
    v_add_u32 v52, v52, v3
    s_lshl_b32 s27, s20, 5
    v_add_u32 v52, s27, v52
    v_mul_lo_u32 v52, v52, s31
    v_lshl_add_u32 v52, v4, 4, v52
    s_lshl_b32 s27, s21, 8
    s_lshl_b32 s28, s24, 6
    s_add_u32 s27, s27, s28
    v_add_u32 v52, s27, v52
    s_lshl_b32 s27, s31, s23
    v_add_u32 v53, s27, v52
    s_and_b32 s22, s19, 3
    s_lshl_b32 s22, s22, 3
    s_lshl_b32 s27, s24, 1
    s_add_u32 s22, s22, s27
    s_lshl_b32 s27, s22, 9
    v_add_u32 v54, s27, v7
    s_waitcnt lgkmcnt(0)
    s_mov_b32 s4, s66
    s_mov_b32 s5, s67
    s_mov_b32 s6, 0x1500000
    s_mov_b32 s7, 0x20000
    s_cmp_eq_u32 s24, 3
    s_cbranch_scc0 L_p0a
    s_mov_b64 exec, 1
    buffer_store_byte v56, v56, s[4:7], s38 offen
    s_mul_i32 s27, s2, 256
    s_add_u32 s27, s27, 21434368
    s_cmp_lt_u32 s2, 64
    s_cbranch_scc0 L_p0b
    buffer_store_dword v56, v56, s[4:7], s27 offen sc1
L_p0b:
    s_mov_b64 exec, -1
L_p0a:
    global_load_dwordx4 v[16:19], v9, s[44:45]
    global_load_dwordx4 v[20:23], v9, s[44:45] offset:1024
    s_cmp_lt_u32 s19, 12
    s_cselect_b32 s34, s68, s72
    s_cselect_b32 s35, s69, s73
    global_load_dwordx4 v[32:35], v52, s[34:35]
    global_load_dwordx4 v[36:39], v53, s[34:35]
    global_load_dwordx4 v[40:43], v54, s[70:71]
    global_load_ushort v10, v5, s[46:47]
    global_load_ushort v11, v5, s[48:49]
    global_load_ushort v12, v5, s[50:51]
    global_load_ushort v13, v5, s[52:53]
    global_load_ushort v14, v6, s[54:55]
    global_load_ushort v15, v6, s[56:57]
    s_mov_b32 s8, s74
    s_mov_b32 s9, s75
    s_mov_b32 s10, 0x200000
    s_mov_b32 s11, 0x20000
    s_mov_b32 s12, s64
    s_mov_b32 s13, s65
    s_mov_b32 s14, 256
    s_mov_b32 s15, 0x20000
    s_branch L_main
.p2align 12
L_main:
    s_cmp_eq_u32 s24, 2
    s_cbranch_scc0 L_wkp_skip
    s_mov_b64 exec, 0
    s_branch L_wkp_0
L_wkp_ret:
    s_mov_b64 exec, -1
L_wkp_skip:
    s_cmp_eq_u32 s24, 3
    s_cbranch_scc0 L_p0g
    s_lshl_b32 s27, s32, 5
    s_lshr_b32 s28, s2, 5
    s_lshl_b32 s28, s28, 2
    s_add_u32 s27, s27, s28
    s_and_b32 s28, s2, 31
    s_lshl_b32 s28, 1, s28
    v_mov_b32 v55, s28
    s_waitcnt vmcnt(11)
    s_mov_b64 exec, 1
    buffer_atomic_or v55, v56, s[12:15], s27 offen
    s_mov_b64 exec, -1
    s_branch L_p0h
L_p0g:
    s_mul_i32 s27, s2, 640
    s_add_u32 s27, s27, 21102592
    v_lshlrev_b32 v55, 4, v0
    v_cmp_gt_u32 vcc, 40, v0
    v_mov_b32 v60, 0x7f000000
    s_nop 0
    v_cndmask_b32 v55, v60, v55, vcc
    buffer_store_dwordx4 v[56:59], v55, s[4:7], s27 offen sc1
L_p0h:
    s_and_b32 s51, s2, 7
    s_lshl_b32 s52, s51, 11
    s_lshl_b32 s51, s51, 1
    s_bfe_u32 s27, s2, 0x10003
    s_add_u32 s51, s51, s27
    s_lshl_b32 s51, s51, 7
    s_lshr_b32 s27, s2, 4
    s_lshl_b32 s27, s27, 14
    s_add_u32 s27, s27, 21757952
    s_add_u32 s79, s51, s27
    s_add_u32 s80, s52, s27
    v_lshlrev_b32 v55, 11, v0
    v_cmp_gt_u32 vcc, 8, v0
    v_mov_b32 v60, 0x7f000000
    s_nop 0
    v_cndmask_b32 v55, v60, v55, vcc
    buffer_store_dword v56, v55, s[4:7], s79 offen sc1
    s_lshl_b32 s51, s51, 10
    s_lshl_b32 s52, s24, 15
    s_add_u32 s51, s51, s52
    s_lshr_b32 s27, s2, 4
    s_lshl_b32 s27, s27, 11
    s_add_u32 s51, s51, s27
    s_add_u32 s51, s51, 12713984
    v_lshlrev_b32 v55, 5, v1
    buffer_load_dword v61, v55, s[4:7], s51 offen sc1
    v_lshlrev_b32 v55, 3, v0
    v_add_u32 v108, -3, v55
    v_add_u32 v109, -2, v55
    v_add_u32 v110, -1, v55
    v_add_u32 v111, 0, v55
    v_add_u32 v112, 1, v55
    v_add_u32 v113, 2, v55
    v_add_u32 v114, 3, v55
    v_add_u32 v115, 4, v55
    v_add_u32 v116, 5, v55
    v_add_u32 v117, 6, v55
    v_add_u32 v118, 7, v55
    v_add_u32 v119, 8, v55
    v_cvt_f32_i32 v108, v108
    v_cvt_f32_i32 v109, v109
    v_cvt_f32_i32 v110, v110
    v_cvt_f32_i32 v111, v111
    v_cvt_f32_i32 v112, v112
    v_cvt_f32_i32 v113, v113
    v_cvt_f32_i32 v114, v114
    v_cvt_f32_i32 v115, v115
    v_cvt_f32_i32 v116, v116
    v_cvt_f32_i32 v117, v117
    v_cvt_f32_i32 v118, v118
    v_cvt_f32_i32 v119, v119
    v_cvt_pk_bf16_f32 v120, v108, v109
    v_cvt_pk_bf16_f32 v121, v110, v111
    v_cvt_pk_bf16_f32 v122, v112, v113
    v_cvt_pk_bf16_f32 v123, v114, v115
    v_cvt_pk_bf16_f32 v124, v116, v117
    v_cvt_pk_bf16_f32 v125, v118, v119
    v_lshlrev_b32 v108, 16, v120
    v_and_b32 v109, 0xffff0000, v120
    v_lshlrev_b32 v110, 16, v121
    v_and_b32 v111, 0xffff0000, v121
    v_lshlrev_b32 v112, 16, v122
    v_and_b32 v113, 0xffff0000, v122
    v_lshlrev_b32 v114, 16, v123
    v_and_b32 v115, 0xffff0000, v123
    v_lshlrev_b32 v116, 16, v124
    v_and_b32 v117, 0xffff0000, v124
    v_lshlrev_b32 v118, 16, v125
    v_and_b32 v119, 0xffff0000, v125
    v_cvt_i32_f32 v108, v108
    v_cvt_i32_f32 v109, v109
    v_cvt_i32_f32 v110, v110
    v_cvt_i32_f32 v111, v111
    v_cvt_i32_f32 v112, v112
    v_cvt_i32_f32 v113, v113
    v_cvt_i32_f32 v114, v114
    v_cvt_i32_f32 v115, v115
    v_cvt_i32_f32 v116, v116
    v_cvt_i32_f32 v117, v117
    v_cvt_i32_f32 v118, v118
    v_min_u32 v108, 3071, v108
    v_min_u32 v109, 3071, v109
    v_min_u32 v110, 3071, v110
    s_mov_b32 s27, 128256
    v_lshrrev_b32 v120, 6, v108
    v_lshl_add_u32 v108, v108, 1, s27
    v_lshl_add_u32 v108, v120, 2, v108
    v_lshrrev_b32 v120, 6, v109
    v_lshl_add_u32 v109, v109, 1, s27
    v_lshl_add_u32 v109, v120, 2, v109
    v_lshrrev_b32 v120, 6, v110
    v_lshl_add_u32 v110, v110, 1, s27
    v_lshl_add_u32 v110, v120, 2, v110
    v_lshrrev_b32 v120, 6, v111
    v_lshl_add_u32 v111, v111, 1, s27
    v_lshl_add_u32 v111, v120, 2, v111
    v_lshrrev_b32 v120, 6, v112
    v_lshl_add_u32 v112, v112, 1, s27
    v_lshl_add_u32 v112, v120, 2, v112
    v_lshrrev_b32 v120, 6, v113
    v_lshl_add_u32 v113, v113, 1, s27
    v_lshl_add_u32 v113, v120, 2, v113
    v_lshrrev_b32 v120, 6, v114
    v_lshl_add_u32 v114, v114, 1, s27
    v_lshl_add_u32 v114, v120, 2, v114
    v_lshrrev_b32 v120, 6, v115
    v_lshl_add_u32 v115, v115, 1, s27
    v_lshl_add_u32 v115, v120, 2, v115
    v_lshrrev_b32 v120, 6, v116
    v_lshl_add_u32 v116, v116, 1, s27
    v_lshl_add_u32 v116, v120, 2, v116
    v_lshrrev_b32 v120, 6, v117
    v_lshl_add_u32 v117, v117, 1, s27
    v_lshl_add_u32 v117, v120, 2, v117
    v_lshrrev_b32 v120, 6, v118
    v_lshl_add_u32 v118, v118, 1, s27
    v_lshl_add_u32 v118, v120, 2, v118
    s_lshl_b32 s27, s24, 11
    s_add_u32 s27, s27, 33792
    v_add_u32 v9, s27, v7
    s_lshl_b32 s27, s24, 10
    s_add_u32 s27, s27, 42048
    v_add_u32 v53, s27, v7
    v_lshrrev_b32 v54, 2, v1
    v_and_b32 v54, 3, v54
    v_lshlrev_b32 v54, 5, v54
    v_lshl_add_u32 v54, v4, 8, v54
    v_and_b32 v55, 3, v0
    v_lshl_add_u32 v54, v55, 3, v54
    v_add_u32 v54, s27, v54
    s_lshl_b32 s27, s24, 4
    s_add_u32 s27, s27, 41984
    v_mov_b32 v55, s27
    s_mov_b32 s60, 0x05040100
    s_mov_b32 s61, 0x07060302
    s_mov_b32 s62, 0x3f803f80
    s_waitcnt vmcnt(12)
    ds_write_b128 v9, v[16:19]
    ds_write_b128 v9, v[20:23] offset:1024
    v_dot2_f32_bf16 v24, v16, s62, 0
    v_dot2_f32_bf16 v26, v16, v16, 0
    v_dot2_f32_bf16 v25, v20, s62, 0
    v_dot2_f32_bf16 v27, v20, v20, 0
    v_dot2_f32_bf16 v24, v17, s62, v24
    v_dot2_f32_bf16 v26, v17, v17, v26
    v_dot2_f32_bf16 v25, v21, s62, v25
    v_dot2_f32_bf16 v27, v21, v21, v27
    v_dot2_f32_bf16 v24, v18, s62, v24
    v_dot2_f32_bf16 v26, v18, v18, v26
    v_dot2_f32_bf16 v25, v22, s62, v25
    v_dot2_f32_bf16 v27, v22, v22, v27
    v_dot2_f32_bf16 v24, v19, s62, v24
    v_dot2_f32_bf16 v26, v19, v19, v26
    v_dot2_f32_bf16 v25, v23, s62, v25
    v_dot2_f32_bf16 v27, v23, v23, v27
    v_add_f32_dpp v24, v24, v24 row_shr:1 row_mask:0xf bank_mask:0xf bound_ctrl:1
    s_nop 0
    v_add_f32_dpp v25, v25, v25 row_shr:1 row_mask:0xf bank_mask:0xf bound_ctrl:1
    v_add_f32_dpp v26, v26, v26 row_shr:1 row_mask:0xf bank_mask:0xf bound_ctrl:1
    v_add_f32_dpp v27, v27, v27 row_shr:1 row_mask:0xf bank_mask:0xf bound_ctrl:1
    v_add_f32_dpp v24, v24, v24 row_shr:2 row_mask:0xf bank_mask:0xf bound_ctrl:1
    v_add_f32_dpp v25, v25, v25 row_shr:2 row_mask:0xf bank_mask:0xf bound_ctrl:1
    v_add_f32_dpp v26, v26, v26 row_shr:2 row_mask:0xf bank_mask:0xf bound_ctrl:1
    v_add_f32_dpp v27, v27, v27 row_shr:2 row_mask:0xf bank_mask:0xf bound_ctrl:1
    v_add_f32_dpp v24, v24, v24 row_shr:4 row_mask:0xf bank_mask:0xf bound_ctrl:1
    v_add_f32_dpp v25, v25, v25 row_shr:4 row_mask:0xf bank_mask:0xf bound_ctrl:1
    v_add_f32_dpp v26, v26, v26 row_shr:4 row_mask:0xf bank_mask:0xf bound_ctrl:1
    v_add_f32_dpp v27, v27, v27 row_shr:4 row_mask:0xf bank_mask:0xf bound_ctrl:1
    v_add_f32_dpp v24, v24, v24 row_shr:8 row_mask:0xf bank_mask:0xf bound_ctrl:1
    v_add_f32_dpp v25, v25, v25 row_shr:8 row_mask:0xf bank_mask:0xf bound_ctrl:1
    v_add_f32_dpp v26, v26, v26 row_shr:8 row_mask:0xf bank_mask:0xf bound_ctrl:1
    v_add_f32_dpp v27, v27, v27 row_shr:8 row_mask:0xf bank_mask:0xf bound_ctrl:1
    v_add_f32_dpp v24, v24, v24 row_bcast:15 row_mask:0xa bank_mask:0xf
    v_add_f32_dpp v25, v25, v25 row_bcast:15 row_mask:0xa bank_mask:0xf
    v_add_f32_dpp v26, v26, v26 row_bcast:15 row_mask:0xa bank_mask:0xf
    v_add_f32_dpp v27, v27, v27 row_bcast:15 row_mask:0xa bank_mask:0xf
    v_add_f32_dpp v24, v24, v24 row_bcast:31 row_mask:0xc bank_mask:0xf
    v_add_f32_dpp v25, v25, v25 row_bcast:31 row_mask:0xc bank_mask:0xf
    v_add_f32_dpp v26, v26, v26 row_bcast:31 row_mask:0xc bank_mask:0xf
    v_add_f32_dpp v27, v27, v27 row_bcast:31 row_mask:0xc bank_mask:0xf
    v_mul_f32 v24, 0x3b000000, v24
    v_mov_b32 v28, 0x3727c5ac
    v_fmac_f32 v28, 0x3b000000, v26
    v_mul_f32 v25, 0x3b000000, v25
    v_mov_b32 v30, 0x3727c5ac
    v_fmac_f32 v30, 0x3b000000, v27
    v_fma_f32 v28, -v24, v24, v28
    v_fma_f32 v30, -v25, v25, v30
    v_max_f32 v28, 0x3727c5ac, v28
    v_max_f32 v30, 0x3727c5ac, v30
    v_rsq_f32 v28, v28
    v_rsq_f32 v30, v30
    v_mul_f32 v29, -v24, v28
    v_mul_f32 v31, -v25, v30
    s_mov_b32 exec_lo, 0
    s_mov_b32 exec_hi, 0x80000000
    ds_write_b128 v55, v[28:31]
    s_mov_b64 exec, -1
    s_waitcnt vmcnt(9)
    ds_write_b128 v53, v[40:43]
    v_lshlrev_b32 v9, 2, v0
    v_mov_b32 v55, 41984
    s_waitcnt lgkmcnt(0)
    s_barrier
    ds_read_b32 v16, v9 offset:33792
    ds_read_b32 v17, v9 offset:34816
    ds_read_b32 v18, v9 offset:35840
    ds_read_b32 v19, v9 offset:36864
    ds_read_b32 v20, v9 offset:37888
    ds_read_b32 v21, v9 offset:38912
    ds_read_b32 v22, v9 offset:39936
    ds_read_b32 v23, v9 offset:40960
    ds_read_b128 v[72:75], v55 offset:0
    ds_read_b128 v[76:79], v55 offset:16
    ds_read_b128 v[80:83], v55 offset:32
    ds_read_b128 v[84:87], v55 offset:48
    ds_read_b64_tr_b16 v[40:41], v54
    ds_read_b64_tr_b16 v[42:43], v54 offset:128
    v_lshlrev_b32 v55, 6, v3
    v_lshl_add_u32 v55, v4, 4, v55
    s_mul_i32 s29, s2, 16640
    s_lshl_b32 s27, s24, 12
    s_add_u32 s29, s29, s27
    s_waitcnt lgkmcnt(6)
    v_perm_b32 v144, v17, v16, s60
    v_perm_b32 v148, v17, v16, s61
    v_perm_b32 v145, v19, v18, s60
    v_perm_b32 v149, v19, v18, s61
    v_perm_b32 v146, v21, v20, s60
    v_perm_b32 v150, v21, v20, s61
    v_perm_b32 v147, v23, v22, s60
    v_perm_b32 v151, v23, v22, s61
    v_lshlrev_b32 v88, 16, v16
    v_and_b32 v89, 0xffff0000, v16
    v_lshlrev_b32 v90, 16, v17
    v_and_b32 v91, 0xffff0000, v17
    v_lshlrev_b32 v92, 16, v18
    v_and_b32 v93, 0xffff0000, v18
    v_lshlrev_b32 v94, 16, v19
    v_and_b32 v95, 0xffff0000, v19
    v_lshlrev_b32 v96, 16, v20
    v_and_b32 v97, 0xffff0000, v20
    v_lshlrev_b32 v98, 16, v21
    v_and_b32 v99, 0xffff0000, v21
    v_lshlrev_b32 v100, 16, v22
    v_and_b32 v101, 0xffff0000, v22
    v_lshlrev_b32 v102, 16, v23
    v_and_b32 v103, 0xffff0000, v23
    s_waitcnt lgkmcnt(2)
    v_pk_fma_f32 v[88:89], v[88:89], v[72:73], v[72:73] op_sel:[0,0,1] op_sel_hi:[1,0,1]
    v_pk_fma_f32 v[90:91], v[90:91], v[74:75], v[74:75] op_sel:[0,0,1] op_sel_hi:[1,0,1]
    v_pk_fma_f32 v[92:93], v[92:93], v[76:77], v[76:77] op_sel:[0,0,1] op_sel_hi:[1,0,1]
    v_pk_fma_f32 v[94:95], v[94:95], v[78:79], v[78:79] op_sel:[0,0,1] op_sel_hi:[1,0,1]
    v_pk_fma_f32 v[96:97], v[96:97], v[80:81], v[80:81] op_sel:[0,0,1] op_sel_hi:[1,0,1]
    v_pk_fma_f32 v[98:99], v[98:99], v[82:83], v[82:83] op_sel:[0,0,1] op_sel_hi:[1,0,1]
    v_pk_fma_f32 v[100:101], v[100:101], v[84:85], v[84:85] op_sel:[0,0,1] op_sel_hi:[1,0,1]
    v_pk_fma_f32 v[102:103], v[102:103], v[86:87], v[86:87] op_sel:[0,0,1] op_sel_hi:[1,0,1]
    v_cvt_pk_bf16_f32 v152, v88, v90
    v_cvt_pk_bf16_f32 v156, v89, v91
    v_cvt_pk_bf16_f32 v153, v92, v94
    v_cvt_pk_bf16_f32 v157, v93, v95
    v_cvt_pk_bf16_f32 v154, v96, v98
    v_cvt_pk_bf16_f32 v158, v97, v99
    v_cvt_pk_bf16_f32 v155, v100, v102
    v_cvt_pk_bf16_f32 v159, v101, v103
    v_permlane32_swap_b32 v144, v152
    v_permlane32_swap_b32 v148, v156
    v_permlane32_swap_b32 v145, v153
    v_permlane32_swap_b32 v149, v157
    v_permlane32_swap_b32 v146, v154
    v_permlane32_swap_b32 v150, v158
    v_permlane32_swap_b32 v147, v155
    v_permlane32_swap_b32 v151, v159
    v_permlane16_swap_b32 v144, v148
    v_permlane16_swap_b32 v152, v156
    v_permlane16_swap_b32 v145, v149
    v_permlane16_swap_b32 v153, v157
    v_permlane16_swap_b32 v146, v150
    v_permlane16_swap_b32 v154, v158
    v_permlane16_swap_b32 v147, v151
    v_permlane16_swap_b32 v155, v159
    buffer_store_dwordx4 v[144:147], v55, s[4:7], s29 offen offset:0 sc1
    buffer_store_dwordx4 v[148:151], v55, s[4:7], s29 offen offset:1024 sc1
    buffer_store_dwordx4 v[152:155], v55, s[4:7], s29 offen offset:2048 sc1
    buffer_store_dwordx4 v[156:159], v55, s[4:7], s29 offen offset:3072 sc1
    s_waitcnt lgkmcnt(0)
    s_cmp_lt_u32 s19, 8
    s_cbranch_scc1 L_p0i
    v_and_b32 v44, 1, v3
    v_lshlrev_b32 v44, 4, v44
    v_mov_b32 v45, 0x3f80
    v_lshlrev_b32 v44, v44, v45
    v_and_b32 v45, 1, v4
    v_lshlrev_b32 v45, 2, v45
    v_lshrrev_b32 v46, 1, v3
    v_sub_u32 v45, v46, v45
    v_cmp_eq_u32 vcc, 0, v45
    s_nop 1
    v_cndmask_b32 v40, 0, v44, vcc
    v_cmp_eq_u32 vcc, 1, v45
    s_nop 1
    v_cndmask_b32 v41, 0, v44, vcc
    v_cmp_eq_u32 vcc, 2, v45
    s_nop 1
    v_cndmask_b32 v42, 0, v44, vcc
    v_cmp_eq_u32 vcc, 3, v45
    s_nop 1
    v_cndmask_b32 v43, 0, v44, vcc
L_p0i:
    s_mov_b32 s60, 0
    s_mov_b32 s61, -1
    v_cndmask_b32 v44, 0, v40, s[60:61]
    v_cndmask_b32 v45, 0, v41, s[60:61]
    v_cndmask_b32 v46, 0, v42, s[60:61]
    v_cndmask_b32 v47, 0, v43, s[60:61]
    v_cndmask_b32 v40, v40, 0, s[60:61]
    v_cndmask_b32 v41, v41, 0, s[60:61]
    v_cndmask_b32 v42, v42, 0, s[60:61]
    v_cndmask_b32 v43, v43, 0, s[60:61]
    s_nop 1
    v_mfma_f32_16x16x32_bf16 v[16:19], v[32:35], v[40:43], 0
    v_mfma_f32_16x16x32_bf16 v[20:23], v[36:39], v[40:43], 0
    v_mfma_f32_16x16x32_bf16 v[24:27], v[32:35], v[44:47], 0
    v_mfma_f32_16x16x32_bf16 v[28:31], v[36:39], v[44:47], 0
    s_cmp_lt_u32 s19, 12
    s_cbranch_scc0 L_p0j
    s_lshl_b32 s27, s22, 4
    s_add_u32 s27, s27, s20
    s_mul_i32 s27, s27, 3
    s_lshr_b32 s28, s19, 2
    s_add_u32 s27, s27, s28
    s_lshl_b32 s27, s27, 10
    s_add_u32 s27, s27, 10616832
    s_add_u32 s28, s27, 49152
    v_lshlrev_b32 v52, 4, v1
    s_branch L_p0k
L_p0j:
    s_lshl_b32 s27, s21, 2
    s_add_u32 s27, s27, s24
    s_lshl_b32 s27, s27, 4
    s_add_u32 s27, s27, s20
    s_lshl_b32 s27, s27, 11
    s_add_u32 s27, s27, 12189696
    s_add_u32 s28, s27, 256
    v_lshlrev_b32 v52, 4, v3
    v_lshl_add_u32 v52, v4, 9, v52
L_p0k:
    s_nop 4
    s_lshr_b32 s60, s19, 2
    s_cmp_eq_u32 s60, 1
    s_cbranch_scc0 L_p0l
    v_subrev_f32_dpp v32, v16, v16 row_newbcast:0 row_mask:0xf bank_mask:0xf
    v_subrev_f32_dpp v33, v17, v17 row_newbcast:0 row_mask:0xf bank_mask:0xf
    v_subrev_f32_dpp v34, v18, v18 row_newbcast:0 row_mask:0xf bank_mask:0xf
    v_subrev_f32_dpp v35, v19, v19 row_newbcast:0 row_mask:0xf bank_mask:0xf
    v_subrev_f32_dpp v36, v20, v20 row_newbcast:0 row_mask:0xf bank_mask:0xf
    v_subrev_f32_dpp v37, v21, v21 row_newbcast:0 row_mask:0xf bank_mask:0xf
    v_subrev_f32_dpp v38, v22, v22 row_newbcast:0 row_mask:0xf bank_mask:0xf
    v_subrev_f32_dpp v39, v23, v23 row_newbcast:0 row_mask:0xf bank_mask:0xf
    v_subrev_f32_dpp v40, v24, v24 row_newbcast:0 row_mask:0xf bank_mask:0xf
    v_subrev_f32_dpp v41, v25, v25 row_newbcast:0 row_mask:0xf bank_mask:0xf
    v_subrev_f32_dpp v42, v26, v26 row_newbcast:0 row_mask:0xf bank_mask:0xf
    v_subrev_f32_dpp v43, v27, v27 row_newbcast:0 row_mask:0xf bank_mask:0xf
    v_subrev_f32_dpp v44, v28, v28 row_newbcast:0 row_mask:0xf bank_mask:0xf
    v_subrev_f32_dpp v45, v29, v29 row_newbcast:0 row_mask:0xf bank_mask:0xf
    v_subrev_f32_dpp v46, v30, v30 row_newbcast:0 row_mask:0xf bank_mask:0xf
    v_subrev_f32_dpp v47, v31, v31 row_newbcast:0 row_mask:0xf bank_mask:0xf
    s_mov_b32 s60, 0x00010001
    s_mov_b32 s61, s60
    v_cndmask_b32 v16, v32, 1.0, s[60:61]
    v_cndmask_b32 v17, v33, 1.0, s[60:61]
    v_cndmask_b32 v18, v34, 1.0, s[60:61]
    v_cndmask_b32 v19, v35, 1.0, s[60:61]
    v_cndmask_b32 v20, v36, 1.0, s[60:61]
    v_cndmask_b32 v21, v37, 1.0, s[60:61]
    v_cndmask_b32 v22, v38, 1.0, s[60:61]
    v_cndmask_b32 v23, v39, 1.0, s[60:61]
    v_cndmask_b32 v24, v40, 1.0, s[60:61]
    v_cndmask_b32 v25, v41, 1.0, s[60:61]
    v_cndmask_b32 v26, v42, 1.0, s[60:61]
    v_cndmask_b32 v27, v43, 1.0, s[60:61]
    v_cndmask_b32 v28, v44, 1.0, s[60:61]
    v_cndmask_b32 v29, v45, 1.0, s[60:61]
    v_cndmask_b32 v30, v46, 1.0, s[60:61]
    v_cndmask_b32 v31, v47, 1.0, s[60:61]
L_p0l:
    v_cvt_pk_bf16_f32 v48, v16, v17
    v_cvt_pk_bf16_f32 v49, v18, v19
    v_cvt_pk_bf16_f32 v50, v20, v21
    v_cvt_pk_bf16_f32 v51, v22, v23
    buffer_store_dwordx4 v[48:51], v52, s[4:7], s27 offen sc1
    v_cvt_pk_bf16_f32 v68, v24, v25
    v_cvt_pk_bf16_f32 v69, v26, v27
    v_cvt_pk_bf16_f32 v70, v28, v29
    v_cvt_pk_bf16_f32 v71, v30, v31
    buffer_store_dwordx4 v[68:71], v52, s[4:7], s28 offen sc1
    s_waitcnt vmcnt(9)
    v_and_b32 v54, 127, v0
    v_mul_u32_u24 v54, 160, v54
    s_mul_i32 s27, s26, 40960
    s_add_u32 s27, s27, 46336
    v_add_u32 v54, s27, v54
    v_lshlrev_b32 v10, 16, v10
    v_lshlrev_b32 v11, 16, v11
    v_lshlrev_b32 v12, 16, v12
    v_lshlrev_b32 v13, 16, v13
    v_lshlrev_b32 v14, 16, v14
    v_lshlrev_b32 v15, 16, v15
    v_mul_f32 v10, 0x3fb8aa3b, v10
    v_mul_f32 v14, 0x3fb8aa3b, v14
    v_exp_f32 v10, v10
    v_exp_f32 v14, v14
    s_nop 0
    v_cvt_pk_bf16_f32 v9, v10, v14
    v_lshlrev_b32 v10, 16, v9
    v_and_b32 v14, 0xffff0000, v9
    v_mul_f32 v10, v10, v14
    v_mul_f32 v11, v11, v14
    v_mul_f32 v10, 0xbfb8aa3b, v10
    v_mul_f32 v11, 0x3e22f983, v11
    v_mul_f32 v22, 0x3f800000, v10
    v_mul_f32 v23, 0x3f800000, v11
    v_mul_f32 v24, 0x41000000, v10
    v_mul_f32 v25, 0x41000000, v11
    v_mul_f32 v26, 0x43000000, v10
    v_mul_f32 v27, 0x43000000, v11
    v_fract_f32 v23, v23
    v_fract_f32 v25, v25
    v_fract_f32 v27, v27
    v_exp_f32 v22, v22
    v_cos_f32 v16, v23
    v_sin_f32 v17, v23
    v_exp_f32 v24, v24
    v_cos_f32 v18, v25
    v_sin_f32 v19, v25
    v_exp_f32 v26, v26
    v_cos_f32 v20, v27
    v_sin_f32 v21, v27
    v_pk_mul_f32 v[16:17], v[16:17], v[22:23] op_sel:[0,0] op_sel_hi:[1,0]
    v_pk_mul_f32 v[18:19], v[18:19], v[24:25] op_sel:[0,0] op_sel_hi:[1,0]
    v_pk_mul_f32 v[20:21], v[20:21], v[26:27] op_sel:[0,0] op_sel_hi:[1,0]
    v_mov_b32 v72, v12
    v_mov_b32 v73, v13
    v_mov_b32 v88, 1.0
    v_mov_b32 v89, 0
    v_mov_b32 v90, v18
    v_mov_b32 v91, v19
    v_pk_mul_f32 v[34:35], v[16:17], v[16:17] op_sel:[0,0] op_sel_hi:[1,0]
    v_pk_mul_f32 v[36:37], v[18:19], v[18:19] op_sel:[0,0] op_sel_hi:[1,0]
    v_pk_mul_f32 v[38:39], v[20:21], v[20:21] op_sel:[0,0] op_sel_hi:[1,0]
    v_pk_mul_f32 v[40:41], v[72:73], v[16:17] op_sel:[0,0] op_sel_hi:[1,0]
    v_pk_fma_f32 v[28:29], v[16:17], v[16:17], v[34:35] op_sel:[1,1,0] op_sel_hi:[0,1,1] neg_lo:[1,0,0]
    v_pk_fma_f32 v[30:31], v[18:19], v[18:19], v[36:37] op_sel:[1,1,0] op_sel_hi:[0,1,1] neg_lo:[1,0,0]
    v_pk_fma_f32 v[32:33], v[20:21], v[20:21], v[38:39] op_sel:[1,1,0] op_sel_hi:[0,1,1] neg_lo:[1,0,0]
    v_pk_fma_f32 v[74:75], v[72:73], v[16:17], v[40:41] op_sel:[1,1,0] op_sel_hi:[0,1,1] neg_lo:[1,0,0]
    v_pk_mul_f32 v[34:35], v[72:73], v[28:29] op_sel:[0,0] op_sel_hi:[1,0]
    v_pk_mul_f32 v[36:37], v[74:75], v[28:29] op_sel:[0,0] op_sel_hi:[1,0]
    v_pk_mul_f32 v[38:39], v[88:89], v[30:31] op_sel:[0,0] op_sel_hi:[1,0]
    v_pk_mul_f32 v[40:41], v[90:91], v[30:31] op_sel:[0,0] op_sel_hi:[1,0]
    v_pk_fma_f32 v[76:77], v[72:73], v[28:29], v[34:35] op_sel:[1,1,0] op_sel_hi:[0,1,1] neg_lo:[1,0,0]
    v_pk_fma_f32 v[78:79], v[74:75], v[28:29], v[36:37] op_sel:[1,1,0] op_sel_hi:[0,1,1] neg_lo:[1,0,0]
    v_pk_fma_f32 v[92:93], v[88:89], v[30:31], v[38:39] op_sel:[1,1,0] op_sel_hi:[0,1,1] neg_lo:[1,0,0]
    v_pk_fma_f32 v[94:95], v[90:91], v[30:31], v[40:41] op_sel:[1,1,0] op_sel_hi:[0,1,1] neg_lo:[1,0,0]
    v_pk_mul_f32 v[34:35], v[76:77], v[28:29] op_sel:[0,0] op_sel_hi:[1,0]
    v_pk_mul_f32 v[36:37], v[78:79], v[28:29] op_sel:[0,0] op_sel_hi:[1,0]
    v_pk_mul_f32 v[38:39], v[92:93], v[30:31] op_sel:[0,0] op_sel_hi:[1,0]
    v_pk_mul_f32 v[40:41], v[94:95], v[30:31] op_sel:[0,0] op_sel_hi:[1,0]
    v_pk_fma_f32 v[80:81], v[76:77], v[28:29], v[34:35] op_sel:[1,1,0] op_sel_hi:[0,1,1] neg_lo:[1,0,0]
    v_pk_fma_f32 v[82:83], v[78:79], v[28:29], v[36:37] op_sel:[1,1,0] op_sel_hi:[0,1,1] neg_lo:[1,0,0]
    v_pk_fma_f32 v[96:97], v[92:93], v[30:31], v[38:39] op_sel:[1,1,0] op_sel_hi:[0,1,1] neg_lo:[1,0,0]
    v_pk_fma_f32 v[98:99], v[94:95], v[30:31], v[40:41] op_sel:[1,1,0] op_sel_hi:[0,1,1] neg_lo:[1,0,0]
    v_pk_mul_f32 v[34:35], v[80:81], v[28:29] op_sel:[0,0] op_sel_hi:[1,0]
    v_pk_mul_f32 v[36:37], v[82:83], v[28:29] op_sel:[0,0] op_sel_hi:[1,0]
    v_pk_mul_f32 v[38:39], v[96:97], v[30:31] op_sel:[0,0] op_sel_hi:[1,0]
    v_pk_mul_f32 v[40:41], v[98:99], v[30:31] op_sel:[0,0] op_sel_hi:[1,0]
    v_pk_fma_f32 v[84:85], v[80:81], v[28:29], v[34:35] op_sel:[1,1,0] op_sel_hi:[0,1,1] neg_lo:[1,0,0]
    v_pk_fma_f32 v[86:87], v[82:83], v[28:29], v[36:37] op_sel:[1,1,0] op_sel_hi:[0,1,1] neg_lo:[1,0,0]
    v_pk_fma_f32 v[100:101], v[96:97], v[30:31], v[38:39] op_sel:[1,1,0] op_sel_hi:[0,1,1] neg_lo:[1,0,0]
    v_pk_fma_f32 v[102:103], v[98:99], v[30:31], v[40:41] op_sel:[1,1,0] op_sel_hi:[0,1,1] neg_lo:[1,0,0]
    v_cvt_pk_bf16_f32 v128, v72, v74
    v_cvt_pk_bf16_f32 v132, -v73, -v75
    v_cvt_pk_bf16_f32 v129, v76, v78
    v_cvt_pk_bf16_f32 v133, -v77, -v79
    v_cvt_pk_bf16_f32 v130, v80, v82
    v_cvt_pk_bf16_f32 v134, -v81, -v83
    v_cvt_pk_bf16_f32 v131, v84, v86
    v_cvt_pk_bf16_f32 v135, -v85, -v87
    ds_write_b128 v54, v[128:131] offset:0
    ds_write_b128 v54, v[132:135] offset:20480
    v_pk_mul_f32 v[34:35], v[72:73], v[20:21] op_sel:[0,0] op_sel_hi:[1,0]
    v_pk_mul_f32 v[36:37], v[74:75], v[20:21] op_sel:[0,0] op_sel_hi:[1,0]
    v_pk_mul_f32 v[38:39], v[76:77], v[20:21] op_sel:[0,0] op_sel_hi:[1,0]
    v_pk_mul_f32 v[40:41], v[78:79], v[20:21] op_sel:[0,0] op_sel_hi:[1,0]
    v_pk_fma_f32 v[72:73], v[72:73], v[20:21], v[34:35] op_sel:[1,1,0] op_sel_hi:[0,1,1] neg_lo:[1,0,0]
    v_pk_fma_f32 v[74:75], v[74:75], v[20:21], v[36:37] op_sel:[1,1,0] op_sel_hi:[0,1,1] neg_lo:[1,0,0]
    v_pk_fma_f32 v[76:77], v[76:77], v[20:21], v[38:39] op_sel:[1,1,0] op_sel_hi:[0,1,1] neg_lo:[1,0,0]
    v_pk_fma_f32 v[78:79], v[78:79], v[20:21], v[40:41] op_sel:[1,1,0] op_sel_hi:[0,1,1] neg_lo:[1,0,0]
    v_pk_mul_f32 v[34:35], v[80:81], v[20:21] op_sel:[0,0] op_sel_hi:[1,0]
    v_pk_mul_f32 v[36:37], v[82:83], v[20:21] op_sel:[0,0] op_sel_hi:[1,0]
    v_pk_mul_f32 v[38:39], v[84:85], v[20:21] op_sel:[0,0] op_sel_hi:[1,0]
    v_pk_mul_f32 v[40:41], v[86:87], v[20:21] op_sel:[0,0] op_sel_hi:[1,0]
    v_pk_fma_f32 v[80:81], v[80:81], v[20:21], v[34:35] op_sel:[1,1,0] op_sel_hi:[0,1,1] neg_lo:[1,0,0]
    v_pk_fma_f32 v[82:83], v[82:83], v[20:21], v[36:37] op_sel:[1,1,0] op_sel_hi:[0,1,1] neg_lo:[1,0,0]
    v_pk_fma_f32 v[84:85], v[84:85], v[20:21], v[38:39] op_sel:[1,1,0] op_sel_hi:[0,1,1] neg_lo:[1,0,0]
    v_pk_fma_f32 v[86:87], v[86:87], v[20:21], v[40:41] op_sel:[1,1,0] op_sel_hi:[0,1,1] neg_lo:[1,0,0]
    v_cvt_pk_bf16_f32 v136, v88, v90
    v_cvt_pk_bf16_f32 v140, v89, v91
    v_cvt_pk_bf16_f32 v137, v92, v94
    v_cvt_pk_bf16_f32 v141, v93, v95
    v_cvt_pk_bf16_f32 v138, v96, v98
    v_cvt_pk_bf16_f32 v142, v97, v99
    v_cvt_pk_bf16_f32 v139, v100, v102
    v_cvt_pk_bf16_f32 v143, v101, v103
    ds_write_b128 v54, v[136:139] offset:96
    ds_write_b128 v54, v[140:143] offset:20576
    s_waitcnt vmcnt(0)
    s_barrier
    s_cmp_eq_u32 s24, 1
    s_cbranch_scc0 L_bs0
    v_mov_b32 v188, 1
    v_mov_b32 v189, 0
    s_mov_b64 exec, 1
    buffer_store_byte v188, v189, s[4:7], s38 offen
    s_mov_b64 exec, -1
L_bs0:
    v_cvt_pk_bf16_f32 v128, v72, v74
    v_cvt_pk_bf16_f32 v132, -v73, -v75
    v_cvt_pk_bf16_f32 v129, v76, v78
    v_cvt_pk_bf16_f32 v133, -v77, -v79
    v_cvt_pk_bf16_f32 v130, v80, v82
    v_cvt_pk_bf16_f32 v134, -v81, -v83
    v_cvt_pk_bf16_f32 v131, v84, v86
    v_cvt_pk_bf16_f32 v135, -v85, -v87
    ds_write_b128 v54, v[128:131] offset:16
    ds_write_b128 v54, v[132:135] offset:20496
    v_pk_mul_f32 v[34:35], v[100:101], v[30:31] op_sel:[0,0] op_sel_hi:[1,0]
    v_pk_mul_f32 v[36:37], v[102:103], v[30:31] op_sel:[0,0] op_sel_hi:[1,0]
    v_pk_mul_f32 v[38:39], v[72:73], v[32:33] op_sel:[0,0] op_sel_hi:[1,0]
    v_pk_mul_f32 v[40:41], v[76:77], v[32:33] op_sel:[0,0] op_sel_hi:[1,0]
    v_pk_fma_f32 v[88:89], v[100:101], v[30:31], v[34:35] op_sel:[1,1,0] op_sel_hi:[0,1,1] neg_lo:[1,0,0]
    v_pk_fma_f32 v[90:91], v[102:103], v[30:31], v[36:37] op_sel:[1,1,0] op_sel_hi:[0,1,1] neg_lo:[1,0,0]
    v_pk_fma_f32 v[74:75], v[72:73], v[32:33], v[38:39] op_sel:[1,1,0] op_sel_hi:[0,1,1] neg_lo:[1,0,0]
    v_pk_fma_f32 v[78:79], v[76:77], v[32:33], v[40:41] op_sel:[1,1,0] op_sel_hi:[0,1,1] neg_lo:[1,0,0]
    v_pk_mul_f32 v[34:35], v[80:81], v[32:33] op_sel:[0,0] op_sel_hi:[1,0]
    v_pk_mul_f32 v[36:37], v[84:85], v[32:33] op_sel:[0,0] op_sel_hi:[1,0]
    v_pk_mul_f32 v[38:39], v[72:73], v[20:21] op_sel:[0,0] op_sel_hi:[1,0]
    v_pk_mul_f32 v[40:41], v[76:77], v[20:21] op_sel:[0,0] op_sel_hi:[1,0]
    v_pk_fma_f32 v[82:83], v[80:81], v[32:33], v[34:35] op_sel:[1,1,0] op_sel_hi:[0,1,1] neg_lo:[1,0,0]
    v_pk_fma_f32 v[86:87], v[84:85], v[32:33], v[36:37] op_sel:[1,1,0] op_sel_hi:[0,1,1] neg_lo:[1,0,0]
    v_pk_fma_f32 v[72:73], v[72:73], v[20:21], v[38:39] op_sel:[1,1,0] op_sel_hi:[0,1,1] neg_lo:[1,0,0]
    v_pk_fma_f32 v[76:77], v[76:77], v[20:21], v[40:41] op_sel:[1,1,0] op_sel_hi:[0,1,1] neg_lo:[1,0,0]
    v_pk_mul_f32 v[34:35], v[80:81], v[20:21] op_sel:[0,0] op_sel_hi:[1,0]
    v_pk_mul_f32 v[36:37], v[84:85], v[20:21] op_sel:[0,0] op_sel_hi:[1,0]
    v_pk_mul_f32 v[38:39], v[88:89], v[30:31] op_sel:[0,0] op_sel_hi:[1,0]
    v_pk_mul_f32 v[40:41], v[90:91], v[30:31] op_sel:[0,0] op_sel_hi:[1,0]
    v_pk_fma_f32 v[80:81], v[80:81], v[20:21], v[34:35] op_sel:[1,1,0] op_sel_hi:[0,1,1] neg_lo:[1,0,0]
    v_pk_fma_f32 v[84:85], v[84:85], v[20:21], v[36:37] op_sel:[1,1,0] op_sel_hi:[0,1,1] neg_lo:[1,0,0]
    v_pk_fma_f32 v[92:93], v[88:89], v[30:31], v[38:39] op_sel:[1,1,0] op_sel_hi:[0,1,1] neg_lo:[1,0,0]
    v_pk_fma_f32 v[94:95], v[90:91], v[30:31], v[40:41] op_sel:[1,1,0] op_sel_hi:[0,1,1] neg_lo:[1,0,0]
    v_cvt_pk_bf16_f32 v136, v72, v76
    v_cvt_pk_bf16_f32 v140, -v73, -v77
    v_cvt_pk_bf16_f32 v137, v80, v84
    v_cvt_pk_bf16_f32 v141, -v81, -v85
    v_cvt_pk_bf16_f32 v138, v74, v78
    v_cvt_pk_bf16_f32 v142, -v75, -v79
    v_cvt_pk_bf16_f32 v139, v82, v86
    v_cvt_pk_bf16_f32 v143, -v83, -v87
    ds_write_b128 v54, v[136:139] offset:32
    ds_write_b128 v54, v[140:143] offset:20512
    v_pk_mul_f32 v[34:35], v[72:73], v[32:33] op_sel:[0,0] op_sel_hi:[1,0]
    v_pk_mul_f32 v[36:37], v[80:81], v[32:33] op_sel:[0,0] op_sel_hi:[1,0]
    v_pk_mul_f32 v[38:39], v[74:75], v[32:33] op_sel:[0,0] op_sel_hi:[1,0]
    v_pk_mul_f32 v[40:41], v[82:83], v[32:33] op_sel:[0,0] op_sel_hi:[1,0]
    v_pk_fma_f32 v[72:73], v[72:73], v[32:33], v[34:35] op_sel:[1,1,0] op_sel_hi:[0,1,1] neg_lo:[1,0,0]
    v_pk_fma_f32 v[80:81], v[80:81], v[32:33], v[36:37] op_sel:[1,1,0] op_sel_hi:[0,1,1] neg_lo:[1,0,0]
    v_pk_fma_f32 v[74:75], v[74:75], v[32:33], v[38:39] op_sel:[1,1,0] op_sel_hi:[0,1,1] neg_lo:[1,0,0]
    v_pk_fma_f32 v[82:83], v[82:83], v[32:33], v[40:41] op_sel:[1,1,0] op_sel_hi:[0,1,1] neg_lo:[1,0,0]
    v_pk_mul_f32 v[34:35], v[92:93], v[30:31] op_sel:[0,0] op_sel_hi:[1,0]
    v_pk_mul_f32 v[36:37], v[94:95], v[30:31] op_sel:[0,0] op_sel_hi:[1,0]
    v_pk_fma_f32 v[96:97], v[92:93], v[30:31], v[34:35] op_sel:[1,1,0] op_sel_hi:[0,1,1] neg_lo:[1,0,0]
    v_pk_fma_f32 v[98:99], v[94:95], v[30:31], v[36:37] op_sel:[1,1,0] op_sel_hi:[0,1,1] neg_lo:[1,0,0]
    v_cvt_pk_bf16_f32 v128, v72, v80
    v_cvt_pk_bf16_f32 v132, -v73, -v81
    v_cvt_pk_bf16_f32 v129, v74, v82
    v_cvt_pk_bf16_f32 v133, -v75, -v83
    v_pk_mul_f32 v[38:39], v[72:73], v[32:33] op_sel:[0,0] op_sel_hi:[1,0]
    v_pk_mul_f32 v[40:41], v[80:81], v[32:33] op_sel:[0,0] op_sel_hi:[1,0]
    v_pk_mul_f32 v[34:35], v[74:75], v[32:33] op_sel:[0,0] op_sel_hi:[1,0]
    v_pk_mul_f32 v[36:37], v[82:83], v[32:33] op_sel:[0,0] op_sel_hi:[1,0]
    v_pk_fma_f32 v[72:73], v[72:73], v[32:33], v[38:39] op_sel:[1,1,0] op_sel_hi:[0,1,1] neg_lo:[1,0,0]
    v_pk_fma_f32 v[80:81], v[80:81], v[32:33], v[40:41] op_sel:[1,1,0] op_sel_hi:[0,1,1] neg_lo:[1,0,0]
    v_pk_fma_f32 v[74:75], v[74:75], v[32:33], v[34:35] op_sel:[1,1,0] op_sel_hi:[0,1,1] neg_lo:[1,0,0]
    v_pk_fma_f32 v[82:83], v[82:83], v[32:33], v[36:37] op_sel:[1,1,0] op_sel_hi:[0,1,1] neg_lo:[1,0,0]
    v_pk_mul_f32 v[38:39], v[96:97], v[30:31] op_sel:[0,0] op_sel_hi:[1,0]
    v_pk_mul_f32 v[40:41], v[98:99], v[30:31] op_sel:[0,0] op_sel_hi:[1,0]
    v_pk_fma_f32 v[100:101], v[96:97], v[30:31], v[38:39] op_sel:[1,1,0] op_sel_hi:[0,1,1] neg_lo:[1,0,0]
    v_pk_fma_f32 v[102:103], v[98:99], v[30:31], v[40:41] op_sel:[1,1,0] op_sel_hi:[0,1,1] neg_lo:[1,0,0]
    v_cvt_pk_bf16_f32 v130, v72, v80
    v_cvt_pk_bf16_f32 v134, -v73, -v81
    v_cvt_pk_bf16_f32 v131, v74, v82
    v_cvt_pk_bf16_f32 v135, -v75, -v83
    ds_write_b128 v54, v[128:131] offset:48
    ds_write_b128 v54, v[132:135] offset:20528
    v_pk_mul_f32 v[34:35], v[72:73], v[32:33] op_sel:[0,0] op_sel_hi:[1,0]
    v_pk_mul_f32 v[36:37], v[74:75], v[32:33] op_sel:[0,0] op_sel_hi:[1,0]
    v_pk_mul_f32 v[38:39], v[32:33], v[32:33] op_sel:[0,0] op_sel_hi:[1,0]
    v_pk_fma_f32 v[72:73], v[72:73], v[32:33], v[34:35] op_sel:[1,1,0] op_sel_hi:[0,1,1] neg_lo:[1,0,0]
L_wkp_0:
    s_cbranch_execz L_wkp_ret
    v_pk_fma_f32 v[74:75], v[74:75], v[32:33], v[36:37] op_sel:[1,1,0] op_sel_hi:[0,1,1] neg_lo:[1,0,0]
    v_pk_fma_f32 v[28:29], v[32:33], v[32:33], v[38:39] op_sel:[1,1,0] op_sel_hi:[0,1,1] neg_lo:[1,0,0]
    v_cvt_pk_bf16_f32 v136, v88, v90
    v_cvt_pk_bf16_f32 v140, v89, v91
    v_cvt_pk_bf16_f32 v137, v92, v94
    v_cvt_pk_bf16_f32 v141, v93, v95
    v_cvt_pk_bf16_f32 v138, v96, v98
    v_cvt_pk_bf16_f32 v142, v97, v99
    v_cvt_pk_bf16_f32 v139, v100, v102
    v_cvt_pk_bf16_f32 v143, v101, v103
    ds_write_b128 v54, v[136:139] offset:112
    ds_write_b128 v54, v[140:143] offset:20592
    v_pk_mul_f32 v[40:41], v[72:73], v[32:33] op_sel:[0,0] op_sel_hi:[1,0]
    v_pk_mul_f32 v[34:35], v[74:75], v[32:33] op_sel:[0,0] op_sel_hi:[1,0]
    v_pk_mul_f32 v[36:37], v[72:73], v[28:29] op_sel:[0,0] op_sel_hi:[1,0]
    v_pk_mul_f32 v[38:39], v[74:75], v[28:29] op_sel:[0,0] op_sel_hi:[1,0]
    v_pk_fma_f32 v[76:77], v[72:73], v[32:33], v[40:41] op_sel:[1,1,0] op_sel_hi:[0,1,1] neg_lo:[1,0,0]
    v_pk_fma_f32 v[78:79], v[74:75], v[32:33], v[34:35] op_sel:[1,1,0] op_sel_hi:[0,1,1] neg_lo:[1,0,0]
    v_pk_fma_f32 v[80:81], v[72:73], v[28:29], v[36:37] op_sel:[1,1,0] op_sel_hi:[0,1,1] neg_lo:[1,0,0]
    v_pk_fma_f32 v[82:83], v[74:75], v[28:29], v[38:39] op_sel:[1,1,0] op_sel_hi:[0,1,1] neg_lo:[1,0,0]
    v_pk_mul_f32 v[40:41], v[76:77], v[28:29] op_sel:[0,0] op_sel_hi:[1,0]
    v_pk_mul_f32 v[34:35], v[78:79], v[28:29] op_sel:[0,0] op_sel_hi:[1,0]
    v_pk_mul_f32 v[36:37], v[80:81], v[28:29] op_sel:[0,0] op_sel_hi:[1,0]
    v_pk_fma_f32 v[84:85], v[76:77], v[28:29], v[40:41] op_sel:[1,1,0] op_sel_hi:[0,1,1] neg_lo:[1,0,0]
    v_pk_fma_f32 v[86:87], v[78:79], v[28:29], v[34:35] op_sel:[1,1,0] op_sel_hi:[0,1,1] neg_lo:[1,0,0]
    v_pk_fma_f32 v[88:89], v[80:81], v[28:29], v[36:37] op_sel:[1,1,0] op_sel_hi:[0,1,1] neg_lo:[1,0,0]
    v_cvt_pk_bf16_f32 v128, v72, v74
    v_cvt_pk_bf16_f32 v132, -v73, -v75
    v_cvt_pk_bf16_f32 v129, v76, v78
    v_cvt_pk_bf16_f32 v133, -v77, -v79
    v_cvt_pk_bf16_f32 v130, v80, v82
    v_cvt_pk_bf16_f32 v134, -v81, -v83
    v_cvt_pk_bf16_f32 v131, v84, v86
    v_cvt_pk_bf16_f32 v135, -v85, -v87
    ds_write_b128 v54, v[128:131] offset:64
    ds_write_b128 v54, v[132:135] offset:20544
    v_cvt_pk_bf16_f32 v136, v88, v88
    v_cvt_pk_bf16_f32 v140, -v89, -v89
    ds_write_b32 v54, v136 offset:80
    ds_write_b32 v54, v140 offset:20560
    v_and_b32 v55, 1, v0
    v_mul_u32_u24 v55, 6400, v55
    v_add_u32 v55, 134584, v55
    ds_write_b32 v55, v56
    v_lshrrev_b32 v55, 1, v3
    v_mul_u32_u24 v55, 4160, v55
    v_and_b32 v53, 1, v0
    v_lshl_add_u32 v55, v53, 4, v55
    ds_write_b128 v55, v[56:59]
    s_and_b32 s25, s24, 1
    v_lshrrev_b32 v54, 2, v1
    v_mul_u32_u24 v54, 160, v54
    v_and_b32 v55, 3, v0
    v_lshl_add_u32 v54, v55, 3, v54
    v_add_u32 v54, s27, v54
    s_lshl_b32 s28, s25, 6
    v_add_u32 v55, s28, v54
    v_and_b32 v24, 7, v3
    v_lshrrev_b32 v25, 3, v3
    v_lshl_add_u32 v24, v25, 7, v24
    v_lshlrev_b32 v26, 7, v3
    v_add_u32 v26, 1024, v26
    s_cmp_eq_u32 s25, 0
    s_cselect_b64 vcc, -1, 0
    v_cndmask_b32 v24, v26, v24, vcc
    s_cselect_b64 s[60:61], 1, 0
    v_cndmask_b32 v15, 0, v15, s[60:61]
    v_lshrrev_b32 v25, 2, v3
    v_lshlrev_b32 v25, 7, v25
    v_and_b32 v26, 3, v3
    v_lshl_add_u32 v25, v26, 1, v25
    v_add_u32 v25, 256, v25
    v_lshrrev_b32 v26, 1, v3
    v_lshlrev_b32 v26, 7, v26
    v_and_b32 v27, 1, v3
    v_lshl_add_u32 v26, v27, 2, v26
    v_cmp_gt_u32 vcc, 8, v3
    s_nop 1
    v_cndmask_b32 v25, v26, v25, vcc
    s_mul_i32 s28, s26, 6400
    s_add_u32 s28, s28, 128256
    v_lshl_add_u32 v24, v4, 5, v24
    v_lshrrev_b32 v26, 6, v24
    v_lshl_add_u32 v24, v24, 1, s28
    v_lshl_add_u32 v24, v26, 2, v24
    v_lshl_add_u32 v25, v4, 5, v25
    v_lshrrev_b32 v26, 6, v25
    v_lshl_add_u32 v25, v25, 1, s28
    v_lshl_add_u32 v25, v26, 2, v25
    v_add_f32 v14, v14, v14
    s_waitcnt lgkmcnt(0)
    s_barrier
    s_cmp_eq_u32 s24, 0
    s_cbranch_scc0 L_p0m
    v_lshlrev_b32 v9, 2, v1
    buffer_load_dword v8, v9, s[12:15], 0 offen sc1
L_p0m:
    ds_read_b64_tr_b16 v[128:129], v54 offset:96
    ds_read_b64_tr_b16 v[130:131], v54 offset:2656
    ds_read_b64_tr_b16 v[192:193], v55 offset:0
    ds_read_b64_tr_b16 v[194:195], v55 offset:2560
    ds_read_b64_tr_b16 v[224:225], v55 offset:32
    ds_read_b64_tr_b16 v[226:227], v55 offset:2592
    ds_read_b64_tr_b16 v[132:133], v54 offset:5216
    ds_read_b64_tr_b16 v[134:135], v54 offset:7776
    ds_read_b64_tr_b16 v[196:197], v55 offset:5120
    ds_read_b64_tr_b16 v[198:199], v55 offset:7680
    ds_read_b64_tr_b16 v[228:229], v55 offset:5152
    ds_read_b64_tr_b16 v[230:231], v55 offset:7712
    ds_read_b64_tr_b16 v[136:137], v54 offset:10336
    ds_read_b64_tr_b16 v[138:139], v54 offset:12896
    ds_read_b64_tr_b16 v[200:201], v55 offset:10240
    ds_read_b64_tr_b16 v[202:203], v55 offset:12800
    ds_read_b64_tr_b16 v[232:233], v55 offset:10272
    ds_read_b64_tr_b16 v[234:235], v55 offset:12832
    s_waitcnt lgkmcnt(12)
    v_mfma_f32_16x16x32_bf16 v[28:31], v[128:131], v[192:195], 0
    v_mfma_f32_16x16x32_bf16 v[16:19], v[128:131], v[224:227], 0
    ds_read_b64_tr_b16 v[140:141], v54 offset:15456
    ds_read_b64_tr_b16 v[142:143], v54 offset:18016
    ds_read_b64_tr_b16 v[204:205], v55 offset:15360
    ds_read_b64_tr_b16 v[206:207], v55 offset:17920
    ds_read_b64_tr_b16 v[236:237], v55 offset:15392
    ds_read_b64_tr_b16 v[238:239], v55 offset:17952
    s_waitcnt lgkmcnt(12)
    v_mfma_f32_16x16x32_bf16 v[28:31], v[132:135], v[196:199], v[28:31]
    v_mfma_f32_16x16x32_bf16 v[16:19], v[132:135], v[228:231], v[16:19]
    ds_read_b64_tr_b16 v[144:145], v54 offset:20576
    ds_read_b64_tr_b16 v[146:147], v54 offset:23136
    ds_read_b64_tr_b16 v[208:209], v55 offset:20480
    ds_read_b64_tr_b16 v[210:211], v55 offset:23040
    ds_read_b64_tr_b16 v[240:241], v55 offset:20512
    ds_read_b64_tr_b16 v[242:243], v55 offset:23072
    s_waitcnt lgkmcnt(12)
    v_mfma_f32_16x16x32_bf16 v[28:31], v[136:139], v[200:203], v[28:31]
    v_mfma_f32_16x16x32_bf16 v[16:19], v[136:139], v[232:235], v[16:19]
    ds_read_b64_tr_b16 v[148:149], v54 offset:25696
    ds_read_b64_tr_b16 v[150:151], v54 offset:28256
    ds_read_b64_tr_b16 v[212:213], v55 offset:25600
    ds_read_b64_tr_b16 v[214:215], v55 offset:28160
    ds_read_b64_tr_b16 v[244:245], v55 offset:25632
    ds_read_b64_tr_b16 v[246:247], v55 offset:28192
    s_waitcnt lgkmcnt(12)
    v_mfma_f32_16x16x32_bf16 v[28:31], v[140:143], v[204:207], v[28:31]
    v_mfma_f32_16x16x32_bf16 v[16:19], v[140:143], v[236:239], v[16:19]
    ds_read_b64_tr_b16 v[152:153], v54 offset:30816
    ds_read_b64_tr_b16 v[154:155], v54 offset:33376
    ds_read_b64_tr_b16 v[216:217], v55 offset:30720
    ds_read_b64_tr_b16 v[218:219], v55 offset:33280
    ds_read_b64_tr_b16 v[248:249], v55 offset:30752
    ds_read_b64_tr_b16 v[250:251], v55 offset:33312
    s_waitcnt lgkmcnt(12)
    v_mfma_f32_16x16x32_bf16 v[28:31], v[144:147], v[208:211], v[28:31]
    v_mfma_f32_16x16x32_bf16 v[16:19], v[144:147], v[240:243], v[16:19]
    ds_read_b64_tr_b16 v[156:157], v54 offset:35936
    ds_read_b64_tr_b16 v[158:159], v54 offset:38496
    ds_read_b64_tr_b16 v[220:221], v55 offset:35840
    ds_read_b64_tr_b16 v[222:223], v55 offset:38400
    ds_read_b64_tr_b16 v[252:253], v55 offset:35872
    ds_read_b64_tr_b16 v[254:255], v55 offset:38432
    s_waitcnt lgkmcnt(12)
    v_mfma_f32_16x16x32_bf16 v[28:31], v[148:151], v[212:215], v[28:31]
    v_mfma_f32_16x16x32_bf16 v[16:19], v[148:151], v[244:247], v[16:19]
    s_waitcnt lgkmcnt(6)
    v_mfma_f32_16x16x32_bf16 v[28:31], v[152:155], v[216:219], v[28:31]
    v_mfma_f32_16x16x32_bf16 v[16:19], v[152:155], v[248:251], v[16:19]
    s_waitcnt lgkmcnt(0)
    v_mfma_f32_16x16x32_bf16 v[28:31], v[156:159], v[220:223], v[28:31]
    v_mfma_f32_16x16x32_bf16 v[16:19], v[156:159], v[252:255], v[16:19]
    s_nop 6
    v_fma_f32 v28, v28, v14, v15
    v_mul_f32 v29, v29, v14
    v_mul_f32 v30, v30, v14
    v_mul_f32 v31, v31, v14
    v_cvt_pk_bf16_f32 v28, v28, v29
    v_cvt_pk_bf16_f32 v30, v30, v31
    ds_write_b16 v24, v28
    ds_write_b16_d16_hi v24, v28 offset:16
    ds_write_b16 v24, v30 offset:32
    ds_write_b16_d16_hi v24, v30 offset:48
    s_cmp_eq_u32 s25, 0
    s_cbranch_scc0 L_p0n
    v_mul_f32 v16, v16, v14
    v_mul_f32 v17, v17, v14
    v_mul_f32 v18, v18, v14
    v_mul_f32 v19, v19, v14
    v_cvt_pk_bf16_f32 v16, v16, v17
    v_cvt_pk_bf16_f32 v18, v18, v19
    ds_write_b16 v25, v16
    ds_write_b16_d16_hi v25, v16 offset:16
    ds_write_b16 v25, v18 offset:32
    ds_write_b16_d16_hi v25, v18 offset:48
L_p0n:
    s_waitcnt lgkmcnt(0)
    s_barrier
    ds_read_u16 v16, v108 offset:0
    ds_read_u16 v17, v109 offset:0
    ds_read_u16 v18, v110 offset:0
    ds_read_u16 v19, v111 offset:0
    ds_read_u16 v20, v112 offset:0
    ds_read_u16 v21, v113 offset:0
    ds_read_u16 v22, v114 offset:0
    ds_read_u16 v23, v115 offset:0
    ds_read_u16 v24, v116 offset:0
    ds_read_u16 v25, v117 offset:0
    ds_read_u16 v26, v118 offset:0
    ds_read_u16 v28, v108 offset:6400
    ds_read_u16 v29, v109 offset:6400
    ds_read_u16 v30, v110 offset:6400
    ds_read_u16 v31, v111 offset:6400
    ds_read_u16 v32, v112 offset:6400
    ds_read_u16 v33, v113 offset:6400
    ds_read_u16 v34, v114 offset:6400
    ds_read_u16 v35, v115 offset:6400
    ds_read_u16 v36, v116 offset:6400
    ds_read_u16 v37, v117 offset:6400
    ds_read_u16 v38, v118 offset:6400
    s_cmp_eq_u32 s24, 0
    s_cbranch_scc0 L_regx
    s_mov_b32 s23, 0
L_reg:
    s_waitcnt vmcnt(0)
    v_bcnt_u32_b32 v12, v8, 0
    s_nop 1
    v_add_u32_dpp v12, v12, v12 row_shr:1 row_mask:0xf bank_mask:0xf bound_ctrl:1
    s_nop 1
    v_add_u32_dpp v12, v12, v12 row_shr:2 row_mask:0xf bank_mask:0xf bound_ctrl:1
    s_nop 1
    v_add_u32_dpp v12, v12, v12 row_shr:4 row_mask:0xf bank_mask:0xf bound_ctrl:1
    s_nop 1
    v_add_u32_dpp v12, v12, v12 row_shr:8 row_mask:0xf bank_mask:0xf bound_ctrl:1
    s_nop 1
    v_add_u32_dpp v12, v12, v12 row_bcast:15 row_mask:0xa bank_mask:0xf
    s_nop 1
    v_add_u32_dpp v12, v12, v12 row_bcast:31 row_mask:0xc bank_mask:0xf
    s_nop 0
    v_readlane_b32 s28, v12, 63
    s_nop 0
    s_cmp_eq_u32 s28, 256
    s_cbranch_scc1 L_regq
    s_sleep 8
    buffer_load_dword v8, v9, s[12:15], 0 offen sc1
    s_add_u32 s23, s23, 1
    s_cmp_gt_u32 s23, 400000
    s_cbranch_scc0 L_reg
    s_waitcnt vmcnt(0)
L_regq:
    v_cmp_ne_u32 vcc, 0, v8
    s_nop 0
    s_mov_b64 s[28:29], vcc
    v_lshlrev_b32 v12, 3, v1
    v_lshrrev_b64 v[10:11], v12, s[28:29]
    v_and_b32 v10, 0xff, v10
    v_cmp_ne_u32 vcc, 0, v10
    s_nop 1
    s_and_b32 s36, vcc_lo, 0xff
    s_lshl_b32 s28, s32, 3
    v_lshrrev_b32 v12, 3, v1
    v_add_u32 v12, s28, v12
    v_lshlrev_b32 v12, 2, v12
    ds_bpermute_b32 v13, v12, v8
    v_and_b32 v12, 7, v1
    v_lshlrev_b32 v12, 2, v12
    s_waitcnt lgkmcnt(0)
    v_lshrrev_b32 v13, v12, v13
    v_and_b32 v13, 15, v13
    v_cmp_ne_u32 vcc, 0, v13
    s_nop 1
    s_ff1_i32_b64 s28, vcc
    s_and_b32 s28, s28, 63
    s_nop 3
    v_readlane_b32 s29, v13, s28
    s_nop 1
    s_ff1_i32_b32 s29, s29
    s_lshl_b32 s28, s28, 2
    s_add_u32 s28, s28, s29
    s_cmp_eq_u32 s28, s2
    s_cselect_b32 s33, 1, 0
    s_mov_b32 s28, 0x00204081
    v_mul_lo_u32 v13, v13, s28
    v_and_b32 v191, 0x01010101, v13
    s_and_b32 s23, s2, 3
    s_lshl_b32 s23, s23, 3
    s_lshl_b32 s23, 1, s23
    v_mov_b32 v10, s23
    s_bfe_u32 s23, s2, 0x10002
    v_and_b32 v11, 1, v1
    v_cmp_eq_u32 vcc, s23, v11
    s_nop 1
    v_cndmask_b32 v10, 0, v10, vcc
    v_and_b32 v11, v10, v191
    v_cmp_ne_u32 vcc, v10, v11
    s_nop 1
    s_cmp_eq_u64 vcc, 0
    s_cselect_b32 s28, 1, 0
    s_lshl_b32 s29, s36, 8
    s_or_b32 s28, s28, s29
    v_mov_b32 v10, s28
    v_mov_b32 v11, 33776
    ds_write_b32 v11, v10
L_regx:
    s_cmp_eq_u32 s33, 1
    s_cbranch_scc0 L_bl0
    v_lshlrev_b32 v188, 0, v191
    v_lshlrev_b32 v189, 2, v1
    s_mov_b32 s23, 0
L_blp0:
    buffer_load_dword v2, v189, s[4:7], s39 offen sc1
    s_add_u32 s23, s23, 1
    s_cmp_gt_u32 s23, 400000
    s_cbranch_scc1 L_blq0
    s_waitcnt vmcnt(0)
    v_and_b32 v2, v2, v188
    v_cmp_ne_u32 vcc, v2, v188
    s_nop 4
    s_cbranch_vccnz L_blp0
L_blq0:
    s_waitcnt vmcnt(0)
    v_mov_b32 v188, 1
    v_mul_u32_u24 v189, 2048, v1
    s_mov_b64 exec, s[36:37]
    buffer_store_dword v188, v189, s[4:7], s40 offen sc1
    s_mov_b64 exec, -1
L_bl0:
    v_lshlrev_b32 v72, 4, v0
    s_waitcnt lgkmcnt(11)
    v_lshl_or_b32 v40, v20, 16, v19
    v_lshl_or_b32 v41, v22, 16, v21
    v_lshl_or_b32 v42, v24, 16, v23
    v_lshl_or_b32 v43, v26, 16, v25
    ds_write_b128 v72, v[40:43] offset:32
    v_lshl_or_b32 v44, v19, 16, v18
    v_lshl_or_b32 v45, v21, 16, v20
    v_lshl_or_b32 v46, v23, 16, v22
    v_lshl_or_b32 v47, v25, 16, v24
    ds_write_b128 v72, v[44:47] offset:4192
    v_lshl_or_b32 v48, v18, 16, v17
    v_lshl_or_b32 v49, v20, 16, v19
    v_lshl_or_b32 v50, v22, 16, v21
    v_lshl_or_b32 v51, v24, 16, v23
    ds_write_b128 v72, v[48:51] offset:8352
    v_lshl_or_b32 v52, v17, 16, v16
    v_lshl_or_b32 v53, v19, 16, v18
    v_lshl_or_b32 v54, v21, 16, v20
    v_lshl_or_b32 v55, v23, 16, v22
    ds_write_b128 v72, v[52:55] offset:12512
    s_waitcnt lgkmcnt(4)
    v_lshl_or_b32 v56, v32, 16, v31
    v_lshl_or_b32 v57, v34, 16, v33
    v_lshl_or_b32 v58, v36, 16, v35
    v_lshl_or_b32 v59, v38, 16, v37
    ds_write_b128 v72, v[56:59] offset:16672
    v_lshl_or_b32 v60, v31, 16, v30
    v_lshl_or_b32 v61, v33, 16, v32
    v_lshl_or_b32 v62, v35, 16, v34
    v_lshl_or_b32 v63, v37, 16, v36
    ds_write_b128 v72, v[60:63] offset:20832
    v_lshl_or_b32 v64, v30, 16, v29
    v_lshl_or_b32 v65, v32, 16, v31
    v_lshl_or_b32 v66, v34, 16, v33
    v_lshl_or_b32 v67, v36, 16, v35
    ds_write_b128 v72, v[64:67] offset:24992
    v_lshl_or_b32 v68, v29, 16, v28
    v_lshl_or_b32 v69, v31, 16, v30
    v_lshl_or_b32 v70, v33, 16, v32
    v_lshl_or_b32 v71, v35, 16, v34
    ds_write_b128 v72, v[68:71] offset:29152
    s_waitcnt lgkmcnt(0)
    s_barrier
    v_mov_b32 v11, 33776
    ds_read_b32 v10, v11
    s_waitcnt lgkmcnt(0)
    v_readfirstlane_b32 s3, v10
    s_nop 0
    s_lshr_b32 s36, s3, 8
    s_and_b32 s3, s3, 1
    s_cmp_eq_u32 s24, 1
    s_cbranch_scc0 L_wk0_skip
    s_mov_b64 exec, 0
    s_branch L_wk0_0
L_wk0_ret:
    s_mov_b64 exec, -1
L_wk0_skip:
    s_lshr_b32 s25, s24, 1
    s_and_b32 s26, s24, 1
    v_lshrrev_b32 v5, 2, v1
    v_mul_u32_u24 v6, 16640, v5
    v_and_b32 v7, 3, v0
    v_lshl_add_u32 v6, v7, 4, v6
    s_mul_i32 s28, s24, 1064960
    s_lshl_b32 s27, s18, 6
    s_add_u32 s28, s28, s27
    s_add_u32 s29, s28, 266240
    s_add_u32 s30, s28, 532480
    s_add_u32 s31, s28, 798720
    s_mov_b32 s44, s28
    v_mov_b32 v10, 43008
    v_mov_b32 v11, 47104
    v_cmp_eq_u32 vcc, 1, v7
    s_nop 1
    v_cndmask_b32 v10, v10, v11, vcc
    v_mov_b32 v11, 34304
    v_cmp_eq_u32 vcc, 2, v7
    s_nop 1
    v_cndmask_b32 v10, v10, v11, vcc
    v_mov_b32 v11, 38912
    v_cmp_eq_u32 vcc, 3, v7
    s_nop 1
    v_cndmask_b32 v10, v10, v11, vcc
    v_lshl_add_u32 v10, v5, 4, v10
    s_lshl_b32 s27, s24, 10
    v_add_u32 v10, s27, v10
    s_lshr_b32 s35, s2, 4
    s_lshl_b32 s35, s35, 1
    s_add_u32 s35, s35, s26
    s_mul_i32 s35, s35, 49152
    s_add_u32 s35, s35, 10616832
    s_mul_i32 s27, s25, 22528
    s_add_u32 s45, s35, s27
    s_add_u32 s45, s45, 4096
    s_mul_i32 s46, s26, 45056
    s_add_u32 s46, s46, s27
    s_add_u32 s46, s46, 67584
    v_lshlrev_b32 v7, 4, v1
    v_mov_b32 v12, 0
    v_mov_b32 v13, 0
    v_mov_b32 v14, 0
    v_mov_b32 v15, 0
    v_lshrrev_b32 v9, 5, v1
    v_mul_u32_u24 v9, 4608, v9
    v_and_b32 v11, 31, v0
    v_lshl_add_u32 v9, v11, 4, v9
    ds_write_b128 v9, v[12:15] offset:33792
    v_lshrrev_b32 v9, 2, v3
    v_mul_u32_u24 v9, 4160, v9
    v_and_b32 v11, 3, v0
    v_lshl_add_u32 v9, v11, 3, v9
    v_lshlrev_b32 v11, 4, v4
    v_sub_u32 v9, v9, v11
    s_mul_i32 s27, s25, 16640
    s_lshl_b32 s28, s26, 8
    s_add_u32 s27, s27, s28
    s_add_u32 s27, s27, 56
    v_add_u32 v9, s27, v9
    v_lshl_add_u32 v11, v3, 5, v11
    s_mul_i32 s27, s25, 4608
    s_sub_u32 s27, s27, s28
    s_add_u32 s27, s27, 34080
    v_add_u32 v11, s27, v11
    ds_read_b64_tr_b16 v[60:61], v9 offset:8
    ds_read_b64_tr_b16 v[62:63], v9 offset:0
    ds_read_b64_tr_b16 v[64:65], v9 offset:520
    ds_read_b64_tr_b16 v[66:67], v9 offset:512
    ds_read_b64_tr_b16 v[68:69], v9 offset:1032
    ds_read_b64_tr_b16 v[70:71], v9 offset:1024
    ds_read_b64_tr_b16 v[72:73], v9 offset:1544
    ds_read_b64_tr_b16 v[74:75], v9 offset:1536
    ds_read_b64_tr_b16 v[76:77], v9 offset:2056
    ds_read_b64_tr_b16 v[78:79], v9 offset:2048
    ds_read_b64_tr_b16 v[80:81], v9 offset:2568
    ds_read_b64_tr_b16 v[82:83], v9 offset:2560
    ds_read_b64_tr_b16 v[84:85], v9 offset:3080
    ds_read_b64_tr_b16 v[86:87], v9 offset:3072
    ds_read_b64_tr_b16 v[88:89], v9 offset:3592
    ds_read_b64_tr_b16 v[90:91], v9 offset:3584
    s_lshl_b32 s27, s24, 11
    s_add_u32 s27, s27, 43008
    v_lshlrev_b32 v8, 5, v3
    v_lshl_add_u32 v8, v4, 3, v8
    v_add_u32 v8, s27, v8
    s_lshl_b32 s27, s24, 12
    s_add_u32 s27, s27, 51200
    v_add_u32 v48, s27, v7
    s_xor_b32 s27, s24, 1
    s_lshl_b32 s27, s27, 12
    s_add_u32 s27, s27, 51200
    v_add_u32 v49, s27, v7
    v_and_b32 v50, 1, v4
    v_lshlrev_b32 v50, 18, v50
    v_lshrrev_b32 v51, 3, v3
    v_lshl_add_u32 v50, v51, 17, v50
    v_and_b32 v51, 7, v3
    v_lshl_add_u32 v50, v51, 5, v50
    v_lshrrev_b32 v51, 1, v4
    v_lshl_add_u32 v50, v51, 4, v50
    s_lshl_b32 s34, s18, 9
    s_lshl_b32 s27, s25, 8
    s_add_u32 s34, s34, s27
    s_lshl_b32 s27, s26, 20
    s_add_u32 s34, s34, s27
    s_add_u32 s34, s34, 4325376
    s_add_u32 s43, s34, 524288
    v_mov_b32 v12, 0x3b000000
    v_mov_b32 v14, 0x3727c5ac
    s_cmp_eq_u32 s24, 0
    s_cbranch_scc0 L_bw0
    v_mul_u32_u24 v189, 256, v1
    s_mov_b32 s23, 0
    s_mov_b64 exec, s[36:37]
L_bwp0:
    buffer_load_dword v2, v189, s[4:7], s41 offen sc1
    s_add_u32 s23, s23, 1
    s_cmp_gt_u32 s23, 400000
    s_cbranch_scc1 L_bwq0
    s_waitcnt vmcnt(0)
    v_cmp_gt_u32 vcc, 1, v2
    s_nop 4
    s_and_b64 exec, exec, vcc
    s_cbranch_execnz L_bwp0
L_bwq0:
    s_waitcnt vmcnt(0)
    s_mov_b64 exec, -1
L_bw0:
    s_waitcnt lgkmcnt(0)
    s_barrier
    buffer_load_dwordx4 v[16:19], v6, s[4:7], s44 offen sc1
    buffer_load_dwordx4 v[20:23], v6, s[4:7], s29 offen sc1
    buffer_load_dwordx4 v[24:27], v6, s[4:7], s30 offen sc1
    buffer_load_dwordx4 v[28:31], v6, s[4:7], s31 offen sc1
    s_waitcnt vmcnt(3)
    ds_write_b128 v10, v[16:19] offset:0
    s_waitcnt vmcnt(2)
    ds_write_b128 v10, v[20:23] offset:256
    s_waitcnt vmcnt(1)
    ds_write_b128 v10, v[24:27] offset:512
    s_waitcnt vmcnt(0)
    ds_write_b128 v10, v[28:31] offset:768
    buffer_load_dwordx4 a[0:3], v7, s[4:7], s35 offen offset:0
    buffer_load_dwordx4 a[4:7], v7, s[4:7], s35 offen offset:1024
    buffer_load_dwordx4 a[8:11], v7, s[4:7], s35 offen offset:2048
    buffer_load_dwordx4 a[12:15], v7, s[4:7], s35 offen offset:3072
    s_waitcnt lgkmcnt(0)
    s_barrier
    ds_read_b128 v[92:95], v11 offset:192
    ds_read_b128 v[96:99], v11 offset:704
    ds_read_b128 v[100:103], v11 offset:1216
    ds_read_b128 v[104:107], v11 offset:1728
    ds_read_b128 v[108:111], v11 offset:2240
    ds_read_b128 v[112:115], v11 offset:2752
    ds_read_b128 v[116:119], v11 offset:3264
    ds_read_b128 v[120:123], v11 offset:3776
    s_waitcnt lgkmcnt(7)
    v_mfma_f32_16x16x32_bf16 v[16:19], v[60:63], v[92:95], 0
    ds_read_b64_tr_b16 v[124:125], v9 offset:72
    s_waitcnt lgkmcnt(7)
    v_mfma_f32_16x16x32_bf16 v[20:23], v[60:63], v[96:99], 0
    ds_read_b64_tr_b16 v[126:127], v9 offset:64
    s_waitcnt lgkmcnt(7)
    v_mfma_f32_16x16x32_bf16 v[24:27], v[60:63], v[100:103], 0
    ds_read_b128 v[156:159], v11 offset:128
    s_waitcnt lgkmcnt(7)
    v_mfma_f32_16x16x32_bf16 v[28:31], v[60:63], v[104:107], 0
    ds_read_b128 v[160:163], v11 offset:640
    s_waitcnt lgkmcnt(7)
    v_mfma_f32_16x16x32_bf16 v[32:35], v[60:63], v[108:111], 0
    ds_read_b128 v[164:167], v11 offset:1152
    s_add_u32 m0, s46, 0
    s_nop 0
    buffer_load_dwordx4 v7, s[4:7], s45 offen offset:0 lds
    s_waitcnt lgkmcnt(7)
    v_mfma_f32_16x16x32_bf16 v[36:39], v[60:63], v[112:115], 0
    ds_read_b128 v[168:171], v11 offset:1664
    s_waitcnt lgkmcnt(7)
    v_mfma_f32_16x16x32_bf16 v[40:43], v[60:63], v[116:119], 0
    ds_read_b128 v[172:175], v11 offset:2176
    s_waitcnt lgkmcnt(7)
    v_mfma_f32_16x16x32_bf16 v[44:47], v[60:63], v[120:123], 0
    ds_read_b128 v[176:179], v11 offset:2688
    v_mfma_f32_16x16x32_bf16 v[20:23], v[64:67], v[92:95], v[20:23]
    ds_read_b128 v[180:183], v11 offset:3200
    v_mfma_f32_16x16x32_bf16 v[24:27], v[64:67], v[96:99], v[24:27]
    ds_read_b128 v[184:187], v11 offset:3712
    buffer_load_dwordx4 v7, s[4:7], s45 offen offset:1024 lds
    v_mfma_f32_16x16x32_bf16 v[28:31], v[64:67], v[100:103], v[28:31]
    ds_read_b64_tr_b16 v[128:129], v9 offset:584
    v_mfma_f32_16x16x32_bf16 v[32:35], v[64:67], v[104:107], v[32:35]
    ds_read_b64_tr_b16 v[130:131], v9 offset:576
    v_mfma_f32_16x16x32_bf16 v[36:39], v[64:67], v[108:111], v[36:39]
    ds_read_b64_tr_b16 v[132:133], v9 offset:1096
    v_mfma_f32_16x16x32_bf16 v[40:43], v[64:67], v[112:115], v[40:43]
    ds_read_b64_tr_b16 v[134:135], v9 offset:1088
    v_mfma_f32_16x16x32_bf16 v[44:47], v[64:67], v[116:119], v[44:47]
    ds_read_b64_tr_b16 v[136:137], v9 offset:1608
    buffer_load_dwordx4 v7, s[4:7], s45 offen offset:2048 lds
    v_mfma_f32_16x16x32_bf16 v[24:27], v[68:71], v[92:95], v[24:27]
    ds_read_b64_tr_b16 v[138:139], v9 offset:1600
    v_mfma_f32_16x16x32_bf16 v[28:31], v[68:71], v[96:99], v[28:31]
    ds_read_b64_tr_b16 v[140:141], v9 offset:2120
    v_mfma_f32_16x16x32_bf16 v[32:35], v[68:71], v[100:103], v[32:35]
    ds_read_b64_tr_b16 v[142:143], v9 offset:2112
    v_mfma_f32_16x16x32_bf16 v[36:39], v[68:71], v[104:107], v[36:39]
    ds_read_b64_tr_b16 v[144:145], v9 offset:2632
    v_mfma_f32_16x16x32_bf16 v[40:43], v[68:71], v[108:111], v[40:43]
    ds_read_b64_tr_b16 v[146:147], v9 offset:2624
    buffer_load_dwordx4 v7, s[4:7], s45 offen offset:3072 lds
    s_add_u32 s45, s45, 4096
    v_mfma_f32_16x16x32_bf16 v[44:47], v[68:71], v[112:115], v[44:47]
    ds_read_b64_tr_b16 v[148:149], v9 offset:3144
    v_mfma_f32_16x16x32_bf16 v[28:31], v[72:75], v[92:95], v[28:31]
    ds_read_b64_tr_b16 v[150:151], v9 offset:3136
    v_mfma_f32_16x16x32_bf16 v[32:35], v[72:75], v[96:99], v[32:35]
    ds_read_b64_tr_b16 v[152:153], v9 offset:3656
    v_mfma_f32_16x16x32_bf16 v[36:39], v[72:75], v[100:103], v[36:39]
    ds_read_b64_tr_b16 v[154:155], v9 offset:3648
    v_mfma_f32_16x16x32_bf16 v[40:43], v[72:75], v[104:107], v[40:43]
    s_add_u32 m0, s46, 4096
    s_nop 0
    buffer_load_dwordx4 v7, s[4:7], s45 offen offset:0 lds
    v_mfma_f32_16x16x32_bf16 v[44:47], v[72:75], v[108:111], v[44:47]
    v_mfma_f32_16x16x32_bf16 v[32:35], v[76:79], v[92:95], v[32:35]
    v_mfma_f32_16x16x32_bf16 v[36:39], v[76:79], v[96:99], v[36:39]
    v_mfma_f32_16x16x32_bf16 v[40:43], v[76:79], v[100:103], v[40:43]
    v_mfma_f32_16x16x32_bf16 v[44:47], v[76:79], v[104:107], v[44:47]
    buffer_load_dwordx4 v7, s[4:7], s45 offen offset:1024 lds
    v_mfma_f32_16x16x32_bf16 v[36:39], v[80:83], v[92:95], v[36:39]
    v_mfma_f32_16x16x32_bf16 v[40:43], v[80:83], v[96:99], v[40:43]
    v_mfma_f32_16x16x32_bf16 v[44:47], v[80:83], v[100:103], v[44:47]
    v_mfma_f32_16x16x32_bf16 v[40:43], v[84:87], v[92:95], v[40:43]
    v_mfma_f32_16x16x32_bf16 v[44:47], v[84:87], v[96:99], v[44:47]
    buffer_load_dwordx4 v7, s[4:7], s45 offen offset:2048 lds
    v_mfma_f32_16x16x32_bf16 v[44:47], v[88:91], v[92:95], v[44:47]
    s_waitcnt lgkmcnt(0)
    v_mfma_f32_16x16x32_bf16 v[16:19], v[124:127], v[156:159], v[16:19]
    ds_read_b64_tr_b16 v[60:61], v9 offset:136
    v_mfma_f32_16x16x32_bf16 v[20:23], v[124:127], v[160:163], v[20:23]
    ds_read_b64_tr_b16 v[62:63], v9 offset:128
    v_mfma_f32_16x16x32_bf16 v[24:27], v[124:127], v[164:167], v[24:27]
    ds_read_b128 v[92:95], v11 offset:64
    v_mfma_f32_16x16x32_bf16 v[28:31], v[124:127], v[168:171], v[28:31]
    ds_read_b128 v[96:99], v11 offset:576
    buffer_load_dwordx4 v7, s[4:7], s45 offen offset:3072 lds
    s_add_u32 s45, s45, 4096
    v_mfma_f32_16x16x32_bf16 v[32:35], v[124:127], v[172:175], v[32:35]
    ds_read_b128 v[100:103], v11 offset:1088
    v_mfma_f32_16x16x32_bf16 v[36:39], v[124:127], v[176:179], v[36:39]
    ds_read_b128 v[104:107], v11 offset:1600
    v_mfma_f32_16x16x32_bf16 v[40:43], v[124:127], v[180:183], v[40:43]
    ds_read_b128 v[108:111], v11 offset:2112
    v_mfma_f32_16x16x32_bf16 v[44:47], v[124:127], v[184:187], v[44:47]
    ds_read_b128 v[112:115], v11 offset:2624
    v_mfma_f32_16x16x32_bf16 v[20:23], v[128:131], v[156:159], v[20:23]
    ds_read_b128 v[116:119], v11 offset:3136
L_wk0_0:
    s_cbranch_execz L_wk0_1
    s_add_u32 m0, s46, 8192
    s_nop 0
    buffer_load_dwordx4 v7, s[4:7], s45 offen offset:0 lds
    v_mfma_f32_16x16x32_bf16 v[24:27], v[128:131], v[160:163], v[24:27]
    ds_read_b128 v[120:123], v11 offset:3648
    v_mfma_f32_16x16x32_bf16 v[28:31], v[128:131], v[164:167], v[28:31]
    ds_read_b64_tr_b16 v[64:65], v9 offset:648
    v_mfma_f32_16x16x32_bf16 v[32:35], v[128:131], v[168:171], v[32:35]
    ds_read_b64_tr_b16 v[66:67], v9 offset:640
    v_mfma_f32_16x16x32_bf16 v[36:39], v[128:131], v[172:175], v[36:39]
    ds_read_b64_tr_b16 v[68:69], v9 offset:1160
    v_mfma_f32_16x16x32_bf16 v[40:43], v[128:131], v[176:179], v[40:43]
    ds_read_b64_tr_b16 v[70:71], v9 offset:1152
    buffer_load_dwordx4 v7, s[4:7], s45 offen offset:1024 lds
    v_mfma_f32_16x16x32_bf16 v[44:47], v[128:131], v[180:183], v[44:47]
    ds_read_b64_tr_b16 v[72:73], v9 offset:1672
    v_mfma_f32_16x16x32_bf16 v[24:27], v[132:135], v[156:159], v[24:27]
    ds_read_b64_tr_b16 v[74:75], v9 offset:1664
    v_mfma_f32_16x16x32_bf16 v[28:31], v[132:135], v[160:163], v[28:31]
    ds_read_b64_tr_b16 v[76:77], v9 offset:2184
    v_mfma_f32_16x16x32_bf16 v[32:35], v[132:135], v[164:167], v[32:35]
    ds_read_b64_tr_b16 v[78:79], v9 offset:2176
    v_mfma_f32_16x16x32_bf16 v[36:39], v[132:135], v[168:171], v[36:39]
    ds_read_b64_tr_b16 v[80:81], v9 offset:2696
    buffer_load_dwordx4 v7, s[4:7], s45 offen offset:2048 lds
    v_mfma_f32_16x16x32_bf16 v[40:43], v[132:135], v[172:175], v[40:43]
    ds_read_b64_tr_b16 v[82:83], v9 offset:2688
    v_mfma_f32_16x16x32_bf16 v[44:47], v[132:135], v[176:179], v[44:47]
    ds_read_b64_tr_b16 v[84:85], v9 offset:3208
    v_mfma_f32_16x16x32_bf16 v[28:31], v[136:139], v[156:159], v[28:31]
    ds_read_b64_tr_b16 v[86:87], v9 offset:3200
    v_mfma_f32_16x16x32_bf16 v[32:35], v[136:139], v[160:163], v[32:35]
    ds_read_b64_tr_b16 v[88:89], v9 offset:3720
    v_mfma_f32_16x16x32_bf16 v[36:39], v[136:139], v[164:167], v[36:39]
    ds_read_b64_tr_b16 v[90:91], v9 offset:3712
    buffer_load_dwordx4 v7, s[4:7], s45 offen offset:3072 lds
    s_add_u32 s45, s45, 4096
    v_mfma_f32_16x16x32_bf16 v[40:43], v[136:139], v[168:171], v[40:43]
    v_mfma_f32_16x16x32_bf16 v[44:47], v[136:139], v[172:175], v[44:47]
    v_mfma_f32_16x16x32_bf16 v[32:35], v[140:143], v[156:159], v[32:35]
    v_mfma_f32_16x16x32_bf16 v[36:39], v[140:143], v[160:163], v[36:39]
    v_mfma_f32_16x16x32_bf16 v[40:43], v[140:143], v[164:167], v[40:43]
    s_add_u32 m0, s46, 12288
    s_nop 0
    buffer_load_dwordx4 v7, s[4:7], s45 offen offset:0 lds
    v_mfma_f32_16x16x32_bf16 v[44:47], v[140:143], v[168:171], v[44:47]
    v_mfma_f32_16x16x32_bf16 v[36:39], v[144:147], v[156:159], v[36:39]
    v_mfma_f32_16x16x32_bf16 v[40:43], v[144:147], v[160:163], v[40:43]
    v_mfma_f32_16x16x32_bf16 v[44:47], v[144:147], v[164:167], v[44:47]
    v_mfma_f32_16x16x32_bf16 v[40:43], v[148:151], v[156:159], v[40:43]
    buffer_load_dwordx4 v7, s[4:7], s45 offen offset:1024 lds
    v_mfma_f32_16x16x32_bf16 v[44:47], v[148:151], v[160:163], v[44:47]
    v_mfma_f32_16x16x32_bf16 v[44:47], v[152:155], v[156:159], v[44:47]
    s_waitcnt lgkmcnt(0)
    v_mfma_f32_16x16x32_bf16 v[16:19], v[60:63], v[92:95], v[16:19]
    ds_read_b64_tr_b16 v[124:125], v9 offset:200
    v_mfma_f32_16x16x32_bf16 v[20:23], v[60:63], v[96:99], v[20:23]
    ds_read_b64_tr_b16 v[126:127], v9 offset:192
    v_mfma_f32_16x16x32_bf16 v[24:27], v[60:63], v[100:103], v[24:27]
    ds_read_b128 v[156:159], v11 offset:0
    buffer_load_dwordx4 v7, s[4:7], s45 offen offset:2048 lds
    v_mfma_f32_16x16x32_bf16 v[28:31], v[60:63], v[104:107], v[28:31]
    ds_read_b128 v[160:163], v11 offset:512
    v_mfma_f32_16x16x32_bf16 v[32:35], v[60:63], v[108:111], v[32:35]
    ds_read_b128 v[164:167], v11 offset:1024
    v_mfma_f32_16x16x32_bf16 v[36:39], v[60:63], v[112:115], v[36:39]
    ds_read_b128 v[168:171], v11 offset:1536
    v_mfma_f32_16x16x32_bf16 v[40:43], v[60:63], v[116:119], v[40:43]
    ds_read_b128 v[172:175], v11 offset:2048
    v_mfma_f32_16x16x32_bf16 v[44:47], v[60:63], v[120:123], v[44:47]
    ds_read_b128 v[176:179], v11 offset:2560
    buffer_load_dwordx4 v7, s[4:7], s45 offen offset:3072 lds
    s_add_u32 s45, s45, 4096
    v_mfma_f32_16x16x32_bf16 v[20:23], v[64:67], v[92:95], v[20:23]
    ds_read_b128 v[180:183], v11 offset:3072
    v_mfma_f32_16x16x32_bf16 v[24:27], v[64:67], v[96:99], v[24:27]
    ds_read_b128 v[184:187], v11 offset:3584
    v_mfma_f32_16x16x32_bf16 v[28:31], v[64:67], v[100:103], v[28:31]
    ds_read_b64_tr_b16 v[128:129], v9 offset:712
    v_mfma_f32_16x16x32_bf16 v[32:35], v[64:67], v[104:107], v[32:35]
    ds_read_b64_tr_b16 v[130:131], v9 offset:704
    v_mfma_f32_16x16x32_bf16 v[36:39], v[64:67], v[108:111], v[36:39]
    ds_read_b64_tr_b16 v[132:133], v9 offset:1224
    s_add_u32 m0, s46, 16384
    s_nop 0
    buffer_load_dwordx4 v7, s[4:7], s45 offen offset:0 lds
    v_mfma_f32_16x16x32_bf16 v[40:43], v[64:67], v[112:115], v[40:43]
    ds_read_b64_tr_b16 v[134:135], v9 offset:1216
    v_mfma_f32_16x16x32_bf16 v[44:47], v[64:67], v[116:119], v[44:47]
    ds_read_b64_tr_b16 v[136:137], v9 offset:1736
    v_mfma_f32_16x16x32_bf16 v[24:27], v[68:71], v[92:95], v[24:27]
    ds_read_b64_tr_b16 v[138:139], v9 offset:1728
    v_mfma_f32_16x16x32_bf16 v[28:31], v[68:71], v[96:99], v[28:31]
    ds_read_b64_tr_b16 v[140:141], v9 offset:2248
    v_mfma_f32_16x16x32_bf16 v[32:35], v[68:71], v[100:103], v[32:35]
    ds_read_b64_tr_b16 v[142:143], v9 offset:2240
    buffer_load_dwordx4 v7, s[4:7], s45 offen offset:1024 lds
    v_mfma_f32_16x16x32_bf16 v[36:39], v[68:71], v[104:107], v[36:39]
    ds_read_b64_tr_b16 v[144:145], v9 offset:2760
    v_mfma_f32_16x16x32_bf16 v[40:43], v[68:71], v[108:111], v[40:43]
    ds_read_b64_tr_b16 v[146:147], v9 offset:2752
    v_mfma_f32_16x16x32_bf16 v[44:47], v[68:71], v[112:115], v[44:47]
    ds_read_b64_tr_b16 v[148:149], v9 offset:3272
    v_mfma_f32_16x16x32_bf16 v[28:31], v[72:75], v[92:95], v[28:31]
    ds_read_b64_tr_b16 v[150:151], v9 offset:3264
    v_mfma_f32_16x16x32_bf16 v[32:35], v[72:75], v[96:99], v[32:35]
    ds_read_b64_tr_b16 v[152:153], v9 offset:3784
    buffer_load_dwordx4 v7, s[4:7], s45 offen offset:2048 lds
    v_mfma_f32_16x16x32_bf16 v[36:39], v[72:75], v[100:103], v[36:39]
    ds_read_b64_tr_b16 v[154:155], v9 offset:3776
    v_mfma_f32_16x16x32_bf16 v[40:43], v[72:75], v[104:107], v[40:43]
    v_mfma_f32_16x16x32_bf16 v[44:47], v[72:75], v[108:111], v[44:47]
    v_mfma_f32_16x16x32_bf16 v[32:35], v[76:79], v[92:95], v[32:35]
    v_mfma_f32_16x16x32_bf16 v[36:39], v[76:79], v[96:99], v[36:39]
    buffer_load_dwordx4 v7, s[4:7], s45 offen offset:3072 lds
    s_add_u32 s45, s45, 4096
    v_mfma_f32_16x16x32_bf16 v[40:43], v[76:79], v[100:103], v[40:43]
    v_mfma_f32_16x16x32_bf16 v[44:47], v[76:79], v[104:107], v[44:47]
    v_mfma_f32_16x16x32_bf16 v[36:39], v[80:83], v[92:95], v[36:39]
    v_mfma_f32_16x16x32_bf16 v[40:43], v[80:83], v[96:99], v[40:43]
    v_mfma_f32_16x16x32_bf16 v[44:47], v[80:83], v[100:103], v[44:47]
    s_add_u32 m0, s46, 20480
    s_nop 0
    buffer_load_dwordx4 v7, s[4:7], s45 offen offset:0 lds
    v_mfma_f32_16x16x32_bf16 v[40:43], v[84:87], v[92:95], v[40:43]
    v_mfma_f32_16x16x32_bf16 v[44:47], v[84:87], v[96:99], v[44:47]
    v_mfma_f32_16x16x32_bf16 v[44:47], v[88:91], v[92:95], v[44:47]
    buffer_load_dwordx4 v7, s[4:7], s45 offen offset:1024 lds
    s_waitcnt lgkmcnt(0)
    s_cmp_eq_u32 s26, 0
    s_cbranch_scc0 L_c0h1
    v_mfma_f32_16x16x32_bf16 v[32:35], v[124:127], v[172:175], v[32:35]
    ds_read_b64 v[60:61], v8 offset:0
    v_mfma_f32_16x16x32_bf16 v[36:39], v[124:127], v[176:179], v[36:39]
    ds_read_b64 v[62:63], v8 offset:512
    v_mfma_f32_16x16x32_bf16 v[40:43], v[124:127], v[180:183], v[40:43]
    ds_read_b64 v[64:65], v8 offset:1024
    v_mfma_f32_16x16x32_bf16 v[44:47], v[124:127], v[184:187], v[44:47]
    ds_read_b64 v[66:67], v8 offset:1536
    v_mfma_f32_16x16x32_bf16 v[32:35], v[128:131], v[168:171], v[32:35]
    v_mfma_f32_16x16x32_bf16 v[36:39], v[128:131], v[172:175], v[36:39]
    v_mfma_f32_16x16x32_bf16 v[40:43], v[128:131], v[176:179], v[40:43]
    v_mfma_f32_16x16x32_bf16 v[44:47], v[128:131], v[180:183], v[44:47]
    s_waitcnt lgkmcnt(0)
    v_mfma_f32_16x16x32_bf16 v[32:35], v[132:135], v[164:167], v[32:35]
    v_lshlrev_b32 v68, 16, v60
    v_mfma_f32_16x16x32_bf16 v[36:39], v[132:135], v[168:171], v[36:39]
    v_and_b32 v69, 0xffff0000, v60
    v_mfma_f32_16x16x32_bf16 v[40:43], v[132:135], v[172:175], v[40:43]
    v_lshlrev_b32 v70, 16, v61
    v_mfma_f32_16x16x32_bf16 v[44:47], v[132:135], v[176:179], v[44:47]
    v_and_b32 v71, 0xffff0000, v61
    v_mfma_f32_16x16x32_bf16 v[32:35], v[136:139], v[160:163], v[32:35]
    v_lshlrev_b32 v72, 16, v62
    v_mfma_f32_16x16x32_bf16 v[36:39], v[136:139], v[164:167], v[36:39]
    v_and_b32 v73, 0xffff0000, v62
    v_mfma_f32_16x16x32_bf16 v[40:43], v[136:139], v[168:171], v[40:43]
    v_lshlrev_b32 v74, 16, v63
    v_mfma_f32_16x16x32_bf16 v[44:47], v[136:139], v[172:175], v[44:47]
    v_and_b32 v75, 0xffff0000, v63
    v_mfma_f32_16x16x32_bf16 v[32:35], v[140:143], v[156:159], v[32:35]
    v_lshlrev_b32 v76, 16, v64
    v_mfma_f32_16x16x32_bf16 v[36:39], v[140:143], v[160:163], v[36:39]
    v_and_b32 v77, 0xffff0000, v64
    v_mfma_f32_16x16x32_bf16 v[40:43], v[140:143], v[164:167], v[40:43]
    v_lshlrev_b32 v78, 16, v65
    v_mfma_f32_16x16x32_bf16 v[44:47], v[140:143], v[168:171], v[44:47]
    v_and_b32 v79, 0xffff0000, v65
    v_mfma_f32_16x16x32_bf16 v[36:39], v[144:147], v[156:159], v[36:39]
    v_lshlrev_b32 v80, 16, v66
    v_mfma_f32_16x16x32_bf16 v[40:43], v[144:147], v[160:163], v[40:43]
    v_and_b32 v81, 0xffff0000, v66
    v_mfma_f32_16x16x32_bf16 v[44:47], v[144:147], v[164:167], v[44:47]
    v_lshlrev_b32 v82, 16, v67
    v_mfma_f32_16x16x32_bf16 v[40:43], v[148:151], v[156:159], v[40:43]
    v_and_b32 v83, 0xffff0000, v67
    v_mfma_f32_16x16x32_bf16 v[44:47], v[148:151], v[160:163], v[44:47]
    ds_write_b128 v48, v[32:35] offset:0
    v_mfma_f32_16x16x32_bf16 v[44:47], v[152:155], v[156:159], v[44:47]
    v_mfma_f32_16x16x32_bf16 v[16:19], v[124:127], v[156:159], v[16:19]
    v_mfma_f32_16x16x32_bf16 v[20:23], v[124:127], v[160:163], v[20:23]
    v_mfma_f32_16x16x32_bf16 v[24:27], v[124:127], v[164:167], v[24:27]
    ds_write_b128 v48, v[36:39] offset:1024
    v_mfma_f32_16x16x32_bf16 v[28:31], v[124:127], v[168:171], v[28:31]
    v_mfma_f32_16x16x32_bf16 v[20:23], v[128:131], v[156:159], v[20:23]
    v_mfma_f32_16x16x32_bf16 v[24:27], v[128:131], v[160:163], v[24:27]
    ds_write_b128 v48, v[40:43] offset:2048
    v_mfma_f32_16x16x32_bf16 v[28:31], v[128:131], v[164:167], v[28:31]
    v_mfma_f32_16x16x32_bf16 v[24:27], v[132:135], v[156:159], v[24:27]
    ds_write_b128 v48, v[44:47] offset:3072
    v_mfma_f32_16x16x32_bf16 v[28:31], v[132:135], v[160:163], v[28:31]
    v_mfma_f32_16x16x32_bf16 v[28:31], v[136:139], v[156:159], v[28:31]
    s_waitcnt lgkmcnt(0)
    s_barrier
    ds_read_b128 v[84:87], v49 offset:0
    ds_read_b128 v[88:91], v49 offset:1024
    ds_read_b128 v[92:95], v49 offset:2048
    ds_read_b128 v[96:99], v49 offset:3072
    v_pk_add_f32 v[16:17], v[16:17], v[68:69]
    v_pk_add_f32 v[18:19], v[18:19], v[70:71]
    v_pk_add_f32 v[20:21], v[20:21], v[72:73]
    v_pk_add_f32 v[22:23], v[22:23], v[74:75]
    v_pk_add_f32 v[24:25], v[24:25], v[76:77]
    v_pk_add_f32 v[26:27], v[26:27], v[78:79]
    v_pk_add_f32 v[28:29], v[28:29], v[80:81]
    v_pk_add_f32 v[30:31], v[30:31], v[82:83]
    s_waitcnt lgkmcnt(2)
    v_pk_add_f32 v[16:17], v[16:17], v[84:85]
    v_pk_add_f32 v[18:19], v[18:19], v[86:87]
    v_pk_add_f32 v[20:21], v[20:21], v[88:89]
    v_pk_add_f32 v[22:23], v[22:23], v[90:91]
    v_cvt_pk_bf16_f32 v100, v16, v17
    v_cvt_pk_bf16_f32 v101, v18, v19
    v_cvt_pk_bf16_f32 v102, v20, v21
    v_cvt_pk_bf16_f32 v103, v22, v23
    s_nop 0
    v_permlane16_swap_b32 v100, v102
    v_permlane16_swap_b32 v101, v103
    buffer_store_dwordx4 v[100:103], v50, s[4:7], s34 offen sc1
    s_waitcnt lgkmcnt(0)
    v_pk_add_f32 v[24:25], v[24:25], v[92:93]
    v_pk_add_f32 v[26:27], v[26:27], v[94:95]
    v_pk_add_f32 v[28:29], v[28:29], v[96:97]
    v_pk_add_f32 v[30:31], v[30:31], v[98:99]
    v_cvt_pk_bf16_f32 v104, v24, v25
    v_cvt_pk_bf16_f32 v105, v26, v27
    v_cvt_pk_bf16_f32 v106, v28, v29
    v_cvt_pk_bf16_f32 v107, v30, v31
    s_nop 0
    v_permlane16_swap_b32 v104, v106
    v_permlane16_swap_b32 v105, v107
    buffer_store_dwordx4 v[104:107], v50, s[4:7], s43 offen sc1
    s_branch L_c0e
L_c0h1:
L_wk0_1:
    s_cbranch_execz L_wk0_ret
    v_mfma_f32_16x16x32_bf16 v[16:19], v[124:127], v[156:159], v[16:19]
    ds_read_b64 v[60:61], v8 offset:0
    v_mfma_f32_16x16x32_bf16 v[20:23], v[124:127], v[160:163], v[20:23]
    ds_read_b64 v[62:63], v8 offset:512
    v_mfma_f32_16x16x32_bf16 v[24:27], v[124:127], v[164:167], v[24:27]
    ds_read_b64 v[64:65], v8 offset:1024
    v_mfma_f32_16x16x32_bf16 v[28:31], v[124:127], v[168:171], v[28:31]
    ds_read_b64 v[66:67], v8 offset:1536
    v_mfma_f32_16x16x32_bf16 v[20:23], v[128:131], v[156:159], v[20:23]
    v_mfma_f32_16x16x32_bf16 v[24:27], v[128:131], v[160:163], v[24:27]
    v_mfma_f32_16x16x32_bf16 v[28:31], v[128:131], v[164:167], v[28:31]
    v_mfma_f32_16x16x32_bf16 v[24:27], v[132:135], v[156:159], v[24:27]
    s_waitcnt lgkmcnt(0)
    v_mfma_f32_16x16x32_bf16 v[28:31], v[132:135], v[160:163], v[28:31]
    v_lshlrev_b32 v68, 16, v60
    ds_write_b128 v48, v[16:19] offset:0
    v_mfma_f32_16x16x32_bf16 v[28:31], v[136:139], v[156:159], v[28:31]
    v_and_b32 v69, 0xffff0000, v60
    v_mfma_f32_16x16x32_bf16 v[32:35], v[124:127], v[172:175], v[32:35]
    v_lshlrev_b32 v70, 16, v61
    v_mfma_f32_16x16x32_bf16 v[36:39], v[124:127], v[176:179], v[36:39]
    v_and_b32 v71, 0xffff0000, v61
    v_mfma_f32_16x16x32_bf16 v[40:43], v[124:127], v[180:183], v[40:43]
    v_lshlrev_b32 v72, 16, v62
    ds_write_b128 v48, v[20:23] offset:1024
    v_mfma_f32_16x16x32_bf16 v[44:47], v[124:127], v[184:187], v[44:47]
    v_and_b32 v73, 0xffff0000, v62
    v_mfma_f32_16x16x32_bf16 v[32:35], v[128:131], v[168:171], v[32:35]
    v_lshlrev_b32 v74, 16, v63
    v_mfma_f32_16x16x32_bf16 v[36:39], v[128:131], v[172:175], v[36:39]
    v_and_b32 v75, 0xffff0000, v63
    ds_write_b128 v48, v[24:27] offset:2048
    v_mfma_f32_16x16x32_bf16 v[40:43], v[128:131], v[176:179], v[40:43]
    v_lshlrev_b32 v76, 16, v64
    v_mfma_f32_16x16x32_bf16 v[44:47], v[128:131], v[180:183], v[44:47]
    v_and_b32 v77, 0xffff0000, v64
    ds_write_b128 v48, v[28:31] offset:3072
    v_mfma_f32_16x16x32_bf16 v[32:35], v[132:135], v[164:167], v[32:35]
    v_lshlrev_b32 v78, 16, v65
    v_mfma_f32_16x16x32_bf16 v[36:39], v[132:135], v[168:171], v[36:39]
    v_and_b32 v79, 0xffff0000, v65
    v_mfma_f32_16x16x32_bf16 v[40:43], v[132:135], v[172:175], v[40:43]
    v_lshlrev_b32 v80, 16, v66
    v_mfma_f32_16x16x32_bf16 v[44:47], v[132:135], v[176:179], v[44:47]
    v_and_b32 v81, 0xffff0000, v66
    v_mfma_f32_16x16x32_bf16 v[32:35], v[136:139], v[160:163], v[32:35]
    v_lshlrev_b32 v82, 16, v67
    v_mfma_f32_16x16x32_bf16 v[36:39], v[136:139], v[164:167], v[36:39]
    v_and_b32 v83, 0xffff0000, v67
    v_mfma_f32_16x16x32_bf16 v[40:43], v[136:139], v[168:171], v[40:43]
    v_mfma_f32_16x16x32_bf16 v[44:47], v[136:139], v[172:175], v[44:47]
    v_mfma_f32_16x16x32_bf16 v[32:35], v[140:143], v[156:159], v[32:35]
    v_mfma_f32_16x16x32_bf16 v[36:39], v[140:143], v[160:163], v[36:39]
    v_mfma_f32_16x16x32_bf16 v[40:43], v[140:143], v[164:167], v[40:43]
    v_mfma_f32_16x16x32_bf16 v[44:47], v[140:143], v[168:171], v[44:47]
    v_mfma_f32_16x16x32_bf16 v[36:39], v[144:147], v[156:159], v[36:39]
    v_mfma_f32_16x16x32_bf16 v[40:43], v[144:147], v[160:163], v[40:43]
    v_mfma_f32_16x16x32_bf16 v[44:47], v[144:147], v[164:167], v[44:47]
    v_mfma_f32_16x16x32_bf16 v[40:43], v[148:151], v[156:159], v[40:43]
    v_mfma_f32_16x16x32_bf16 v[44:47], v[148:151], v[160:163], v[44:47]
    v_mfma_f32_16x16x32_bf16 v[44:47], v[152:155], v[156:159], v[44:47]
    s_waitcnt lgkmcnt(0)
    s_barrier
    ds_read_b128 v[84:87], v49 offset:0
    ds_read_b128 v[88:91], v49 offset:1024
    ds_read_b128 v[92:95], v49 offset:2048
    ds_read_b128 v[96:99], v49 offset:3072
    v_pk_add_f32 v[32:33], v[32:33], v[68:69]
    v_pk_add_f32 v[34:35], v[34:35], v[70:71]
    v_pk_add_f32 v[36:37], v[36:37], v[72:73]
    v_pk_add_f32 v[38:39], v[38:39], v[74:75]
    v_pk_add_f32 v[40:41], v[40:41], v[76:77]
    v_pk_add_f32 v[42:43], v[42:43], v[78:79]
    v_pk_add_f32 v[44:45], v[44:45], v[80:81]
    v_pk_add_f32 v[46:47], v[46:47], v[82:83]
    s_waitcnt lgkmcnt(2)
    v_pk_add_f32 v[32:33], v[32:33], v[84:85]
    v_pk_add_f32 v[34:35], v[34:35], v[86:87]
    v_pk_add_f32 v[36:37], v[36:37], v[88:89]
    v_pk_add_f32 v[38:39], v[38:39], v[90:91]
    v_cvt_pk_bf16_f32 v100, v32, v33
    v_cvt_pk_bf16_f32 v101, v34, v35
    v_cvt_pk_bf16_f32 v102, v36, v37
    v_cvt_pk_bf16_f32 v103, v38, v39
    s_nop 0
    v_permlane16_swap_b32 v100, v102
    v_permlane16_swap_b32 v101, v103
    buffer_store_dwordx4 v[100:103], v50, s[4:7], s34 offen sc1
    s_waitcnt lgkmcnt(0)
    v_pk_add_f32 v[40:41], v[40:41], v[92:93]
    v_pk_add_f32 v[42:43], v[42:43], v[94:95]
    v_pk_add_f32 v[44:45], v[44:45], v[96:97]
    v_pk_add_f32 v[46:47], v[46:47], v[98:99]
    v_cvt_pk_bf16_f32 v104, v40, v41
    v_cvt_pk_bf16_f32 v105, v42, v43
    v_cvt_pk_bf16_f32 v106, v44, v45
    v_cvt_pk_bf16_f32 v107, v46, v47
    s_nop 0
    v_permlane16_swap_b32 v104, v106
    v_permlane16_swap_b32 v105, v107
    buffer_store_dwordx4 v[104:107], v50, s[4:7], s43 offen sc1
L_c0e:
    s_waitcnt vmcnt(0) lgkmcnt(0)
    s_barrier
    s_cmp_eq_u32 s24, 1
    s_cbranch_scc0 L_bs1
    v_mov_b32 v188, 3
    v_mov_b32 v189, 0
    s_mov_b64 exec, 1
    buffer_store_byte v188, v189, s[4:7], s38 offen
    s_mov_b64 exec, -1
L_bs1:
    s_cmp_eq_u32 s24, 1
    s_cbranch_scc0 L_wk1_skip
    s_mov_b64 exec, 0
    s_branch L_wk1_0
L_wk1_ret:
    s_mov_b64 exec, -1
L_wk1_skip:
    s_cmp_eq_u32 s33, 1
    s_cbranch_scc0 L_bl1
    v_lshlrev_b32 v188, 1, v191
    v_lshlrev_b32 v189, 2, v1
    s_mov_b32 s23, 0
L_blp1:
    buffer_load_dword v2, v189, s[4:7], s39 offen sc1
    s_add_u32 s23, s23, 1
    s_cmp_gt_u32 s23, 400000
    s_cbranch_scc1 L_blq1
    s_waitcnt vmcnt(0)
    v_and_b32 v2, v2, v188
    v_cmp_ne_u32 vcc, v2, v188
    s_nop 4
    s_cbranch_vccnz L_blp1
L_blq1:
    s_waitcnt vmcnt(0)
    v_mov_b32 v188, 2
    v_mul_u32_u24 v189, 2048, v1
    s_mov_b64 exec, s[36:37]
    buffer_store_dword v188, v189, s[4:7], s40 offen sc1
    s_mov_b64 exec, -1
L_bl1:
    s_and_b32 s20, s24, 1
    s_lshr_b32 s21, s24, 1
    s_mul_i32 s27, s20, 45056
    s_add_u32 s27, s27, 67584
    v_lshl_add_u32 v5, v1, 4, s27
    ds_read_b128 a[16:19], v5 offset:0
    ds_read_b128 a[20:23], v5 offset:1024
    ds_read_b128 a[24:27], v5 offset:2048
    ds_read_b128 a[28:31], v5 offset:3072
    ds_read_b128 a[32:35], v5 offset:4096
    ds_read_b128 a[36:39], v5 offset:5120
    ds_read_b128 a[40:43], v5 offset:6144
    ds_read_b128 a[44:47], v5 offset:7168
    ds_read_b128 a[48:51], v5 offset:8192
    ds_read_b128 a[52:55], v5 offset:9216
    ds_read_b128 a[56:59], v5 offset:10240
    ds_read_b128 a[60:63], v5 offset:11264
    ds_read_b128 a[64:67], v5 offset:12288
    ds_read_b128 a[68:71], v5 offset:13312
    ds_read_b128 a[72:75], v5 offset:14336
    ds_read_b128 a[76:79], v5 offset:15360
    ds_read_b128 a[80:83], v5 offset:16384
    ds_read_b128 a[84:87], v5 offset:17408
    ds_read_b128 a[88:91], v5 offset:18432
    ds_read_b128 a[92:95], v5 offset:19456
    ds_read_b128 a[96:99], v5 offset:20480
    ds_read_b128 a[100:103], v5 offset:21504
    ds_read_b128 a[104:107], v5 offset:22528
    ds_read_b128 a[108:111], v5 offset:23552
    ds_read_b128 a[112:115], v5 offset:24576
    ds_read_b128 a[116:119], v5 offset:25600
    ds_read_b128 a[120:123], v5 offset:26624
    ds_read_b128 a[124:127], v5 offset:27648
    ds_read_b128 a[128:131], v5 offset:28672
    ds_read_b128 a[132:135], v5 offset:29696
    ds_read_b128 a[136:139], v5 offset:30720
    ds_read_b128 a[140:143], v5 offset:31744
    ds_read_b128 a[144:147], v5 offset:32768
    ds_read_b128 a[148:151], v5 offset:33792
    ds_read_b128 a[152:155], v5 offset:34816
    ds_read_b128 a[156:159], v5 offset:35840
    ds_read_b128 a[160:163], v5 offset:36864
    ds_read_b128 a[164:167], v5 offset:37888
    ds_read_b128 a[168:171], v5 offset:38912
    ds_read_b128 a[172:175], v5 offset:39936
    ds_read_b128 a[176:179], v5 offset:40960
    ds_read_b128 a[180:183], v5 offset:41984
    ds_read_b128 a[184:187], v5 offset:43008
    ds_read_b128 a[188:191], v5 offset:44032
    s_waitcnt lgkmcnt(0)
    s_cmp_eq_u32 s21, 1
    s_cbranch_scc0 L_cs
    v_mov_b32 v12, 0x3f803f80
    v_mov_b32 v13, 0x3f803f80
    v_mov_b32 v14, 0x3f803f80
    v_mov_b32 v15, 0x3f803f80
    s_nop 1
    v_mfma_f32_16x16x32_bf16 v[16:19], a[0:3], v[12:15], 0
    v_mfma_f32_16x16x32_bf16 v[20:23], a[4:7], v[12:15], 0
    v_mfma_f32_16x16x32_bf16 v[24:27], a[8:11], v[12:15], 0
    v_mfma_f32_16x16x32_bf16 v[16:19], a[12:15], v[12:15], v[16:19]
    v_mfma_f32_16x16x32_bf16 v[20:23], a[16:19], v[12:15], v[20:23]
    v_mfma_f32_16x16x32_bf16 v[24:27], a[20:23], v[12:15], v[24:27]
    v_mfma_f32_16x16x32_bf16 v[16:19], a[24:27], v[12:15], v[16:19]
    v_mfma_f32_16x16x32_bf16 v[20:23], a[28:31], v[12:15], v[20:23]
    v_mfma_f32_16x16x32_bf16 v[24:27], a[32:35], v[12:15], v[24:27]
    v_mfma_f32_16x16x32_bf16 v[16:19], a[36:39], v[12:15], v[16:19]
    v_mfma_f32_16x16x32_bf16 v[20:23], a[40:43], v[12:15], v[20:23]
    v_mfma_f32_16x16x32_bf16 v[24:27], a[44:47], v[12:15], v[24:27]
    v_mfma_f32_16x16x32_bf16 v[16:19], a[48:51], v[12:15], v[16:19]
    v_mfma_f32_16x16x32_bf16 v[20:23], a[52:55], v[12:15], v[20:23]
    v_mfma_f32_16x16x32_bf16 v[24:27], a[56:59], v[12:15], v[24:27]
    v_mfma_f32_16x16x32_bf16 v[16:19], a[60:63], v[12:15], v[16:19]
    v_mfma_f32_16x16x32_bf16 v[20:23], a[64:67], v[12:15], v[20:23]
    v_mfma_f32_16x16x32_bf16 v[24:27], a[68:71], v[12:15], v[24:27]
    v_mfma_f32_16x16x32_bf16 v[16:19], a[72:75], v[12:15], v[16:19]
    v_mfma_f32_16x16x32_bf16 v[20:23], a[76:79], v[12:15], v[20:23]
    v_mfma_f32_16x16x32_bf16 v[24:27], a[80:83], v[12:15], v[24:27]
    v_mfma_f32_16x16x32_bf16 v[16:19], a[84:87], v[12:15], v[16:19]
    v_mfma_f32_16x16x32_bf16 v[20:23], a[88:91], v[12:15], v[20:23]
    v_mfma_f32_16x16x32_bf16 v[24:27], a[92:95], v[12:15], v[24:27]
    v_mfma_f32_16x16x32_bf16 v[16:19], a[96:99], v[12:15], v[16:19]
    v_mfma_f32_16x16x32_bf16 v[20:23], a[100:103], v[12:15], v[20:23]
    v_mfma_f32_16x16x32_bf16 v[24:27], a[104:107], v[12:15], v[24:27]
    v_mfma_f32_16x16x32_bf16 v[16:19], a[108:111], v[12:15], v[16:19]
    v_mfma_f32_16x16x32_bf16 v[20:23], a[112:115], v[12:15], v[20:23]
    v_mfma_f32_16x16x32_bf16 v[24:27], a[116:119], v[12:15], v[24:27]
    v_mfma_f32_16x16x32_bf16 v[16:19], a[120:123], v[12:15], v[16:19]
    v_mfma_f32_16x16x32_bf16 v[20:23], a[124:127], v[12:15], v[20:23]
    v_mfma_f32_16x16x32_bf16 v[24:27], a[128:131], v[12:15], v[24:27]
    v_mfma_f32_16x16x32_bf16 v[16:19], a[132:135], v[12:15], v[16:19]
    v_mfma_f32_16x16x32_bf16 v[20:23], a[136:139], v[12:15], v[20:23]
    v_mfma_f32_16x16x32_bf16 v[24:27], a[140:143], v[12:15], v[24:27]
    v_mfma_f32_16x16x32_bf16 v[16:19], a[144:147], v[12:15], v[16:19]
    v_mfma_f32_16x16x32_bf16 v[20:23], a[148:151], v[12:15], v[20:23]
    v_mfma_f32_16x16x32_bf16 v[24:27], a[152:155], v[12:15], v[24:27]
    v_mfma_f32_16x16x32_bf16 v[16:19], a[156:159], v[12:15], v[16:19]
    v_mfma_f32_16x16x32_bf16 v[20:23], a[160:163], v[12:15], v[20:23]
    v_mfma_f32_16x16x32_bf16 v[24:27], a[164:167], v[12:15], v[24:27]
    v_mfma_f32_16x16x32_bf16 v[16:19], a[168:171], v[12:15], v[16:19]
    v_mfma_f32_16x16x32_bf16 v[20:23], a[172:175], v[12:15], v[20:23]
    v_mfma_f32_16x16x32_bf16 v[24:27], a[176:179], v[12:15], v[24:27]
    v_mfma_f32_16x16x32_bf16 v[16:19], a[180:183], v[12:15], v[16:19]
    v_mfma_f32_16x16x32_bf16 v[20:23], a[184:187], v[12:15], v[20:23]
    v_mfma_f32_16x16x32_bf16 v[24:27], a[188:191], v[12:15], v[24:27]
    s_mul_i32 s27, s20, 192
    s_add_u32 s27, s27, 33280
    v_lshl_add_u32 v5, v4, 4, s27
    s_nop 2
    ds_write_b128 v5, v[16:19] offset:0
    ds_write_b128 v5, v[20:23] offset:64
    ds_write_b128 v5, v[24:27] offset:128
L_cs:
    s_bfe_u32 s35, s2, 0x20003
    s_lshl_b32 s35, s35, 2
    s_add_u32 s35, s35, s24
    s_lshl_b32 s35, s35, 15
    s_add_u32 s35, s35, 12189696
    s_and_b32 s25, s2, 7
    s_lshl_b32 s25, s25, 1
    s_bfe_u32 s26, s2, 0x10003
    s_add_u32 s25, s25, s26
    s_lshr_b32 s26, s2, 4
    v_lshrrev_b32 v5, 1, v3
    v_xor_b32 v5, v5, v4
    v_lshlrev_b32 v5, 5, v5
    v_lshl_add_u32 v5, v4, 8, v5
    v_and_b32 v6, 1, v0
    v_lshl_add_u32 v5, v6, 4, v5
    v_xor_b32 v6, 0x80, v5
    s_lshl_b32 s28, s24, 12
    s_lshl_b32 s27, s25, 17
    s_add_u32 s28, s28, s27
    s_add_u32 s28, s28, 4325376
    s_lshl_b32 s34, s24, 12
    s_add_u32 s34, s34, 33792
    v_lshlrev_b32 v7, 4, v1
    v_lshrrev_b32 v8, 2, v1
    v_and_b32 v9, 7, v8
    s_lshl_b32 s27, s24, 1
    v_xor_b32 v9, s27, v9
    v_lshlrev_b32 v9, 5, v9
    v_lshl_add_u32 v8, v8, 8, v9
    v_and_b32 v9, 3, v0
    v_lshl_add_u32 v8, v9, 3, v8
    v_add_u32 v8, 33792, v8
    v_xor_b32 v9, 32, v8
    v_xor_b32 v10, 64, v8
    v_xor_b32 v11, 96, v8
    v_add_u32 v12, 49152, v8
    v_add_u32 v13, 49152, v9
    v_add_u32 v14, 49152, v10
    v_add_u32 v15, 49152, v11
    s_lshl_b32 s27, s24, 7
    s_add_u32 s27, s27, 160768
    v_lshl_add_u32 v184, v3, 2, s27
    s_lshl_b32 s27, s20, 5
    v_xor_b32 v185, s27, v1
    s_lshl_b32 s27, s21, 6
    v_add_u32 v185, s27, v185
    v_lshlrev_b32 v186, 2, v185
    v_add_u32 v186, 160768, v186
    s_mul_i32 s27, s20, 192
    s_add_u32 s27, s27, 33280
    v_mov_b32 v187, s27
    s_mov_b32 s56, 0xcccccccc
    s_mov_b32 s57, s56
    s_mov_b32 s58, 0xaaaaaaaa
    s_mov_b32 s59, s58
    s_cmp_eq_u32 s24, 0
    s_cbranch_scc0 L_bw1
    v_mul_u32_u24 v189, 256, v1
    s_mov_b32 s23, 0
    s_mov_b64 exec, s[36:37]
L_bwp1:
    buffer_load_dword v2, v189, s[4:7], s41 offen sc1
    s_add_u32 s23, s23, 1
    s_cmp_gt_u32 s23, 400000
    s_cbranch_scc1 L_bwq1
    s_waitcnt vmcnt(0)
    v_cmp_gt_u32 vcc, 2, v2
    s_nop 4
    s_and_b64 exec, exec, vcc
    s_cbranch_execnz L_bwp1
L_bwq1:
    s_waitcnt vmcnt(0)
    s_mov_b64 exec, -1
L_bw1:
    s_waitcnt lgkmcnt(0)
    s_barrier
    s_add_u32 m0, s34, 0
    s_nop 0
    buffer_load_dwordx4 v5, s[4:7], s28 offen offset:0 sc1 lds
    buffer_load_dwordx4 v6, s[4:7], s28 offen offset:1024 sc1 lds
    buffer_load_dwordx4 v5, s[4:7], s28 offen offset:2048 sc1 lds
    buffer_load_dwordx4 v6, s[4:7], s28 offen offset:3072 sc1 lds
    s_add_u32 s28, s28, 16384
    s_add_u32 m0, s34, 16384
    s_nop 0
    buffer_load_dwordx4 v5, s[4:7], s28 offen offset:0 sc1 lds
    buffer_load_dwordx4 v6, s[4:7], s28 offen offset:1024 sc1 lds
    buffer_load_dwordx4 v5, s[4:7], s28 offen offset:2048 sc1 lds
    buffer_load_dwordx4 v6, s[4:7], s28 offen offset:3072 sc1 lds
    s_add_u32 s28, s28, 16384
    s_add_u32 m0, s34, 32768
    s_nop 0
    buffer_load_dwordx4 v5, s[4:7], s28 offen offset:0 sc1 lds
    buffer_load_dwordx4 v6, s[4:7], s28 offen offset:1024 sc1 lds
    buffer_load_dwordx4 v5, s[4:7], s28 offen offset:2048 sc1 lds
    buffer_load_dwordx4 v6, s[4:7], s28 offen offset:3072 sc1 lds
    s_add_u32 s28, s28, 16384
    s_waitcnt vmcnt(8)
    s_barrier
    ds_read_b64_tr_b16 v[72:73], v8 offset:0
    ds_read_b64_tr_b16 v[74:75], v8 offset:4096
L_wk1_0:
    s_cbranch_execz L_wk1_1
    ds_read_b64_tr_b16 v[76:77], v9 offset:0
    ds_read_b64_tr_b16 v[78:79], v9 offset:4096
    ds_read_b64_tr_b16 v[80:81], v10 offset:0
    ds_read_b64_tr_b16 v[82:83], v10 offset:4096
    ds_read_b64_tr_b16 v[84:85], v11 offset:0
    ds_read_b64_tr_b16 v[86:87], v11 offset:4096
    s_waitcnt lgkmcnt(6)
    v_mfma_f32_16x16x32_bf16 v[64:67], v[72:75], v[72:75], 0
    ds_read_b64_tr_b16 v[88:89], v8 offset:8192
    v_mfma_f32_16x16x32_bf16 v[16:19], a[0:3], v[72:75], 0
    ds_read_b64_tr_b16 v[90:91], v8 offset:12288
    v_mfma_f32_16x16x32_bf16 v[32:35], a[4:7], v[72:75], 0
    ds_read_b64_tr_b16 v[92:93], v9 offset:8192
    s_add_u32 m0, s34, 49152
    s_nop 0
    buffer_load_dwordx4 v5, s[4:7], s28 offen offset:0 sc1 lds
    v_mfma_f32_16x16x32_bf16 v[48:51], a[8:11], v[72:75], 0
    ds_read_b64_tr_b16 v[94:95], v9 offset:12288
    s_waitcnt lgkmcnt(8)
    v_mfma_f32_16x16x32_bf16 v[68:71], v[76:79], v[76:79], 0
    ds_read_b64_tr_b16 v[96:97], v10 offset:8192
    v_mfma_f32_16x16x32_bf16 v[20:23], a[0:3], v[76:79], 0
    ds_read_b64_tr_b16 v[98:99], v10 offset:12288
    buffer_load_dwordx4 v6, s[4:7], s28 offen offset:1024 sc1 lds
    v_mfma_f32_16x16x32_bf16 v[36:39], a[4:7], v[76:79], 0
    ds_read_b64_tr_b16 v[100:101], v11 offset:8192
    v_mfma_f32_16x16x32_bf16 v[52:55], a[8:11], v[76:79], 0
    ds_read_b64_tr_b16 v[102:103], v11 offset:12288
    s_waitcnt lgkmcnt(10)
    v_mfma_f32_16x16x32_bf16 v[24:27], a[0:3], v[80:83], 0
    buffer_load_dwordx4 v5, s[4:7], s28 offen offset:2048 sc1 lds
    v_mfma_f32_16x16x32_bf16 v[40:43], a[4:7], v[80:83], 0
    v_mfma_f32_16x16x32_bf16 v[56:59], a[8:11], v[80:83], 0
    s_waitcnt lgkmcnt(8)
    v_mfma_f32_16x16x32_bf16 v[28:31], a[0:3], v[84:87], 0
    buffer_load_dwordx4 v6, s[4:7], s28 offen offset:3072 sc1 lds
    s_add_u32 s28, s28, 16384
    v_mfma_f32_16x16x32_bf16 v[44:47], a[4:7], v[84:87], 0
    v_mfma_f32_16x16x32_bf16 v[60:63], a[8:11], v[84:87], 0
    s_waitcnt lgkmcnt(0)
    v_mfma_f32_16x16x32_bf16 v[64:67], v[88:91], v[88:91], v[64:67]
    v_mfma_f32_16x16x32_bf16 v[16:19], a[12:15], v[88:91], v[16:19]
    s_waitcnt vmcnt(8)
    s_barrier
    ds_read_b64_tr_b16 v[72:73], v8 offset:16384
    v_mfma_f32_16x16x32_bf16 v[32:35], a[16:19], v[88:91], v[32:35]
    ds_read_b64_tr_b16 v[74:75], v8 offset:20480
    v_mfma_f32_16x16x32_bf16 v[48:51], a[20:23], v[88:91], v[48:51]
    ds_read_b64_tr_b16 v[76:77], v9 offset:16384
    v_mfma_f32_16x16x32_bf16 v[68:71], v[92:95], v[92:95], v[68:71]
    ds_read_b64_tr_b16 v[78:79], v9 offset:20480
    v_mfma_f32_16x16x32_bf16 v[20:23], a[12:15], v[92:95], v[20:23]
    ds_read_b64_tr_b16 v[80:81], v10 offset:16384
    v_mfma_f32_16x16x32_bf16 v[36:39], a[16:19], v[92:95], v[36:39]
    ds_read_b64_tr_b16 v[82:83], v10 offset:20480
    v_mfma_f32_16x16x32_bf16 v[52:55], a[20:23], v[92:95], v[52:55]
    ds_read_b64_tr_b16 v[84:85], v11 offset:16384
    v_mfma_f32_16x16x32_bf16 v[24:27], a[12:15], v[96:99], v[24:27]
    ds_read_b64_tr_b16 v[86:87], v11 offset:20480
    v_mfma_f32_16x16x32_bf16 v[40:43], a[16:19], v[96:99], v[40:43]
    v_mfma_f32_16x16x32_bf16 v[56:59], a[20:23], v[96:99], v[56:59]
    v_mfma_f32_16x16x32_bf16 v[28:31], a[12:15], v[100:103], v[28:31]
    v_mfma_f32_16x16x32_bf16 v[44:47], a[16:19], v[100:103], v[44:47]
    v_mfma_f32_16x16x32_bf16 v[60:63], a[20:23], v[100:103], v[60:63]
    s_waitcnt lgkmcnt(0)
    v_mfma_f32_16x16x32_bf16 v[64:67], v[72:75], v[72:75], v[64:67]
    ds_read_b64_tr_b16 v[88:89], v8 offset:24576
    v_mfma_f32_16x16x32_bf16 v[16:19], a[24:27], v[72:75], v[16:19]
    ds_read_b64_tr_b16 v[90:91], v8 offset:28672
    v_mfma_f32_16x16x32_bf16 v[32:35], a[28:31], v[72:75], v[32:35]
    ds_read_b64_tr_b16 v[92:93], v9 offset:24576
    s_add_u32 m0, s34, 65536
    s_nop 0
    buffer_load_dwordx4 v5, s[4:7], s28 offen offset:0 sc1 lds
    v_mfma_f32_16x16x32_bf16 v[48:51], a[32:35], v[72:75], v[48:51]
    ds_read_b64_tr_b16 v[94:95], v9 offset:28672
    v_mfma_f32_16x16x32_bf16 v[68:71], v[76:79], v[76:79], v[68:71]
    ds_read_b64_tr_b16 v[96:97], v10 offset:24576
    v_mfma_f32_16x16x32_bf16 v[20:23], a[24:27], v[76:79], v[20:23]
    ds_read_b64_tr_b16 v[98:99], v10 offset:28672
    buffer_load_dwordx4 v6, s[4:7], s28 offen offset:1024 sc1 lds
    v_mfma_f32_16x16x32_bf16 v[36:39], a[28:31], v[76:79], v[36:39]
    ds_read_b64_tr_b16 v[100:101], v11 offset:24576
    v_mfma_f32_16x16x32_bf16 v[52:55], a[32:35], v[76:79], v[52:55]
    ds_read_b64_tr_b16 v[102:103], v11 offset:28672
    v_mfma_f32_16x16x32_bf16 v[24:27], a[24:27], v[80:83], v[24:27]
    buffer_load_dwordx4 v5, s[4:7], s28 offen offset:2048 sc1 lds
    v_mfma_f32_16x16x32_bf16 v[40:43], a[28:31], v[80:83], v[40:43]
    v_mfma_f32_16x16x32_bf16 v[56:59], a[32:35], v[80:83], v[56:59]
    v_mfma_f32_16x16x32_bf16 v[28:31], a[24:27], v[84:87], v[28:31]
    buffer_load_dwordx4 v6, s[4:7], s28 offen offset:3072 sc1 lds
    s_add_u32 s28, s28, 16384
    v_mfma_f32_16x16x32_bf16 v[44:47], a[28:31], v[84:87], v[44:47]
    v_mfma_f32_16x16x32_bf16 v[60:63], a[32:35], v[84:87], v[60:63]
    s_waitcnt lgkmcnt(0)
    v_mfma_f32_16x16x32_bf16 v[64:67], v[88:91], v[88:91], v[64:67]
    v_mfma_f32_16x16x32_bf16 v[16:19], a[36:39], v[88:91], v[16:19]
    s_waitcnt vmcnt(8)
    s_barrier
    ds_read_b64_tr_b16 v[72:73], v8 offset:32768
    v_mfma_f32_16x16x32_bf16 v[32:35], a[40:43], v[88:91], v[32:35]
    ds_read_b64_tr_b16 v[74:75], v8 offset:36864
    v_mfma_f32_16x16x32_bf16 v[48:51], a[44:47], v[88:91], v[48:51]
    ds_read_b64_tr_b16 v[76:77], v9 offset:32768
    v_mfma_f32_16x16x32_bf16 v[68:71], v[92:95], v[92:95], v[68:71]
    ds_read_b64_tr_b16 v[78:79], v9 offset:36864
    v_mfma_f32_16x16x32_bf16 v[20:23], a[36:39], v[92:95], v[20:23]
    ds_read_b64_tr_b16 v[80:81], v10 offset:32768
    v_mfma_f32_16x16x32_bf16 v[36:39], a[40:43], v[92:95], v[36:39]
    ds_read_b64_tr_b16 v[82:83], v10 offset:36864
    v_mfma_f32_16x16x32_bf16 v[52:55], a[44:47], v[92:95], v[52:55]
    ds_read_b64_tr_b16 v[84:85], v11 offset:32768
    v_mfma_f32_16x16x32_bf16 v[24:27], a[36:39], v[96:99], v[24:27]
    ds_read_b64_tr_b16 v[86:87], v11 offset:36864
    v_mfma_f32_16x16x32_bf16 v[40:43], a[40:43], v[96:99], v[40:43]
    v_mfma_f32_16x16x32_bf16 v[56:59], a[44:47], v[96:99], v[56:59]
    v_mfma_f32_16x16x32_bf16 v[28:31], a[36:39], v[100:103], v[28:31]
    v_mfma_f32_16x16x32_bf16 v[44:47], a[40:43], v[100:103], v[44:47]
    v_mfma_f32_16x16x32_bf16 v[60:63], a[44:47], v[100:103], v[60:63]
    s_waitcnt lgkmcnt(0)
    v_mfma_f32_16x16x32_bf16 v[64:67], v[72:75], v[72:75], v[64:67]
    ds_read_b64_tr_b16 v[88:89], v8 offset:40960
    v_mfma_f32_16x16x32_bf16 v[32:35], a[52:55], v[72:75], v[32:35]
    ds_read_b64_tr_b16 v[90:91], v8 offset:45056
    v_mfma_f32_16x16x32_bf16 v[48:51], a[56:59], v[72:75], v[48:51]
    ds_read_b64_tr_b16 v[92:93], v9 offset:40960
    s_add_u32 m0, s34, 81920
    s_nop 0
    buffer_load_dwordx4 v5, s[4:7], s28 offen offset:0 sc1 lds
    v_mfma_f32_16x16x32_bf16 v[68:71], v[76:79], v[76:79], v[68:71]
    ds_read_b64_tr_b16 v[94:95], v9 offset:45056
    v_mfma_f32_16x16x32_bf16 v[36:39], a[52:55], v[76:79], v[36:39]
    ds_read_b64_tr_b16 v[96:97], v10 offset:40960
    buffer_load_dwordx4 v6, s[4:7], s28 offen offset:1024 sc1 lds
    v_mfma_f32_16x16x32_bf16 v[52:55], a[56:59], v[76:79], v[52:55]
    ds_read_b64_tr_b16 v[98:99], v10 offset:45056
    v_mfma_f32_16x16x32_bf16 v[40:43], a[52:55], v[80:83], v[40:43]
    ds_read_b64_tr_b16 v[100:101], v11 offset:40960
    buffer_load_dwordx4 v5, s[4:7], s28 offen offset:2048 sc1 lds
    v_mfma_f32_16x16x32_bf16 v[56:59], a[56:59], v[80:83], v[56:59]
    ds_read_b64_tr_b16 v[102:103], v11 offset:45056
    v_mfma_f32_16x16x32_bf16 v[44:47], a[52:55], v[84:87], v[44:47]
    buffer_load_dwordx4 v6, s[4:7], s28 offen offset:3072 sc1 lds
    s_add_u32 s28, s28, 16384
    v_mfma_f32_16x16x32_bf16 v[60:63], a[56:59], v[84:87], v[60:63]
    s_waitcnt lgkmcnt(0)
    v_mfma_f32_16x16x32_bf16 v[64:67], v[88:91], v[88:91], v[64:67]
    v_mfma_f32_16x16x32_bf16 v[32:35], a[64:67], v[88:91], v[32:35]
    s_waitcnt vmcnt(8)
    s_barrier
    ds_read_b64_tr_b16 v[72:73], v12 offset:0
    v_mfma_f32_16x16x32_bf16 v[48:51], a[68:71], v[88:91], v[48:51]
    ds_read_b64_tr_b16 v[74:75], v12 offset:4096
    v_mfma_f32_16x16x32_bf16 v[68:71], v[92:95], v[92:95], v[68:71]
    ds_read_b64_tr_b16 v[76:77], v13 offset:0
    v_mfma_f32_16x16x32_bf16 v[36:39], a[64:67], v[92:95], v[36:39]
    ds_read_b64_tr_b16 v[78:79], v13 offset:4096
    v_mfma_f32_16x16x32_bf16 v[52:55], a[68:71], v[92:95], v[52:55]
    ds_read_b64_tr_b16 v[80:81], v14 offset:0
    v_mfma_f32_16x16x32_bf16 v[40:43], a[64:67], v[96:99], v[40:43]
    ds_read_b64_tr_b16 v[82:83], v14 offset:4096
    v_mfma_f32_16x16x32_bf16 v[56:59], a[68:71], v[96:99], v[56:59]
    ds_read_b64_tr_b16 v[84:85], v15 offset:0
    v_mfma_f32_16x16x32_bf16 v[44:47], a[64:67], v[100:103], v[44:47]
    ds_read_b64_tr_b16 v[86:87], v15 offset:4096
    v_mfma_f32_16x16x32_bf16 v[60:63], a[68:71], v[100:103], v[60:63]
    s_waitcnt lgkmcnt(0)
    v_mfma_f32_16x16x32_bf16 v[64:67], v[72:75], v[72:75], v[64:67]
    ds_read_b64_tr_b16 v[88:89], v12 offset:8192
    v_mfma_f32_16x16x32_bf16 v[32:35], a[76:79], v[72:75], v[32:35]
    ds_read_b64_tr_b16 v[90:91], v12 offset:12288
    v_mfma_f32_16x16x32_bf16 v[48:51], a[80:83], v[72:75], v[48:51]
    ds_read_b64_tr_b16 v[92:93], v13 offset:8192
    s_add_u32 m0, s34, 0
    s_nop 0
    buffer_load_dwordx4 v5, s[4:7], s28 offen offset:0 sc1 lds
    v_mfma_f32_16x16x32_bf16 v[68:71], v[76:79], v[76:79], v[68:71]
    ds_read_b64_tr_b16 v[94:95], v13 offset:12288
    v_mfma_f32_16x16x32_bf16 v[36:39], a[76:79], v[76:79], v[36:39]
    ds_read_b64_tr_b16 v[96:97], v14 offset:8192
    buffer_load_dwordx4 v6, s[4:7], s28 offen offset:1024 sc1 lds
    v_mfma_f32_16x16x32_bf16 v[52:55], a[80:83], v[76:79], v[52:55]
    ds_read_b64_tr_b16 v[98:99], v14 offset:12288
    v_mfma_f32_16x16x32_bf16 v[40:43], a[76:79], v[80:83], v[40:43]
    ds_read_b64_tr_b16 v[100:101], v15 offset:8192
    buffer_load_dwordx4 v5, s[4:7], s28 offen offset:2048 sc1 lds
    v_mfma_f32_16x16x32_bf16 v[56:59], a[80:83], v[80:83], v[56:59]
    ds_read_b64_tr_b16 v[102:103], v15 offset:12288
    v_mfma_f32_16x16x32_bf16 v[44:47], a[76:79], v[84:87], v[44:47]
    buffer_load_dwordx4 v6, s[4:7], s28 offen offset:3072 sc1 lds
    s_add_u32 s28, s28, 16384
    v_mfma_f32_16x16x32_bf16 v[60:63], a[80:83], v[84:87], v[60:63]
    s_waitcnt lgkmcnt(0)
    v_mfma_f32_16x16x32_bf16 v[64:67], v[88:91], v[88:91], v[64:67]
    v_mfma_f32_16x16x32_bf16 v[32:35], a[88:91], v[88:91], v[32:35]
    s_waitcnt vmcnt(8)
    s_barrier
    ds_read_b64_tr_b16 v[72:73], v12 offset:16384
    v_mfma_f32_16x16x32_bf16 v[48:51], a[92:95], v[88:91], v[48:51]
    ds_read_b64_tr_b16 v[74:75], v12 offset:20480
    v_mfma_f32_16x16x32_bf16 v[68:71], v[92:95], v[92:95], v[68:71]
    ds_read_b64_tr_b16 v[76:77], v13 offset:16384
    v_mfma_f32_16x16x32_bf16 v[36:39], a[88:91], v[92:95], v[36:39]
    ds_read_b64_tr_b16 v[78:79], v13 offset:20480
    v_mfma_f32_16x16x32_bf16 v[52:55], a[92:95], v[92:95], v[52:55]
    ds_read_b64_tr_b16 v[80:81], v14 offset:16384
    v_mfma_f32_16x16x32_bf16 v[40:43], a[88:91], v[96:99], v[40:43]
    ds_read_b64_tr_b16 v[82:83], v14 offset:20480
    v_mfma_f32_16x16x32_bf16 v[56:59], a[92:95], v[96:99], v[56:59]
    ds_read_b64_tr_b16 v[84:85], v15 offset:16384
    v_mfma_f32_16x16x32_bf16 v[44:47], a[88:91], v[100:103], v[44:47]
    ds_read_b64_tr_b16 v[86:87], v15 offset:20480
    v_mfma_f32_16x16x32_bf16 v[60:63], a[92:95], v[100:103], v[60:63]
    s_waitcnt lgkmcnt(0)
    v_mfma_f32_16x16x32_bf16 v[64:67], v[72:75], v[72:75], v[64:67]
    ds_read_b64_tr_b16 v[88:89], v12 offset:24576
    v_mfma_f32_16x16x32_bf16 v[32:35], a[100:103], v[72:75], v[32:35]
    ds_read_b64_tr_b16 v[90:91], v12 offset:28672
    v_mfma_f32_16x16x32_bf16 v[48:51], a[104:107], v[72:75], v[48:51]
    ds_read_b64_tr_b16 v[92:93], v13 offset:24576
    s_add_u32 m0, s34, 16384
    s_nop 0
    buffer_load_dwordx4 v5, s[4:7], s28 offen offset:0 sc1 lds
    v_mfma_f32_16x16x32_bf16 v[68:71], v[76:79], v[76:79], v[68:71]
    ds_read_b64_tr_b16 v[94:95], v13 offset:28672
    v_mfma_f32_16x16x32_bf16 v[36:39], a[100:103], v[76:79], v[36:39]
    ds_read_b64_tr_b16 v[96:97], v14 offset:24576
    buffer_load_dwordx4 v6, s[4:7], s28 offen offset:1024 sc1 lds
    v_mfma_f32_16x16x32_bf16 v[52:55], a[104:107], v[76:79], v[52:55]
    ds_read_b64_tr_b16 v[98:99], v14 offset:28672
    v_mfma_f32_16x16x32_bf16 v[40:43], a[100:103], v[80:83], v[40:43]
    ds_read_b64_tr_b16 v[100:101], v15 offset:24576
    buffer_load_dwordx4 v5, s[4:7], s28 offen offset:2048 sc1 lds
    v_mfma_f32_16x16x32_bf16 v[56:59], a[104:107], v[80:83], v[56:59]
    ds_read_b64_tr_b16 v[102:103], v15 offset:28672
    v_mfma_f32_16x16x32_bf16 v[44:47], a[100:103], v[84:87], v[44:47]
    buffer_load_dwordx4 v6, s[4:7], s28 offen offset:3072 sc1 lds
    v_mfma_f32_16x16x32_bf16 v[60:63], a[104:107], v[84:87], v[60:63]
    s_waitcnt lgkmcnt(0)
    v_mfma_f32_16x16x32_bf16 v[64:67], v[88:91], v[88:91], v[64:67]
    v_mfma_f32_16x16x32_bf16 v[32:35], a[112:115], v[88:91], v[32:35]
    s_waitcnt vmcnt(8)
    s_barrier
    ds_read_b64_tr_b16 v[72:73], v12 offset:32768
    v_mfma_f32_16x16x32_bf16 v[48:51], a[116:119], v[88:91], v[48:51]
    ds_read_b64_tr_b16 v[74:75], v12 offset:36864
    v_mfma_f32_16x16x32_bf16 v[68:71], v[92:95], v[92:95], v[68:71]
    ds_read_b64_tr_b16 v[76:77], v13 offset:32768
    v_mfma_f32_16x16x32_bf16 v[36:39], a[112:115], v[92:95], v[36:39]
    ds_read_b64_tr_b16 v[78:79], v13 offset:36864
    v_mfma_f32_16x16x32_bf16 v[52:55], a[116:119], v[92:95], v[52:55]
    ds_read_b64_tr_b16 v[80:81], v14 offset:32768
    v_mfma_f32_16x16x32_bf16 v[40:43], a[112:115], v[96:99], v[40:43]
    ds_read_b64_tr_b16 v[82:83], v14 offset:36864
    v_mfma_f32_16x16x32_bf16 v[56:59], a[116:119], v[96:99], v[56:59]
    ds_read_b64_tr_b16 v[84:85], v15 offset:32768
    v_mfma_f32_16x16x32_bf16 v[44:47], a[112:115], v[100:103], v[44:47]
    ds_read_b64_tr_b16 v[86:87], v15 offset:36864
    v_mfma_f32_16x16x32_bf16 v[60:63], a[116:119], v[100:103], v[60:63]
    s_waitcnt lgkmcnt(0)
    v_mfma_f32_16x16x32_bf16 v[64:67], v[72:75], v[72:75], v[64:67]
    ds_read_b64_tr_b16 v[88:89], v12 offset:40960
    v_mfma_f32_16x16x32_bf16 v[32:35], a[124:127], v[72:75], v[32:35]
    ds_read_b64_tr_b16 v[90:91], v12 offset:45056
    v_mfma_f32_16x16x32_bf16 v[48:51], a[128:131], v[72:75], v[48:51]
    ds_read_b64_tr_b16 v[92:93], v13 offset:40960
    v_mfma_f32_16x16x32_bf16 v[68:71], v[76:79], v[76:79], v[68:71]
    ds_read_b64_tr_b16 v[94:95], v13 offset:45056
    v_mfma_f32_16x16x32_bf16 v[36:39], a[124:127], v[76:79], v[36:39]
    ds_read_b64_tr_b16 v[96:97], v14 offset:40960
    buffer_load_dwordx4 a[192:195], v7, s[4:7], s35 offen offset:0
    v_mfma_f32_16x16x32_bf16 v[52:55], a[128:131], v[76:79], v[52:55]
    ds_read_b64_tr_b16 v[98:99], v14 offset:45056
    v_mfma_f32_16x16x32_bf16 v[40:43], a[124:127], v[80:83], v[40:43]
    ds_read_b64_tr_b16 v[100:101], v15 offset:40960
    v_mfma_f32_16x16x32_bf16 v[56:59], a[128:131], v[80:83], v[56:59]
    ds_read_b64_tr_b16 v[102:103], v15 offset:45056
    v_mfma_f32_16x16x32_bf16 v[44:47], a[124:127], v[84:87], v[44:47]
    v_mfma_f32_16x16x32_bf16 v[60:63], a[128:131], v[84:87], v[60:63]
    buffer_load_dwordx4 a[196:199], v7, s[4:7], s35 offen offset:1024
    s_waitcnt lgkmcnt(0)
    v_mfma_f32_16x16x32_bf16 v[64:67], v[88:91], v[88:91], v[64:67]
    v_mfma_f32_16x16x32_bf16 v[32:35], a[136:139], v[88:91], v[32:35]
    s_waitcnt vmcnt(6)
    s_barrier
    ds_read_b64_tr_b16 v[72:73], v8 offset:0
    v_mfma_f32_16x16x32_bf16 v[48:51], a[140:143], v[88:91], v[48:51]
    ds_read_b64_tr_b16 v[74:75], v8 offset:4096
    v_mfma_f32_16x16x32_bf16 v[68:71], v[92:95], v[92:95], v[68:71]
    ds_read_b64_tr_b16 v[76:77], v9 offset:0
    v_mfma_f32_16x16x32_bf16 v[36:39], a[136:139], v[92:95], v[36:39]
    ds_read_b64_tr_b16 v[78:79], v9 offset:4096
    buffer_load_dwordx4 a[200:203], v7, s[4:7], s35 offen offset:2048
    v_mfma_f32_16x16x32_bf16 v[52:55], a[140:143], v[92:95], v[52:55]
    ds_read_b64_tr_b16 v[80:81], v10 offset:0
    v_mfma_f32_16x16x32_bf16 v[40:43], a[136:139], v[96:99], v[40:43]
    ds_read_b64_tr_b16 v[82:83], v10 offset:4096
    v_mfma_f32_16x16x32_bf16 v[56:59], a[140:143], v[96:99], v[56:59]
    ds_read_b64_tr_b16 v[84:85], v11 offset:0
    v_mfma_f32_16x16x32_bf16 v[44:47], a[136:139], v[100:103], v[44:47]
    ds_read_b64_tr_b16 v[86:87], v11 offset:4096
    v_mfma_f32_16x16x32_bf16 v[60:63], a[140:143], v[100:103], v[60:63]
    buffer_load_dwordx4 a[204:207], v7, s[4:7], s35 offen offset:3072
    s_add_u32 s35, s35, 4096
    s_waitcnt lgkmcnt(0)
    v_mfma_f32_16x16x32_bf16 v[64:67], v[72:75], v[72:75], v[64:67]
    ds_read_b64_tr_b16 v[88:89], v8 offset:8192
    v_mfma_f32_16x16x32_bf16 v[32:35], a[148:151], v[72:75], v[32:35]
    ds_read_b64_tr_b16 v[90:91], v8 offset:12288
    v_mfma_f32_16x16x32_bf16 v[48:51], a[152:155], v[72:75], v[48:51]
    ds_read_b64_tr_b16 v[92:93], v9 offset:8192
    v_mfma_f32_16x16x32_bf16 v[68:71], v[76:79], v[76:79], v[68:71]
    ds_read_b64_tr_b16 v[94:95], v9 offset:12288
    v_mfma_f32_16x16x32_bf16 v[36:39], a[148:151], v[76:79], v[36:39]
    ds_read_b64_tr_b16 v[96:97], v10 offset:8192
    buffer_load_dwordx4 a[208:211], v7, s[4:7], s35 offen offset:0
    v_mfma_f32_16x16x32_bf16 v[52:55], a[152:155], v[76:79], v[52:55]
    ds_read_b64_tr_b16 v[98:99], v10 offset:12288
    v_mfma_f32_16x16x32_bf16 v[40:43], a[148:151], v[80:83], v[40:43]
    ds_read_b64_tr_b16 v[100:101], v11 offset:8192
    v_mfma_f32_16x16x32_bf16 v[56:59], a[152:155], v[80:83], v[56:59]
    ds_read_b64_tr_b16 v[102:103], v11 offset:12288
    v_mfma_f32_16x16x32_bf16 v[44:47], a[148:151], v[84:87], v[44:47]
    v_mfma_f32_16x16x32_bf16 v[60:63], a[152:155], v[84:87], v[60:63]
    buffer_load_dwordx4 a[212:215], v7, s[4:7], s35 offen offset:1024
    s_waitcnt lgkmcnt(0)
    v_mfma_f32_16x16x32_bf16 v[64:67], v[88:91], v[88:91], v[64:67]
    v_mfma_f32_16x16x32_bf16 v[32:35], a[160:163], v[88:91], v[32:35]
    s_waitcnt vmcnt(6)
    s_barrier
    ds_read_b64_tr_b16 v[72:73], v8 offset:16384
    v_mfma_f32_16x16x32_bf16 v[48:51], a[164:167], v[88:91], v[48:51]
    ds_read_b64_tr_b16 v[74:75], v8 offset:20480
    v_mfma_f32_16x16x32_bf16 v[68:71], v[92:95], v[92:95], v[68:71]
    ds_read_b64_tr_b16 v[76:77], v9 offset:16384
    v_mfma_f32_16x16x32_bf16 v[36:39], a[160:163], v[92:95], v[36:39]
    ds_read_b64_tr_b16 v[78:79], v9 offset:20480
    buffer_load_dwordx4 a[216:219], v7, s[4:7], s35 offen offset:2048
    v_mfma_f32_16x16x32_bf16 v[52:55], a[164:167], v[92:95], v[52:55]
    ds_read_b64_tr_b16 v[80:81], v10 offset:16384
    v_mfma_f32_16x16x32_bf16 v[40:43], a[160:163], v[96:99], v[40:43]
    ds_read_b64_tr_b16 v[82:83], v10 offset:20480
    v_mfma_f32_16x16x32_bf16 v[56:59], a[164:167], v[96:99], v[56:59]
    ds_read_b64_tr_b16 v[84:85], v11 offset:16384
    v_mfma_f32_16x16x32_bf16 v[44:47], a[160:163], v[100:103], v[44:47]
    ds_read_b64_tr_b16 v[86:87], v11 offset:20480
    v_mfma_f32_16x16x32_bf16 v[60:63], a[164:167], v[100:103], v[60:63]
    buffer_load_dwordx4 a[220:223], v7, s[4:7], s35 offen offset:3072
    s_add_u32 s35, s35, 4096
    s_waitcnt lgkmcnt(0)
    v_mfma_f32_16x16x32_bf16 v[64:67], v[72:75], v[72:75], v[64:67]
    ds_read_b64_tr_b16 v[88:89], v8 offset:24576
    v_mfma_f32_16x16x32_bf16 v[32:35], a[172:175], v[72:75], v[32:35]
    ds_read_b64_tr_b16 v[90:91], v8 offset:28672
    v_mfma_f32_16x16x32_bf16 v[48:51], a[176:179], v[72:75], v[48:51]
    ds_read_b64_tr_b16 v[92:93], v9 offset:24576
    v_mfma_f32_16x16x32_bf16 v[68:71], v[76:79], v[76:79], v[68:71]
    ds_read_b64_tr_b16 v[94:95], v9 offset:28672
    v_mfma_f32_16x16x32_bf16 v[36:39], a[172:175], v[76:79], v[36:39]
    ds_read_b64_tr_b16 v[96:97], v10 offset:24576
    buffer_load_dwordx4 a[224:227], v7, s[4:7], s35 offen offset:0
    v_mfma_f32_16x16x32_bf16 v[52:55], a[176:179], v[76:79], v[52:55]
    ds_read_b64_tr_b16 v[98:99], v10 offset:28672
    v_mfma_f32_16x16x32_bf16 v[40:43], a[172:175], v[80:83], v[40:43]
    ds_read_b64_tr_b16 v[100:101], v11 offset:24576
    v_mfma_f32_16x16x32_bf16 v[56:59], a[176:179], v[80:83], v[56:59]
    ds_read_b64_tr_b16 v[102:103], v11 offset:28672
    v_mfma_f32_16x16x32_bf16 v[44:47], a[172:175], v[84:87], v[44:47]
    v_mfma_f32_16x16x32_bf16 v[60:63], a[176:179], v[84:87], v[60:63]
    buffer_load_dwordx4 a[228:231], v7, s[4:7], s35 offen offset:1024
    s_waitcnt lgkmcnt(0)
    v_mfma_f32_16x16x32_bf16 v[64:67], v[88:91], v[88:91], v[64:67]
    ds_read_b128 v[136:139], v187 offset:64
    v_mfma_f32_16x16x32_bf16 v[32:35], a[184:187], v[88:91], v[32:35]
    ds_read_b128 v[140:143], v187 offset:80
    v_mfma_f32_16x16x32_bf16 v[48:51], a[188:191], v[88:91], v[48:51]
    ds_read_b128 v[144:147], v187 offset:96
    v_mfma_f32_16x16x32_bf16 v[68:71], v[92:95], v[92:95], v[68:71]
    ds_read_b128 v[148:151], v187 offset:112
    v_mfma_f32_16x16x32_bf16 v[36:39], a[184:187], v[92:95], v[36:39]
    ds_read_b128 v[152:155], v187 offset:128
    buffer_load_dwordx4 a[232:235], v7, s[4:7], s35 offen offset:2048
    v_mfma_f32_16x16x32_bf16 v[52:55], a[188:191], v[92:95], v[52:55]
    ds_read_b128 v[156:159], v187 offset:144
    v_mfma_f32_16x16x32_bf16 v[40:43], a[184:187], v[96:99], v[40:43]
    ds_read_b128 v[160:163], v187 offset:160
    v_mfma_f32_16x16x32_bf16 v[56:59], a[188:191], v[96:99], v[56:59]
    ds_read_b128 v[164:167], v187 offset:176
    v_mfma_f32_16x16x32_bf16 v[44:47], a[184:187], v[100:103], v[44:47]
    v_mfma_f32_16x16x32_bf16 v[60:63], a[188:191], v[100:103], v[60:63]
    buffer_load_dwordx4 a[236:239], v7, s[4:7], s35 offen offset:3072
    s_add_u32 s35, s35, 4096
    v_cndmask_b32 v64, v64, v66, s[56:57]
    v_cndmask_b32 v65, v65, v67, s[56:57]
    v_cndmask_b32 v64, v64, v65, s[58:59]
    v_cndmask_b32 v68, v68, v70, s[56:57]
    v_cndmask_b32 v69, v69, v71, s[56:57]
    v_cndmask_b32 v68, v68, v69, s[58:59]
    s_mov_b32 exec_lo, 0x00f0000f
    s_mov_b32 exec_hi, 0xf0000f00
    ds_write_b32 v184, v64
    ds_write_b32 v184, v68 offset:64
    s_mov_b64 exec, -1
    v_permlane32_swap_b32 v32, v40
    v_permlane32_swap_b32 v36, v44
    v_permlane32_swap_b32 v33, v41
    v_permlane32_swap_b32 v37, v45
    v_permlane32_swap_b32 v34, v42
    v_permlane32_swap_b32 v38, v46
    v_permlane32_swap_b32 v35, v43
    v_permlane32_swap_b32 v39, v47
    v_permlane16_swap_b32 v32, v36
    v_permlane16_swap_b32 v40, v44
    v_permlane16_swap_b32 v33, v37
    v_permlane16_swap_b32 v41, v45
    v_permlane16_swap_b32 v34, v38
    v_permlane16_swap_b32 v42, v46
    v_permlane16_swap_b32 v35, v39
    v_permlane16_swap_b32 v43, v47
    buffer_load_dwordx4 a[240:243], v7, s[4:7], s35 offen offset:0
    buffer_load_dwordx4 a[244:247], v7, s[4:7], s35 offen offset:1024
    s_waitcnt lgkmcnt(0)
    s_barrier
    ds_read_b32 v66, v186
    v_mul_f32 v64, 0x3b000000, v32
    v_pk_fma_f32 v[32:33], v[136:137], v[64:65], v[32:33] op_sel_hi:[1,0,1] neg_lo:[0,1,0] neg_hi:[0,1,0]
    v_pk_fma_f32 v[34:35], v[138:139], v[64:65], v[34:35] op_sel_hi:[1,0,1] neg_lo:[0,1,0] neg_hi:[0,1,0]
    v_pk_fma_f32 v[36:37], v[140:141], v[64:65], v[36:37] op_sel_hi:[1,0,1] neg_lo:[0,1,0] neg_hi:[0,1,0]
    v_pk_fma_f32 v[38:39], v[142:143], v[64:65], v[38:39] op_sel_hi:[1,0,1] neg_lo:[0,1,0] neg_hi:[0,1,0]
    v_pk_fma_f32 v[40:41], v[144:145], v[64:65], v[40:41] op_sel_hi:[1,0,1] neg_lo:[0,1,0] neg_hi:[0,1,0]
    v_pk_fma_f32 v[42:43], v[146:147], v[64:65], v[42:43] op_sel_hi:[1,0,1] neg_lo:[0,1,0] neg_hi:[0,1,0]
    v_pk_fma_f32 v[44:45], v[148:149], v[64:65], v[44:45] op_sel_hi:[1,0,1] neg_lo:[0,1,0] neg_hi:[0,1,0]
    v_pk_fma_f32 v[46:47], v[150:151], v[64:65], v[46:47] op_sel_hi:[1,0,1] neg_lo:[0,1,0] neg_hi:[0,1,0]
    v_max3_f32 v68, v32, v33, v34
    v_min3_f32 v70, v32, v33, v34
    v_max3_f32 v68, v68, v35, v36
    v_min3_f32 v70, v70, v35, v36
    v_max3_f32 v68, v68, v37, v38
    v_min3_f32 v70, v70, v37, v38
    v_max3_f32 v68, v68, v39, v40
    v_min3_f32 v70, v70, v39, v40
    v_max3_f32 v68, v68, v41, v42
    v_min3_f32 v70, v70, v41, v42
    v_max3_f32 v68, v68, v43, v44
    v_min3_f32 v70, v70, v43, v44
    v_max3_f32 v68, v68, v45, v46
    v_min3_f32 v70, v70, v45, v46
    v_max_f32 v68, v68, v47
    v_min_f32 v70, v70, v47
    buffer_load_dwordx4 a[248:251], v7, s[4:7], s35 offen offset:2048
    buffer_load_dwordx4 a[252:255], v7, s[4:7], s35 offen offset:3072
    s_add_u32 s35, s35, 4096
    s_waitcnt lgkmcnt(0)
    v_mov_b32 v76, 0x3727c5ac
    v_fmac_f32 v76, 0x3b000000, v66
    v_fma_f32 v66, -v64, v64, v76
    v_max_f32 v66, 0x3727c5ac, v66
    v_rsq_f32 v66, v66
    v_mul_u32_u24 v5, 224, v185
    s_lshl_b32 s27, s20, 6
    s_add_u32 s27, s27, 132096
    v_add_u32 v180, s27, v5
    s_lshl_b32 s27, s20, 5
    s_add_u32 s27, s27, 132224
    v_add_u32 v181, s27, v5
    v_mul_f32 v76, 0x3fb8aa3b, v66
    v_mul_f32 v68, v68, v76
    v_mul_f32 v70, v70, v76
    v_pk_fma_f32 v[80:81], v[32:33], v[76:77], v[68:69] op_sel_hi:[1,0,0] neg_lo:[0,0,1] neg_hi:[0,0,1]
    v_pk_fma_f32 v[96:97], v[32:33], v[76:77], v[70:71] op_sel_hi:[1,0,0] neg_lo:[1,0,0] neg_hi:[1,0,0]
    v_pk_fma_f32 v[82:83], v[34:35], v[76:77], v[68:69] op_sel_hi:[1,0,0] neg_lo:[0,0,1] neg_hi:[0,0,1]
    v_pk_fma_f32 v[98:99], v[34:35], v[76:77], v[70:71] op_sel_hi:[1,0,0] neg_lo:[1,0,0] neg_hi:[1,0,0]
    v_pk_fma_f32 v[84:85], v[36:37], v[76:77], v[68:69] op_sel_hi:[1,0,0] neg_lo:[0,0,1] neg_hi:[0,0,1]
    v_pk_fma_f32 v[100:101], v[36:37], v[76:77], v[70:71] op_sel_hi:[1,0,0] neg_lo:[1,0,0] neg_hi:[1,0,0]
    v_pk_fma_f32 v[86:87], v[38:39], v[76:77], v[68:69] op_sel_hi:[1,0,0] neg_lo:[0,0,1] neg_hi:[0,0,1]
    v_pk_fma_f32 v[102:103], v[38:39], v[76:77], v[70:71] op_sel_hi:[1,0,0] neg_lo:[1,0,0] neg_hi:[1,0,0]
    v_pk_fma_f32 v[88:89], v[40:41], v[76:77], v[68:69] op_sel_hi:[1,0,0] neg_lo:[0,0,1] neg_hi:[0,0,1]
    v_pk_fma_f32 v[104:105], v[40:41], v[76:77], v[70:71] op_sel_hi:[1,0,0] neg_lo:[1,0,0] neg_hi:[1,0,0]
    v_pk_fma_f32 v[90:91], v[42:43], v[76:77], v[68:69] op_sel_hi:[1,0,0] neg_lo:[0,0,1] neg_hi:[0,0,1]
    v_pk_fma_f32 v[106:107], v[42:43], v[76:77], v[70:71] op_sel_hi:[1,0,0] neg_lo:[1,0,0] neg_hi:[1,0,0]
    v_pk_fma_f32 v[92:93], v[44:45], v[76:77], v[68:69] op_sel_hi:[1,0,0] neg_lo:[0,0,1] neg_hi:[0,0,1]
    v_pk_fma_f32 v[108:109], v[44:45], v[76:77], v[70:71] op_sel_hi:[1,0,0] neg_lo:[1,0,0] neg_hi:[1,0,0]
    v_pk_fma_f32 v[94:95], v[46:47], v[76:77], v[68:69] op_sel_hi:[1,0,0] neg_lo:[0,0,1] neg_hi:[0,0,1]
    v_pk_fma_f32 v[110:111], v[46:47], v[76:77], v[70:71] op_sel_hi:[1,0,0] neg_lo:[1,0,0] neg_hi:[1,0,0]
    v_exp_f32 v80, v80
    v_exp_f32 v81, v81
    v_exp_f32 v82, v82
    v_exp_f32 v83, v83
    buffer_load_dwordx4 v[192:195], v7, s[4:7], s35 offen offset:0
    v_exp_f32 v84, v84
    v_exp_f32 v85, v85
    v_exp_f32 v86, v86
    v_exp_f32 v87, v87
    buffer_load_dwordx4 v[196:199], v7, s[4:7], s35 offen offset:1024
    v_exp_f32 v88, v88
    v_exp_f32 v89, v89
    v_exp_f32 v90, v90
    v_exp_f32 v91, v91
    buffer_load_dwordx4 v[200:203], v7, s[4:7], s35 offen offset:2048
    v_exp_f32 v92, v92
    v_exp_f32 v93, v93
    v_exp_f32 v94, v94
    v_exp_f32 v95, v95
    buffer_load_dwordx4 v[204:207], v7, s[4:7], s35 offen offset:3072
    s_add_u32 s35, s35, 4096
    v_exp_f32 v96, v96
    v_exp_f32 v97, v97
    v_exp_f32 v98, v98
    v_exp_f32 v99, v99
    buffer_load_dwordx4 v[208:211], v7, s[4:7], s35 offen offset:0
    v_exp_f32 v100, v100
    v_exp_f32 v101, v101
    v_exp_f32 v102, v102
    v_exp_f32 v103, v103
    buffer_load_dwordx4 v[212:215], v7, s[4:7], s35 offen offset:1024
    v_exp_f32 v104, v104
    v_exp_f32 v105, v105
    v_exp_f32 v106, v106
    v_exp_f32 v107, v107
    buffer_load_dwordx4 v[216:219], v7, s[4:7], s35 offen offset:2048
    v_exp_f32 v108, v108
    v_exp_f32 v109, v109
    v_exp_f32 v110, v110
    v_exp_f32 v111, v111
    buffer_load_dwordx4 v[220:223], v7, s[4:7], s35 offen offset:3072
    s_add_u32 s35, s35, 4096
    v_pk_add_f32 v[68:69], v[80:81], v[82:83]
    v_pk_add_f32 v[70:71], v[96:97], v[98:99]
    v_pk_add_f32 v[68:69], v[68:69], v[84:85]
    v_pk_add_f32 v[70:71], v[70:71], v[100:101]
    v_pk_add_f32 v[68:69], v[68:69], v[86:87]
    v_pk_add_f32 v[70:71], v[70:71], v[102:103]
    v_pk_add_f32 v[68:69], v[68:69], v[88:89]
    v_pk_add_f32 v[70:71], v[70:71], v[104:105]
    v_pk_add_f32 v[68:69], v[68:69], v[90:91]
    v_pk_add_f32 v[70:71], v[70:71], v[106:107]
    v_pk_add_f32 v[68:69], v[68:69], v[92:93]
    v_pk_add_f32 v[70:71], v[70:71], v[108:109]
    v_pk_add_f32 v[68:69], v[68:69], v[94:95]
    v_pk_add_f32 v[70:71], v[70:71], v[110:111]
    v_add_f32 v68, v68, v69
    v_add_f32 v70, v70, v71
    v_rcp_f32 v68, v68
    v_rcp_f32 v70, v70
    v_pk_mul_f32 v[80:81], v[80:81], v[68:69] op_sel_hi:[1,0]
    v_pk_mul_f32 v[96:97], v[96:97], v[70:71] op_sel_hi:[1,0]
    v_pk_mul_f32 v[82:83], v[82:83], v[68:69] op_sel_hi:[1,0]
    v_pk_mul_f32 v[98:99], v[98:99], v[70:71] op_sel_hi:[1,0]
    v_pk_mul_f32 v[84:85], v[84:85], v[68:69] op_sel_hi:[1,0]
    v_pk_mul_f32 v[100:101], v[100:101], v[70:71] op_sel_hi:[1,0]
    v_pk_mul_f32 v[86:87], v[86:87], v[68:69] op_sel_hi:[1,0]
    v_pk_mul_f32 v[102:103], v[102:103], v[70:71] op_sel_hi:[1,0]
    v_pk_mul_f32 v[88:89], v[88:89], v[68:69] op_sel_hi:[1,0]
    v_pk_mul_f32 v[104:105], v[104:105], v[70:71] op_sel_hi:[1,0]
    v_pk_mul_f32 v[90:91], v[90:91], v[68:69] op_sel_hi:[1,0]
    v_pk_mul_f32 v[106:107], v[106:107], v[70:71] op_sel_hi:[1,0]
    v_pk_mul_f32 v[92:93], v[92:93], v[68:69] op_sel_hi:[1,0]
    v_pk_mul_f32 v[108:109], v[108:109], v[70:71] op_sel_hi:[1,0]
    v_pk_mul_f32 v[94:95], v[94:95], v[68:69] op_sel_hi:[1,0]
    v_pk_mul_f32 v[110:111], v[110:111], v[70:71] op_sel_hi:[1,0]
    buffer_load_dwordx4 v[224:227], v7, s[4:7], s35 offen offset:0
    buffer_load_dwordx4 v[228:231], v7, s[4:7], s35 offen offset:1024
    v_cvt_pk_bf16_f32 v32, v80, v81
    v_cvt_pk_bf16_f32 v33, v82, v83
L_wk1_1:
    s_cbranch_execz L_wk1_2
    v_cvt_pk_bf16_f32 v34, v84, v85
    v_cvt_pk_bf16_f32 v35, v86, v87
    ds_write_b128 v180, v[32:35] offset:0
    v_cvt_pk_bf16_f32 v36, v88, v89
    v_cvt_pk_bf16_f32 v37, v90, v91
    v_cvt_pk_bf16_f32 v38, v92, v93
    v_cvt_pk_bf16_f32 v39, v94, v95
    ds_write_b128 v180, v[36:39] offset:16
    v_cvt_pk_bf16_f32 v40, v96, v97
    v_cvt_pk_bf16_f32 v41, v98, v99
    v_cvt_pk_bf16_f32 v42, v100, v101
    v_cvt_pk_bf16_f32 v43, v102, v103
    ds_write_b128 v180, v[40:43] offset:32
    v_cvt_pk_bf16_f32 v44, v104, v105
    v_cvt_pk_bf16_f32 v45, v106, v107
    v_cvt_pk_bf16_f32 v46, v108, v109
    v_cvt_pk_bf16_f32 v47, v110, v111
    ds_write_b128 v180, v[44:47] offset:48
    buffer_load_dwordx4 v[232:235], v7, s[4:7], s35 offen offset:2048
    buffer_load_dwordx4 v[236:239], v7, s[4:7], s35 offen offset:3072
    s_add_u32 s35, s35, 4096
    v_permlane32_swap_b32 v48, v56
    v_permlane32_swap_b32 v52, v60
    v_permlane32_swap_b32 v49, v57
    v_permlane32_swap_b32 v53, v61
    v_permlane32_swap_b32 v50, v58
    v_permlane32_swap_b32 v54, v62
    v_permlane32_swap_b32 v51, v59
    v_permlane32_swap_b32 v55, v63
    v_permlane16_swap_b32 v48, v52
    v_permlane16_swap_b32 v56, v60
    v_permlane16_swap_b32 v49, v53
    v_permlane16_swap_b32 v57, v61
    v_permlane16_swap_b32 v50, v54
    v_permlane16_swap_b32 v58, v62
    v_permlane16_swap_b32 v51, v55
    v_permlane16_swap_b32 v59, v63
    v_pk_fma_f32 v[48:49], v[152:153], v[64:65], v[48:49] op_sel_hi:[1,0,1] neg_lo:[0,1,0] neg_hi:[0,1,0]
    v_pk_fma_f32 v[50:51], v[154:155], v[64:65], v[50:51] op_sel_hi:[1,0,1] neg_lo:[0,1,0] neg_hi:[0,1,0]
    v_pk_fma_f32 v[52:53], v[156:157], v[64:65], v[52:53] op_sel_hi:[1,0,1] neg_lo:[0,1,0] neg_hi:[0,1,0]
    v_pk_fma_f32 v[54:55], v[158:159], v[64:65], v[54:55] op_sel_hi:[1,0,1] neg_lo:[0,1,0] neg_hi:[0,1,0]
    v_pk_fma_f32 v[56:57], v[160:161], v[64:65], v[56:57] op_sel_hi:[1,0,1] neg_lo:[0,1,0] neg_hi:[0,1,0]
    v_pk_fma_f32 v[58:59], v[162:163], v[64:65], v[58:59] op_sel_hi:[1,0,1] neg_lo:[0,1,0] neg_hi:[0,1,0]
    v_pk_fma_f32 v[60:61], v[164:165], v[64:65], v[60:61] op_sel_hi:[1,0,1] neg_lo:[0,1,0] neg_hi:[0,1,0]
    v_pk_fma_f32 v[62:63], v[166:167], v[64:65], v[62:63] op_sel_hi:[1,0,1] neg_lo:[0,1,0] neg_hi:[0,1,0]
    v_pk_mul_f32 v[48:49], v[48:49], v[66:67] op_sel_hi:[1,0]
    v_pk_mul_f32 v[50:51], v[50:51], v[66:67] op_sel_hi:[1,0]
    v_pk_mul_f32 v[52:53], v[52:53], v[66:67] op_sel_hi:[1,0]
    v_pk_mul_f32 v[54:55], v[54:55], v[66:67] op_sel_hi:[1,0]
    v_pk_mul_f32 v[56:57], v[56:57], v[66:67] op_sel_hi:[1,0]
    v_pk_mul_f32 v[58:59], v[58:59], v[66:67] op_sel_hi:[1,0]
    v_pk_mul_f32 v[60:61], v[60:61], v[66:67] op_sel_hi:[1,0]
    v_pk_mul_f32 v[62:63], v[62:63], v[66:67] op_sel_hi:[1,0]
    v_cvt_pk_bf16_f32 v128, v48, v49
    v_cvt_pk_bf16_f32 v129, v50, v51
    v_cvt_pk_bf16_f32 v130, v52, v53
    v_cvt_pk_bf16_f32 v131, v54, v55
    ds_write_b128 v181, v[128:131] offset:0
    v_cvt_pk_bf16_f32 v132, v56, v57
    v_cvt_pk_bf16_f32 v133, v58, v59
    v_cvt_pk_bf16_f32 v134, v60, v61
    v_cvt_pk_bf16_f32 v135, v62, v63
    ds_write_b128 v181, v[132:135] offset:16
    buffer_load_dwordx4 v[240:243], v7, s[4:7], s35 offen offset:0
    buffer_load_dwordx4 v[244:247], v7, s[4:7], s35 offen offset:1024
    buffer_load_dwordx4 v[248:251], v7, s[4:7], s35 offen offset:2048
    buffer_load_dwordx4 v[252:255], v7, s[4:7], s35 offen offset:3072
    v_lshrrev_b32 v5, 2, v1
    v_mul_u32_u24 v5, 224, v5
    v_and_b32 v6, 3, v0
    v_lshl_add_u32 v5, v6, 3, v5
    v_add_u32 v180, s27, v5
    s_lshl_b32 s27, s20, 6
    s_lshl_b32 s28, s21, 5
    s_add_u32 s27, s27, s28
    s_add_u32 s27, s27, 132096
    v_add_u32 v181, s27, v5
    v_mov_b32 v48, 0x3f803f80
    v_mov_b32 v49, 0x3f803f80
    v_mov_b32 v50, 0x3f803f80
    v_mov_b32 v51, 0x3f803f80
    s_lshl_b32 s30, s26, 1
    s_add_u32 s30, s30, s20
    s_lshl_b32 s30, s30, 1
    s_add_u32 s30, s30, s21
    s_mul_i32 s30, s30, 1152
    s_add_u32 s30, s30, 21102592
    v_lshlrev_b32 v182, 2, v3
    v_lshl_add_u32 v183, v4, 8, v182
    s_waitcnt lgkmcnt(0)
    s_barrier
    ds_read_b64_tr_b16 v[136:137], v180 offset:0
    ds_read_b64_tr_b16 v[152:153], v181 offset:0
    ds_read_b64_tr_b16 v[138:139], v180 offset:3584
    ds_read_b64_tr_b16 v[154:155], v181 offset:3584
    ds_read_b64_tr_b16 v[140:141], v180 offset:7168
    ds_read_b64_tr_b16 v[156:157], v181 offset:7168
    ds_read_b64_tr_b16 v[142:143], v180 offset:10752
    ds_read_b64_tr_b16 v[158:159], v181 offset:10752
    ds_read_b64_tr_b16 v[144:145], v180 offset:14336
    ds_read_b64_tr_b16 v[160:161], v181 offset:14336
    ds_read_b64_tr_b16 v[146:147], v180 offset:17920
    ds_read_b64_tr_b16 v[162:163], v181 offset:17920
    ds_read_b64_tr_b16 v[148:149], v180 offset:21504
    ds_read_b64_tr_b16 v[164:165], v181 offset:21504
    ds_read_b64_tr_b16 v[150:151], v180 offset:25088
    ds_read_b64_tr_b16 v[166:167], v181 offset:25088
    s_waitcnt lgkmcnt(12)
    v_mfma_f32_16x16x32_bf16 v[168:171], v[136:139], v[152:155], 0
    v_mfma_f32_16x16x32_bf16 v[172:175], v[48:51], v[152:155], 0
    ds_read_b64_tr_b16 v[80:81], v8 offset:32768
    ds_read_b64_tr_b16 v[82:83], v8 offset:36864
    ds_read_b64_tr_b16 v[84:85], v9 offset:32768
    ds_read_b64_tr_b16 v[86:87], v9 offset:36864
    s_waitcnt lgkmcnt(12)
    v_mfma_f32_16x16x32_bf16 v[168:171], v[140:143], v[156:159], v[168:171]
    v_mfma_f32_16x16x32_bf16 v[172:175], v[48:51], v[156:159], v[172:175]
    ds_read_b64_tr_b16 v[88:89], v10 offset:32768
    ds_read_b64_tr_b16 v[90:91], v10 offset:36864
    ds_read_b64_tr_b16 v[92:93], v11 offset:32768
    ds_read_b64_tr_b16 v[94:95], v11 offset:36864
    s_waitcnt lgkmcnt(12)
    v_mfma_f32_16x16x32_bf16 v[168:171], v[144:147], v[160:163], v[168:171]
    v_mfma_f32_16x16x32_bf16 v[172:175], v[48:51], v[160:163], v[172:175]
    ds_read_b64_tr_b16 v[96:97], v8 offset:40960
    ds_read_b64_tr_b16 v[98:99], v8 offset:45056
    ds_read_b64_tr_b16 v[100:101], v9 offset:40960
    ds_read_b64_tr_b16 v[102:103], v9 offset:45056
    s_waitcnt lgkmcnt(12)
    v_mfma_f32_16x16x32_bf16 v[168:171], v[148:151], v[164:167], v[168:171]
    v_mfma_f32_16x16x32_bf16 v[172:175], v[48:51], v[164:167], v[172:175]
    ds_read_b64_tr_b16 v[104:105], v10 offset:40960
    ds_read_b64_tr_b16 v[106:107], v10 offset:45056
    ds_read_b64_tr_b16 v[108:109], v11 offset:40960
    ds_read_b64_tr_b16 v[110:111], v11 offset:45056
    s_nop 2
    buffer_atomic_add_f32 v168, v183, s[4:7], s30 offen offset:0
    buffer_atomic_add_f32 v169, v183, s[4:7], s30 offen offset:64
    buffer_atomic_add_f32 v170, v183, s[4:7], s30 offen offset:128
    buffer_atomic_add_f32 v171, v183, s[4:7], s30 offen offset:192
    s_mov_b64 exec, 0xffff
    buffer_atomic_add_f32 v172, v182, s[4:7], s30 offen offset:1024
    s_mov_b64 exec, -1
    s_waitcnt lgkmcnt(8)
    v_mfma_f32_16x16x32_bf16 v[16:19], a[48:51], v[80:83], v[16:19]
    ds_read_b64_tr_b16 v[112:113], v12 offset:0
    ds_read_b64_tr_b16 v[114:115], v12 offset:4096
    v_mfma_f32_16x16x32_bf16 v[20:23], a[48:51], v[84:87], v[20:23]
    ds_read_b64_tr_b16 v[116:117], v13 offset:0
    ds_read_b64_tr_b16 v[118:119], v13 offset:4096
    v_mfma_f32_16x16x32_bf16 v[24:27], a[48:51], v[88:91], v[24:27]
    ds_read_b64_tr_b16 v[120:121], v14 offset:0
    ds_read_b64_tr_b16 v[122:123], v14 offset:4096
    v_mfma_f32_16x16x32_bf16 v[28:31], a[48:51], v[92:95], v[28:31]
    ds_read_b64_tr_b16 v[124:125], v15 offset:0
    ds_read_b64_tr_b16 v[126:127], v15 offset:4096
    s_waitcnt lgkmcnt(8)
    v_mfma_f32_16x16x32_bf16 v[16:19], a[60:63], v[96:99], v[16:19]
    ds_read_b64_tr_b16 v[80:81], v12 offset:8192
    ds_read_b64_tr_b16 v[82:83], v12 offset:12288
    v_mfma_f32_16x16x32_bf16 v[20:23], a[60:63], v[100:103], v[20:23]
    ds_read_b64_tr_b16 v[84:85], v13 offset:8192
    ds_read_b64_tr_b16 v[86:87], v13 offset:12288
    v_mfma_f32_16x16x32_bf16 v[24:27], a[60:63], v[104:107], v[24:27]
    ds_read_b64_tr_b16 v[88:89], v14 offset:8192
    ds_read_b64_tr_b16 v[90:91], v14 offset:12288
    v_mfma_f32_16x16x32_bf16 v[28:31], a[60:63], v[108:111], v[28:31]
    ds_read_b64_tr_b16 v[92:93], v15 offset:8192
    ds_read_b64_tr_b16 v[94:95], v15 offset:12288
    s_waitcnt lgkmcnt(8)
    v_mfma_f32_16x16x32_bf16 v[16:19], a[72:75], v[112:115], v[16:19]
    ds_read_b64_tr_b16 v[96:97], v12 offset:16384
    ds_read_b64_tr_b16 v[98:99], v12 offset:20480
    v_mfma_f32_16x16x32_bf16 v[20:23], a[72:75], v[116:119], v[20:23]
    ds_read_b64_tr_b16 v[100:101], v13 offset:16384
    ds_read_b64_tr_b16 v[102:103], v13 offset:20480
    v_mfma_f32_16x16x32_bf16 v[24:27], a[72:75], v[120:123], v[24:27]
    ds_read_b64_tr_b16 v[104:105], v14 offset:16384
    ds_read_b64_tr_b16 v[106:107], v14 offset:20480
    v_mfma_f32_16x16x32_bf16 v[28:31], a[72:75], v[124:127], v[28:31]
    ds_read_b64_tr_b16 v[108:109], v15 offset:16384
    ds_read_b64_tr_b16 v[110:111], v15 offset:20480
    s_waitcnt lgkmcnt(8)
    v_mfma_f32_16x16x32_bf16 v[16:19], a[84:87], v[80:83], v[16:19]
    ds_read_b64_tr_b16 v[112:113], v12 offset:24576
    ds_read_b64_tr_b16 v[114:115], v12 offset:28672
    v_mfma_f32_16x16x32_bf16 v[20:23], a[84:87], v[84:87], v[20:23]
    ds_read_b64_tr_b16 v[116:117], v13 offset:24576
    ds_read_b64_tr_b16 v[118:119], v13 offset:28672
    v_mfma_f32_16x16x32_bf16 v[24:27], a[84:87], v[88:91], v[24:27]
    ds_read_b64_tr_b16 v[120:121], v14 offset:24576
    ds_read_b64_tr_b16 v[122:123], v14 offset:28672
    v_mfma_f32_16x16x32_bf16 v[28:31], a[84:87], v[92:95], v[28:31]
    ds_read_b64_tr_b16 v[124:125], v15 offset:24576
    ds_read_b64_tr_b16 v[126:127], v15 offset:28672
    s_waitcnt lgkmcnt(8)
    v_mfma_f32_16x16x32_bf16 v[16:19], a[96:99], v[96:99], v[16:19]
    ds_read_b64_tr_b16 v[80:81], v12 offset:32768
    ds_read_b64_tr_b16 v[82:83], v12 offset:36864
    v_mfma_f32_16x16x32_bf16 v[20:23], a[96:99], v[100:103], v[20:23]
    ds_read_b64_tr_b16 v[84:85], v13 offset:32768
    ds_read_b64_tr_b16 v[86:87], v13 offset:36864
    v_mfma_f32_16x16x32_bf16 v[24:27], a[96:99], v[104:107], v[24:27]
    ds_read_b64_tr_b16 v[88:89], v14 offset:32768
    ds_read_b64_tr_b16 v[90:91], v14 offset:36864
    v_mfma_f32_16x16x32_bf16 v[28:31], a[96:99], v[108:111], v[28:31]
    ds_read_b64_tr_b16 v[92:93], v15 offset:32768
    ds_read_b64_tr_b16 v[94:95], v15 offset:36864
    s_waitcnt lgkmcnt(8)
    v_mfma_f32_16x16x32_bf16 v[16:19], a[108:111], v[112:115], v[16:19]
    ds_read_b64_tr_b16 v[96:97], v12 offset:40960
    ds_read_b64_tr_b16 v[98:99], v12 offset:45056
    v_mfma_f32_16x16x32_bf16 v[20:23], a[108:111], v[116:119], v[20:23]
    ds_read_b64_tr_b16 v[100:101], v13 offset:40960
    ds_read_b64_tr_b16 v[102:103], v13 offset:45056
    v_mfma_f32_16x16x32_bf16 v[24:27], a[108:111], v[120:123], v[24:27]
    ds_read_b64_tr_b16 v[104:105], v14 offset:40960
    ds_read_b64_tr_b16 v[106:107], v14 offset:45056
    v_mfma_f32_16x16x32_bf16 v[28:31], a[108:111], v[124:127], v[28:31]
    ds_read_b64_tr_b16 v[108:109], v15 offset:40960
    ds_read_b64_tr_b16 v[110:111], v15 offset:45056
    s_waitcnt lgkmcnt(8)
    v_mfma_f32_16x16x32_bf16 v[16:19], a[120:123], v[80:83], v[16:19]
    ds_read_b64_tr_b16 v[112:113], v8 offset:0
    ds_read_b64_tr_b16 v[114:115], v8 offset:4096
    v_mfma_f32_16x16x32_bf16 v[20:23], a[120:123], v[84:87], v[20:23]
    ds_read_b64_tr_b16 v[116:117], v9 offset:0
    ds_read_b64_tr_b16 v[118:119], v9 offset:4096
    v_mfma_f32_16x16x32_bf16 v[24:27], a[120:123], v[88:91], v[24:27]
    ds_read_b64_tr_b16 v[120:121], v10 offset:0
    ds_read_b64_tr_b16 v[122:123], v10 offset:4096
    v_mfma_f32_16x16x32_bf16 v[28:31], a[120:123], v[92:95], v[28:31]
    ds_read_b64_tr_b16 v[124:125], v11 offset:0
    ds_read_b64_tr_b16 v[126:127], v11 offset:4096
    s_waitcnt lgkmcnt(8)
    v_mfma_f32_16x16x32_bf16 v[16:19], a[132:135], v[96:99], v[16:19]
    ds_read_b64_tr_b16 v[80:81], v8 offset:8192
    ds_read_b64_tr_b16 v[82:83], v8 offset:12288
    v_mfma_f32_16x16x32_bf16 v[20:23], a[132:135], v[100:103], v[20:23]
    ds_read_b64_tr_b16 v[84:85], v9 offset:8192
    ds_read_b64_tr_b16 v[86:87], v9 offset:12288
    v_mfma_f32_16x16x32_bf16 v[24:27], a[132:135], v[104:107], v[24:27]
    ds_read_b64_tr_b16 v[88:89], v10 offset:8192
    ds_read_b64_tr_b16 v[90:91], v10 offset:12288
    v_mfma_f32_16x16x32_bf16 v[28:31], a[132:135], v[108:111], v[28:31]
    ds_read_b64_tr_b16 v[92:93], v11 offset:8192
    ds_read_b64_tr_b16 v[94:95], v11 offset:12288
    s_waitcnt lgkmcnt(8)
    v_mfma_f32_16x16x32_bf16 v[16:19], a[144:147], v[112:115], v[16:19]
    ds_read_b64_tr_b16 v[96:97], v8 offset:16384
    ds_read_b64_tr_b16 v[98:99], v8 offset:20480
    v_mfma_f32_16x16x32_bf16 v[20:23], a[144:147], v[116:119], v[20:23]
    ds_read_b64_tr_b16 v[100:101], v9 offset:16384
    ds_read_b64_tr_b16 v[102:103], v9 offset:20480
    v_mfma_f32_16x16x32_bf16 v[24:27], a[144:147], v[120:123], v[24:27]
    ds_read_b64_tr_b16 v[104:105], v10 offset:16384
    ds_read_b64_tr_b16 v[106:107], v10 offset:20480
    v_mfma_f32_16x16x32_bf16 v[28:31], a[144:147], v[124:127], v[28:31]
    ds_read_b64_tr_b16 v[108:109], v11 offset:16384
    ds_read_b64_tr_b16 v[110:111], v11 offset:20480
    s_waitcnt lgkmcnt(8)
    v_mfma_f32_16x16x32_bf16 v[16:19], a[156:159], v[80:83], v[16:19]
    ds_read_b64_tr_b16 v[112:113], v8 offset:24576
    ds_read_b64_tr_b16 v[114:115], v8 offset:28672
    v_mfma_f32_16x16x32_bf16 v[20:23], a[156:159], v[84:87], v[20:23]
    ds_read_b64_tr_b16 v[116:117], v9 offset:24576
    ds_read_b64_tr_b16 v[118:119], v9 offset:28672
    v_mfma_f32_16x16x32_bf16 v[24:27], a[156:159], v[88:91], v[24:27]
    ds_read_b64_tr_b16 v[120:121], v10 offset:24576
    ds_read_b64_tr_b16 v[122:123], v10 offset:28672
    v_mfma_f32_16x16x32_bf16 v[28:31], a[156:159], v[92:95], v[28:31]
    ds_read_b64_tr_b16 v[124:125], v11 offset:24576
    ds_read_b64_tr_b16 v[126:127], v11 offset:28672
    s_waitcnt lgkmcnt(8)
    v_mfma_f32_16x16x32_bf16 v[16:19], a[168:171], v[96:99], v[16:19]
    ds_read_b128 v[32:35], v187 offset:0
    ds_read_b128 v[36:39], v187 offset:16
    v_mfma_f32_16x16x32_bf16 v[20:23], a[168:171], v[100:103], v[20:23]
    ds_read_b128 v[40:43], v187 offset:32
    ds_read_b128 v[44:47], v187 offset:48
    v_mfma_f32_16x16x32_bf16 v[24:27], a[168:171], v[104:107], v[24:27]
    v_mfma_f32_16x16x32_bf16 v[28:31], a[168:171], v[108:111], v[28:31]
    s_waitcnt lgkmcnt(4)
    v_mfma_f32_16x16x32_bf16 v[16:19], a[180:183], v[112:115], v[16:19]
    v_mfma_f32_16x16x32_bf16 v[20:23], a[180:183], v[116:119], v[20:23]
    v_mfma_f32_16x16x32_bf16 v[24:27], a[180:183], v[120:123], v[24:27]
    v_mfma_f32_16x16x32_bf16 v[28:31], a[180:183], v[124:127], v[28:31]
    s_nop 6
    v_permlane32_swap_b32 v16, v24
    v_permlane32_swap_b32 v20, v28
    v_permlane32_swap_b32 v17, v25
    v_permlane32_swap_b32 v21, v29
    v_permlane32_swap_b32 v18, v26
    v_permlane32_swap_b32 v22, v30
    v_permlane32_swap_b32 v19, v27
    v_permlane32_swap_b32 v23, v31
    v_permlane16_swap_b32 v16, v20
    v_permlane16_swap_b32 v24, v28
    v_permlane16_swap_b32 v17, v21
    v_permlane16_swap_b32 v25, v29
    v_permlane16_swap_b32 v18, v22
    v_permlane16_swap_b32 v26, v30
    v_permlane16_swap_b32 v19, v23
    v_permlane16_swap_b32 v27, v31
    s_waitcnt lgkmcnt(0)
    v_pk_fma_f32 v[16:17], v[32:33], v[64:65], v[16:17] op_sel_hi:[1,0,1] neg_lo:[0,1,0] neg_hi:[0,1,0]
    v_pk_fma_f32 v[18:19], v[34:35], v[64:65], v[18:19] op_sel_hi:[1,0,1] neg_lo:[0,1,0] neg_hi:[0,1,0]
    v_pk_fma_f32 v[20:21], v[36:37], v[64:65], v[20:21] op_sel_hi:[1,0,1] neg_lo:[0,1,0] neg_hi:[0,1,0]
    v_pk_fma_f32 v[22:23], v[38:39], v[64:65], v[22:23] op_sel_hi:[1,0,1] neg_lo:[0,1,0] neg_hi:[0,1,0]
    v_pk_fma_f32 v[24:25], v[40:41], v[64:65], v[24:25] op_sel_hi:[1,0,1] neg_lo:[0,1,0] neg_hi:[0,1,0]
    v_pk_fma_f32 v[26:27], v[42:43], v[64:65], v[26:27] op_sel_hi:[1,0,1] neg_lo:[0,1,0] neg_hi:[0,1,0]
    v_pk_fma_f32 v[28:29], v[44:45], v[64:65], v[28:29] op_sel_hi:[1,0,1] neg_lo:[0,1,0] neg_hi:[0,1,0]
    v_pk_fma_f32 v[30:31], v[46:47], v[64:65], v[30:31] op_sel_hi:[1,0,1] neg_lo:[0,1,0] neg_hi:[0,1,0]
    v_max3_f32 v72, v16, v17, v18
    v_min3_f32 v74, v16, v17, v18
    v_max3_f32 v72, v72, v19, v20
    v_min3_f32 v74, v74, v19, v20
    v_max3_f32 v72, v72, v21, v22
    v_min3_f32 v74, v74, v21, v22
    v_max3_f32 v72, v72, v23, v24
    v_min3_f32 v74, v74, v23, v24
    v_max3_f32 v72, v72, v25, v26
    v_min3_f32 v74, v74, v25, v26
    v_max3_f32 v72, v72, v27, v28
    v_min3_f32 v74, v74, v27, v28
    v_max3_f32 v72, v72, v29, v30
    v_min3_f32 v74, v74, v29, v30
    v_max_f32 v72, v72, v31
    v_min_f32 v74, v74, v31
    s_waitcnt vmcnt(0)
    s_barrier
    s_cmp_eq_u32 s24, 1
    s_cbranch_scc0 L_gs0
    v_mov_b32 v188, 1
    v_lshlrev_b32 v189, 11, v1
    s_mov_b64 exec, 0xff
    buffer_store_dword v188, v189, s[4:7], s79 offen sc1
    s_mov_b64 exec, -1
L_gs0:
    v_mul_f32 v72, v72, v76
    v_mul_f32 v74, v74, v76
    v_pk_fma_f32 v[80:81], v[16:17], v[76:77], v[72:73] op_sel_hi:[1,0,0] neg_lo:[0,0,1] neg_hi:[0,0,1]
    v_pk_fma_f32 v[96:97], v[16:17], v[76:77], v[74:75] op_sel_hi:[1,0,0] neg_lo:[1,0,0] neg_hi:[1,0,0]
    v_pk_fma_f32 v[82:83], v[18:19], v[76:77], v[72:73] op_sel_hi:[1,0,0] neg_lo:[0,0,1] neg_hi:[0,0,1]
    v_pk_fma_f32 v[98:99], v[18:19], v[76:77], v[74:75] op_sel_hi:[1,0,0] neg_lo:[1,0,0] neg_hi:[1,0,0]
    v_pk_fma_f32 v[84:85], v[20:21], v[76:77], v[72:73] op_sel_hi:[1,0,0] neg_lo:[0,0,1] neg_hi:[0,0,1]
    v_pk_fma_f32 v[100:101], v[20:21], v[76:77], v[74:75] op_sel_hi:[1,0,0] neg_lo:[1,0,0] neg_hi:[1,0,0]
    v_pk_fma_f32 v[86:87], v[22:23], v[76:77], v[72:73] op_sel_hi:[1,0,0] neg_lo:[0,0,1] neg_hi:[0,0,1]
    v_pk_fma_f32 v[102:103], v[22:23], v[76:77], v[74:75] op_sel_hi:[1,0,0] neg_lo:[1,0,0] neg_hi:[1,0,0]
    v_pk_fma_f32 v[88:89], v[24:25], v[76:77], v[72:73] op_sel_hi:[1,0,0] neg_lo:[0,0,1] neg_hi:[0,0,1]
    v_pk_fma_f32 v[104:105], v[24:25], v[76:77], v[74:75] op_sel_hi:[1,0,0] neg_lo:[1,0,0] neg_hi:[1,0,0]
    v_pk_fma_f32 v[90:91], v[26:27], v[76:77], v[72:73] op_sel_hi:[1,0,0] neg_lo:[0,0,1] neg_hi:[0,0,1]
    v_pk_fma_f32 v[106:107], v[26:27], v[76:77], v[74:75] op_sel_hi:[1,0,0] neg_lo:[1,0,0] neg_hi:[1,0,0]
    v_pk_fma_f32 v[92:93], v[28:29], v[76:77], v[72:73] op_sel_hi:[1,0,0] neg_lo:[0,0,1] neg_hi:[0,0,1]
    v_pk_fma_f32 v[108:109], v[28:29], v[76:77], v[74:75] op_sel_hi:[1,0,0] neg_lo:[1,0,0] neg_hi:[1,0,0]
    v_pk_fma_f32 v[94:95], v[30:31], v[76:77], v[72:73] op_sel_hi:[1,0,0] neg_lo:[0,0,1] neg_hi:[0,0,1]
    v_pk_fma_f32 v[110:111], v[30:31], v[76:77], v[74:75] op_sel_hi:[1,0,0] neg_lo:[1,0,0] neg_hi:[1,0,0]
    v_exp_f32 v80, v80
    v_exp_f32 v81, v81
    v_exp_f32 v82, v82
    v_exp_f32 v83, v83
    v_exp_f32 v84, v84
    v_exp_f32 v85, v85
    v_exp_f32 v86, v86
    v_exp_f32 v87, v87
    v_exp_f32 v88, v88
    v_exp_f32 v89, v89
    v_exp_f32 v90, v90
    v_exp_f32 v91, v91
    v_exp_f32 v92, v92
    v_exp_f32 v93, v93
    v_exp_f32 v94, v94
    v_exp_f32 v95, v95
    v_exp_f32 v96, v96
    v_exp_f32 v97, v97
    v_exp_f32 v98, v98
    v_exp_f32 v99, v99
    v_exp_f32 v100, v100
    v_exp_f32 v101, v101
    v_exp_f32 v102, v102
    v_exp_f32 v103, v103
    v_exp_f32 v104, v104
    v_exp_f32 v105, v105
    v_exp_f32 v106, v106
    v_exp_f32 v107, v107
    v_exp_f32 v108, v108
    v_exp_f32 v109, v109
    v_exp_f32 v110, v110
    v_exp_f32 v111, v111
    v_pk_add_f32 v[72:73], v[80:81], v[82:83]
    v_pk_add_f32 v[74:75], v[96:97], v[98:99]
    v_pk_add_f32 v[72:73], v[72:73], v[84:85]
    v_pk_add_f32 v[74:75], v[74:75], v[100:101]
    v_pk_add_f32 v[72:73], v[72:73], v[86:87]
    v_pk_add_f32 v[74:75], v[74:75], v[102:103]
    v_pk_add_f32 v[72:73], v[72:73], v[88:89]
    v_pk_add_f32 v[74:75], v[74:75], v[104:105]
    v_pk_add_f32 v[72:73], v[72:73], v[90:91]
    v_pk_add_f32 v[74:75], v[74:75], v[106:107]
    v_pk_add_f32 v[72:73], v[72:73], v[92:93]
    v_pk_add_f32 v[74:75], v[74:75], v[108:109]
    v_pk_add_f32 v[72:73], v[72:73], v[94:95]
    v_pk_add_f32 v[74:75], v[74:75], v[110:111]
    v_add_f32 v72, v72, v73
    v_add_f32 v74, v74, v75
    v_rcp_f32 v72, v72
    v_rcp_f32 v74, v74
    v_pk_mul_f32 v[80:81], v[80:81], v[72:73] op_sel_hi:[1,0]
    v_pk_mul_f32 v[96:97], v[96:97], v[74:75] op_sel_hi:[1,0]
    v_pk_mul_f32 v[82:83], v[82:83], v[72:73] op_sel_hi:[1,0]
    v_pk_mul_f32 v[98:99], v[98:99], v[74:75] op_sel_hi:[1,0]
    v_pk_mul_f32 v[84:85], v[84:85], v[72:73] op_sel_hi:[1,0]
    v_pk_mul_f32 v[100:101], v[100:101], v[74:75] op_sel_hi:[1,0]
    v_pk_mul_f32 v[86:87], v[86:87], v[72:73] op_sel_hi:[1,0]
    v_pk_mul_f32 v[102:103], v[102:103], v[74:75] op_sel_hi:[1,0]
    v_pk_mul_f32 v[88:89], v[88:89], v[72:73] op_sel_hi:[1,0]
    v_pk_mul_f32 v[104:105], v[104:105], v[74:75] op_sel_hi:[1,0]
    v_pk_mul_f32 v[90:91], v[90:91], v[72:73] op_sel_hi:[1,0]
    v_pk_mul_f32 v[106:107], v[106:107], v[74:75] op_sel_hi:[1,0]
    v_pk_mul_f32 v[92:93], v[92:93], v[72:73] op_sel_hi:[1,0]
    v_pk_mul_f32 v[108:109], v[108:109], v[74:75] op_sel_hi:[1,0]
    v_pk_mul_f32 v[94:95], v[94:95], v[72:73] op_sel_hi:[1,0]
    v_pk_mul_f32 v[110:111], v[110:111], v[74:75] op_sel_hi:[1,0]
    v_cvt_pk_bf16_f32 v112, v80, v81
    v_cvt_pk_bf16_f32 v113, v82, v83
    v_cvt_pk_bf16_f32 v114, v84, v85
    v_cvt_pk_bf16_f32 v115, v86, v87
    v_cvt_pk_bf16_f32 v116, v88, v89
    v_cvt_pk_bf16_f32 v117, v90, v91
    v_cvt_pk_bf16_f32 v118, v92, v93
    v_cvt_pk_bf16_f32 v119, v94, v95
    v_cvt_pk_bf16_f32 v120, v96, v97
    v_cvt_pk_bf16_f32 v121, v98, v99
    v_cvt_pk_bf16_f32 v122, v100, v101
    v_cvt_pk_bf16_f32 v123, v102, v103
    v_cvt_pk_bf16_f32 v124, v104, v105
    v_cvt_pk_bf16_f32 v125, v106, v107
    v_cvt_pk_bf16_f32 v126, v108, v109
    v_cvt_pk_bf16_f32 v127, v110, v111
    v_permlane32_swap_b32 v112, v116
    v_permlane32_swap_b32 v113, v117
    v_permlane32_swap_b32 v114, v118
    v_permlane32_swap_b32 v115, v119
    v_permlane32_swap_b32 v120, v124
    v_permlane32_swap_b32 v121, v125
    v_permlane32_swap_b32 v122, v126
    v_permlane32_swap_b32 v123, v127
    v_and_b32 v5, 31, v0
    v_min_u32 v5, 16, v5
    v_lshlrev_b32 v5, 6, v5
    v_lshrrev_b32 v6, 5, v1
    v_lshl_add_u32 v5, v6, 5, v5
    s_lshl_b32 s29, s26, 1
    s_add_u32 s29, s29, s20
    s_mul_i32 s30, s29, 2304
    s_add_u32 s30, s30, 21102592
    s_lshl_b32 s29, s29, 10
    s_lshl_b32 s22, s25, 2
    s_add_u32 s22, s22, s24
    s_lshl_b32 s28, s22, 15
    s_add_u32 s28, s28, s29
    s_add_u32 s28, s28, 12713984
    s_xor_b32 s22, s22, 1
    s_lshl_b32 s22, s22, 15
    s_add_u32 s29, s29, s22
    s_add_u32 s29, s29, 12713984
    s_mov_b32 s31, 0x358637bd
    s_cmp_eq_u32 s24, 3
    s_cbranch_scc0 L_wk2_skip
    s_mov_b64 exec, 0
    s_branch L_wk2_ret
L_wk2_ret:
    s_mov_b64 exec, -1
L_wk2_skip:
    s_cmp_eq_u32 s24, 0
    s_cbranch_scc0 L_gw0
    v_lshlrev_b32 v189, 7, v1
    s_mov_b32 s23, 0
    s_mov_b64 exec, 0xffff
L_gwp0:
    buffer_load_dword v2, v189, s[4:7], s80 offen sc1
    s_add_u32 s23, s23, 1
    s_cmp_gt_u32 s23, 400000
    s_cbranch_scc1 L_gwq0
    s_waitcnt vmcnt(0)
    v_cmp_gt_u32 vcc, 1, v2
    s_nop 4
    s_and_b64 exec, exec, vcc
    s_cbranch_execnz L_gwp0
L_gwq0:
    s_waitcnt vmcnt(0)
    s_mov_b64 exec, -1
L_gw0:
    s_waitcnt lgkmcnt(0)
    s_barrier
    buffer_load_dwordx4 v[136:139], v5, s[4:7], s30 offen offset:0 sc1
    buffer_load_dwordx4 v[140:143], v5, s[4:7], s30 offen offset:16 sc1
    buffer_load_dwordx4 v[144:147], v5, s[4:7], s30 offen offset:1152 sc1
    buffer_load_dwordx4 v[148:151], v5, s[4:7], s30 offen offset:1168 sc1
    s_and_b32 s25, s2, 7
    s_lshl_b32 s25, s25, 3
    s_lshr_b32 s26, s2, 5
    s_add_u32 s25, s25, s26
    s_bfe_u32 s26, s2, 0x20003
    s_lshl_b32 s26, s26, 2
    s_add_u32 s26, s26, s24
    v_lshrrev_b32 v9, 2, v1
    v_lshlrev_b32 v9, 8, v9
    v_and_b32 v10, 3, v0
    v_lshl_add_u32 v9, v10, 4, v9
    s_lshr_b32 s44, s25, 2
    s_lshl_b32 s44, s44, 17
    s_and_b32 s45, s25, 3
    s_lshl_b32 s45, s45, 6
    s_add_u32 s44, s44, s45
    s_lshl_b32 s45, s26, 13
    s_add_u32 s44, s44, s45
    s_add_u32 s44, s44, 4325376
    s_add_u32 s45, s44, 3072
    s_lshl_b32 s34, s24, 11
    s_add_u32 s34, s34, 66560
    s_mov_b32 m0, s34
    s_nop 0
    buffer_load_dwordx4 v9, s[4:7], s44 offen sc1 lds
    buffer_load_dwordx4 v9, s[4:7], s45 offen offset:1024 sc1 lds
    s_lshl_b32 s47, s24, 12
    s_lshl_b32 s46, s25, 15
    s_add_u32 s46, s46, s47
    s_add_u32 s46, s46, 12713984
    s_add_u32 s43, s46, 16384
    s_add_u32 s47, s47, 33792
    v_and_b32 v184, 31, v0
    v_add_u32 v185, 33792, v7
    v_lshrrev_b32 v186, 5, v1
    v_bfe_u32 v8, v0, 2, 2
    v_lshlrev_b32 v8, 6, v8
    v_lshl_add_u32 v8, v186, 8, v8
    v_and_b32 v9, 1, v4
    v_lshl_add_u32 v8, v9, 5, v8
    v_and_b32 v9, 3, v0
    v_lshl_add_u32 v8, v9, 3, v8
    v_add_u32 v8, s34, v8
    s_waitcnt vmcnt(4)
    v_cvt_pk_bf16_f32 v136, v136, v137
    v_cvt_pk_bf16_f32 v137, v138, v139
    v_cvt_pk_bf16_f32 v138, v140, v141
    v_cvt_pk_bf16_f32 v139, v142, v143
    s_nop 1
    v_mfma_f32_32x32x16_bf16 v[16:31], v[136:139], v[112:115], 0
    v_mfma_f32_32x32x16_bf16 v[32:47], v[136:139], v[116:119], 0
    s_waitcnt vmcnt(2)
    v_cvt_pk_bf16_f32 v144, v144, v145
    v_cvt_pk_bf16_f32 v145, v146, v147
    v_cvt_pk_bf16_f32 v146, v148, v149
    v_cvt_pk_bf16_f32 v147, v150, v151
    s_nop 1
    v_mfma_f32_32x32x16_bf16 v[16:31], v[144:147], v[120:123], v[16:31]
    v_mfma_f32_32x32x16_bf16 v[32:47], v[144:147], v[124:127], v[32:47]
    s_nop 10
    v_add_f32 v24, s31, v24
    v_rcp_f32 v24, v24
    s_nop 0
    v_pk_mul_f32 v[16:17], v[16:17], v[24:25] op_sel_hi:[1,0]
    v_pk_mul_f32 v[18:19], v[18:19], v[24:25] op_sel_hi:[1,0]
    v_pk_mul_f32 v[20:21], v[20:21], v[24:25] op_sel_hi:[1,0]
    v_pk_mul_f32 v[22:23], v[22:23], v[24:25] op_sel_hi:[1,0]
    v_cvt_pk_bf16_f32 v28, v16, v17
    v_cvt_pk_bf16_f32 v29, v18, v19
    v_cvt_pk_bf16_f32 v30, v20, v21
    v_cvt_pk_bf16_f32 v31, v22, v23
    s_cmp_eq_u32 s3, 1
    s_cbranch_scc1 L_q0p0
    buffer_store_dwordx4 v[28:31], v7, s[4:7], s28 offen sc1
    s_branch L_q0q0
L_q0p0:
    buffer_store_dwordx4 v[28:31], v7, s[4:7], s28 offen
L_q0q0:
    v_add_f32 v40, s31, v40
    v_rcp_f32 v40, v40
    s_nop 0
    v_pk_mul_f32 v[32:33], v[32:33], v[40:41] op_sel_hi:[1,0]
    v_pk_mul_f32 v[34:35], v[34:35], v[40:41] op_sel_hi:[1,0]
    v_pk_mul_f32 v[36:37], v[36:37], v[40:41] op_sel_hi:[1,0]
    v_pk_mul_f32 v[38:39], v[38:39], v[40:41] op_sel_hi:[1,0]
    v_cvt_pk_bf16_f32 v44, v32, v33
    v_cvt_pk_bf16_f32 v45, v34, v35
    v_cvt_pk_bf16_f32 v46, v36, v37
    v_cvt_pk_bf16_f32 v47, v38, v39
    s_cmp_eq_u32 s3, 1
    s_cbranch_scc1 L_q0p1
    buffer_store_dwordx4 v[44:47], v7, s[4:7], s29 offen sc1
    s_branch L_q0q1
L_q0p1:
    buffer_store_dwordx4 v[44:47], v7, s[4:7], s29 offen
L_q0q1:
    s_waitcnt vmcnt(0) lgkmcnt(0)
    s_barrier
    s_cmp_eq_u32 s24, 1
    s_cbranch_scc0 L_bs3
    v_mov_b32 v188, 15
    v_mov_b32 v189, 0
    s_mov_b64 exec, 1
    buffer_store_byte v188, v189, s[4:7], s38 offen
    s_mov_b64 exec, -1
L_bs3:
    s_cmp_eq_u32 s33, 1
    s_cbranch_scc0 L_bl3
    v_lshlrev_b32 v188, 3, v191
    v_lshlrev_b32 v189, 2, v1
    s_mov_b32 s23, 0
L_blp3:
    buffer_load_dword v2, v189, s[4:7], s39 offen sc1
    s_add_u32 s23, s23, 1
    s_cmp_gt_u32 s23, 400000
    s_cbranch_scc1 L_blq3
    s_waitcnt vmcnt(0)
    v_and_b32 v2, v2, v188
    v_cmp_ne_u32 vcc, v2, v188
    s_nop 4
    s_cbranch_vccnz L_blp3
L_blq3:
    s_waitcnt vmcnt(0)
    v_mov_b32 v188, 4
    v_mul_u32_u24 v189, 2048, v1
    s_mov_b64 exec, s[36:37]
    buffer_store_dword v188, v189, s[4:7], s40 offen sc1
    s_mov_b64 exec, -1
L_bl3:
    s_cmp_eq_u32 s3, 1
    s_cbranch_scc0 L_bg3
    s_cmp_eq_u32 s24, 0
    s_cbranch_scc0 L_bwx3
    s_cmp_eq_u32 s33, 1
    s_cbranch_scc1 L_bwx3
    s_and_b32 s23, s2, 3
    s_lshl_b32 s23, s23, 3
    s_lshl_b32 s23, 1, s23
    v_mov_b32 v188, s23
    s_bfe_u32 s23, s2, 0x10002
    v_and_b32 v189, 1, v1
    v_cmp_eq_u32 vcc, s23, v189
    s_nop 1
    v_cndmask_b32 v188, 0, v188, vcc
    s_lshr_b32 s23, s2, 7
    v_bfe_u32 v189, v1, 1, 1
L_wk1_2:
    s_cbranch_execz L_wk1_ret
    v_cmp_eq_u32 vcc, s23, v189
    s_nop 1
    v_cndmask_b32 v188, 0, v188, vcc
    v_lshlrev_b32 v188, 3, v188
    v_lshlrev_b32 v189, 2, v1
    s_mov_b32 s23, 0
L_bcp3:
    buffer_load_dword v2, v189, s[4:7], s39 offen sc1
    s_add_u32 s23, s23, 1
    s_cmp_gt_u32 s23, 400000
    s_cbranch_scc1 L_bcq3
    s_waitcnt vmcnt(0)
    v_and_b32 v2, v2, v188
    v_cmp_ne_u32 vcc, v2, v188
    s_nop 4
    s_cbranch_vccnz L_bcp3
L_bcq3:
    s_waitcnt vmcnt(0)
    s_branch L_bwx3
L_bg3:
    s_cmp_eq_u32 s24, 0
    s_cbranch_scc0 L_bwx3
    v_mul_u32_u24 v189, 256, v1
    s_mov_b32 s23, 0
    s_mov_b64 exec, s[36:37]
L_bwpx3:
    buffer_load_dword v2, v189, s[4:7], s41 offen sc1
    s_add_u32 s23, s23, 1
    s_cmp_gt_u32 s23, 400000
    s_cbranch_scc1 L_bwqx3
    s_waitcnt vmcnt(0)
    v_cmp_gt_u32 vcc, 4, v2
    s_nop 4
    s_and_b64 exec, exec, vcc
    s_cbranch_execnz L_bwpx3
L_bwqx3:
    s_waitcnt vmcnt(0)
    s_mov_b64 exec, -1
L_bwx3:
    s_waitcnt lgkmcnt(0)
    s_barrier
    s_add_u32 m0, s47, 0
    s_nop 0
    buffer_load_dwordx4 v7, s[4:7], s46 offen offset:0 sc1 lds
    buffer_load_dwordx4 v7, s[4:7], s46 offen offset:1024 sc1 lds
    buffer_load_dwordx4 v7, s[4:7], s46 offen offset:2048 sc1 lds
    buffer_load_dwordx4 v7, s[4:7], s46 offen offset:3072 sc1 lds
    s_add_u32 m0, s47, 16384
    s_nop 0
    buffer_load_dwordx4 v7, s[4:7], s43 offen offset:0 sc1 lds
    buffer_load_dwordx4 v7, s[4:7], s43 offen offset:1024 sc1 lds
    buffer_load_dwordx4 v7, s[4:7], s43 offen offset:2048 sc1 lds
    buffer_load_dwordx4 v7, s[4:7], s43 offen offset:3072 sc1 lds
    ds_read_b64_tr_b16 v[48:49], v8 offset:0
    ds_read_b64_tr_b16 v[50:51], v8 offset:512
    ds_read_b64_tr_b16 v[52:53], v8 offset:1024
    ds_read_b64_tr_b16 v[54:55], v8 offset:1536
    s_waitcnt lgkmcnt(0)
    v_lshlrev_b32 v32, 16, v48
    v_and_b32 v33, 0xffff0000, v48
    v_lshlrev_b32 v34, 16, v49
    v_and_b32 v35, 0xffff0000, v49
    v_lshlrev_b32 v36, 16, v50
    v_and_b32 v37, 0xffff0000, v50
    v_lshlrev_b32 v38, 16, v51
    v_and_b32 v39, 0xffff0000, v51
    v_lshlrev_b32 v40, 16, v52
    v_and_b32 v41, 0xffff0000, v52
    v_lshlrev_b32 v42, 16, v53
    v_and_b32 v43, 0xffff0000, v53
    v_lshlrev_b32 v44, 16, v54
    v_and_b32 v45, 0xffff0000, v54
    v_lshlrev_b32 v46, 16, v55
    v_and_b32 v47, 0xffff0000, v55
    s_waitcnt vmcnt(4)
    s_barrier
    ds_read_b128 v[56:59], v185 offset:0
    ds_read_b128 v[60:63], v185 offset:1024
    ds_read_b128 v[64:67], v185 offset:2048
    ds_read_b128 v[68:71], v185 offset:3072
    ds_read_b128 v[72:75], v185 offset:4096
    ds_read_b128 v[76:79], v185 offset:5120
    ds_read_b128 v[80:83], v185 offset:6144
    ds_read_b128 v[84:87], v185 offset:7168
    s_waitcnt lgkmcnt(7)
    v_mfma_f32_32x32x16_bf16 v[16:31], a[192:195], v[56:59], v[32:47]
    ds_read_b128 v[88:91], v185 offset:8192
    s_waitcnt lgkmcnt(7)
    v_mfma_f32_32x32x16_bf16 v[16:31], a[196:199], v[60:63], v[16:31]
    ds_read_b128 v[92:95], v185 offset:9216
    s_waitcnt lgkmcnt(7)
    v_mfma_f32_32x32x16_bf16 v[16:31], a[200:203], v[64:67], v[16:31]
    ds_read_b128 v[96:99], v185 offset:10240
    s_waitcnt lgkmcnt(7)
    v_mfma_f32_32x32x16_bf16 v[16:31], a[204:207], v[68:71], v[16:31]
    ds_read_b128 v[100:103], v185 offset:11264
    s_waitcnt lgkmcnt(7)
    v_mfma_f32_32x32x16_bf16 v[16:31], a[208:211], v[72:75], v[16:31]
    ds_read_b128 v[104:107], v185 offset:12288
    s_waitcnt lgkmcnt(7)
    v_mfma_f32_32x32x16_bf16 v[16:31], a[212:215], v[76:79], v[16:31]
    ds_read_b128 v[108:111], v185 offset:13312
    s_waitcnt lgkmcnt(7)
    v_mfma_f32_32x32x16_bf16 v[16:31], a[216:219], v[80:83], v[16:31]
    ds_read_b128 v[112:115], v185 offset:14336
    s_waitcnt lgkmcnt(7)
    v_mfma_f32_32x32x16_bf16 v[16:31], a[220:223], v[84:87], v[16:31]
    ds_read_b128 v[116:119], v185 offset:15360
    s_waitcnt lgkmcnt(7)
    v_mfma_f32_32x32x16_bf16 v[16:31], a[224:227], v[88:91], v[16:31]
    s_waitcnt vmcnt(0)
    s_barrier
    ds_read_b128 v[120:123], v185 offset:16384
    s_waitcnt lgkmcnt(7)
    v_mfma_f32_32x32x16_bf16 v[16:31], a[228:231], v[92:95], v[16:31]
    ds_read_b128 v[124:127], v185 offset:17408
    s_waitcnt lgkmcnt(7)
    v_mfma_f32_32x32x16_bf16 v[16:31], a[232:235], v[96:99], v[16:31]
    ds_read_b128 v[128:131], v185 offset:18432
    s_waitcnt lgkmcnt(7)
    v_mfma_f32_32x32x16_bf16 v[16:31], a[236:239], v[100:103], v[16:31]
    ds_read_b128 v[132:135], v185 offset:19456
    s_waitcnt lgkmcnt(7)
    v_mfma_f32_32x32x16_bf16 v[16:31], a[240:243], v[104:107], v[16:31]
    ds_read_b128 v[136:139], v185 offset:20480
    s_waitcnt lgkmcnt(7)
    v_mfma_f32_32x32x16_bf16 v[16:31], a[244:247], v[108:111], v[16:31]
    ds_read_b128 v[140:143], v185 offset:21504
    s_waitcnt lgkmcnt(7)
    v_mfma_f32_32x32x16_bf16 v[16:31], a[248:251], v[112:115], v[16:31]
    ds_read_b128 v[144:147], v185 offset:22528
    s_waitcnt lgkmcnt(7)
    v_mfma_f32_32x32x16_bf16 v[16:31], a[252:255], v[116:119], v[16:31]
    ds_read_b128 v[148:151], v185 offset:23552
    s_waitcnt lgkmcnt(7)
    v_mfma_f32_32x32x16_bf16 v[16:31], v[192:195], v[120:123], v[16:31]
    ds_read_b128 v[152:155], v185 offset:24576
    s_waitcnt lgkmcnt(7)
    v_mfma_f32_32x32x16_bf16 v[16:31], v[196:199], v[124:127], v[16:31]
    ds_read_b128 v[156:159], v185 offset:25600
    s_waitcnt lgkmcnt(7)
    v_mfma_f32_32x32x16_bf16 v[16:31], v[200:203], v[128:131], v[16:31]
    ds_read_b128 v[160:163], v185 offset:26624
    s_waitcnt lgkmcnt(7)
    v_mfma_f32_32x32x16_bf16 v[16:31], v[204:207], v[132:135], v[16:31]
    ds_read_b128 v[164:167], v185 offset:27648
    s_waitcnt lgkmcnt(7)
    v_mfma_f32_32x32x16_bf16 v[16:31], v[208:211], v[136:139], v[16:31]
    ds_read_b128 v[168:171], v185 offset:28672
    s_waitcnt lgkmcnt(7)
    v_mfma_f32_32x32x16_bf16 v[16:31], v[212:215], v[140:143], v[16:31]
    ds_read_b128 v[172:175], v185 offset:29696
    s_waitcnt lgkmcnt(7)
    v_mfma_f32_32x32x16_bf16 v[16:31], v[216:219], v[144:147], v[16:31]
    ds_read_b128 v[176:179], v185 offset:30720
    s_waitcnt lgkmcnt(7)
    v_mfma_f32_32x32x16_bf16 v[16:31], v[220:223], v[148:151], v[16:31]
    ds_read_b128 v[180:183], v185 offset:31744
    s_waitcnt lgkmcnt(7)
    v_mfma_f32_32x32x16_bf16 v[16:31], v[224:227], v[152:155], v[16:31]
    s_waitcnt lgkmcnt(6)
    v_mfma_f32_32x32x16_bf16 v[16:31], v[228:231], v[156:159], v[16:31]
    s_waitcnt lgkmcnt(5)
    v_mfma_f32_32x32x16_bf16 v[16:31], v[232:235], v[160:163], v[16:31]
    s_waitcnt lgkmcnt(4)
    v_mfma_f32_32x32x16_bf16 v[16:31], v[236:239], v[164:167], v[16:31]
    s_waitcnt lgkmcnt(3)
    v_mfma_f32_32x32x16_bf16 v[16:31], v[240:243], v[168:171], v[16:31]
    s_waitcnt lgkmcnt(2)
    v_mfma_f32_32x32x16_bf16 v[16:31], v[244:247], v[172:175], v[16:31]
    s_waitcnt lgkmcnt(1)
    v_mfma_f32_32x32x16_bf16 v[16:31], v[248:251], v[176:179], v[16:31]
    s_waitcnt lgkmcnt(0)
    v_mfma_f32_32x32x16_bf16 v[16:31], v[252:255], v[180:183], v[16:31]
    s_nop 11
    v_cvt_pk_bf16_f32 v56, v16, v17
    v_cvt_pk_bf16_f32 v57, v18, v19
    v_cvt_pk_bf16_f32 v58, v20, v21
    v_cvt_pk_bf16_f32 v59, v22, v23
    v_cvt_pk_bf16_f32 v60, v24, v25
    v_cvt_pk_bf16_f32 v61, v26, v27
    v_cvt_pk_bf16_f32 v62, v28, v29
    v_cvt_pk_bf16_f32 v63, v30, v31
    s_mul_i32 s27, s24, 2304
    s_add_u32 s27, s27, 74752
    v_mul_u32_u24 v8, 72, v184
    v_lshl_add_u32 v8, v186, 3, v8
    v_add_u32 v8, s27, v8
    ds_write_b64 v8, v[56:57] offset:0
    ds_write_b64 v8, v[58:59] offset:16
    ds_write_b64 v8, v[60:61] offset:32
    ds_write_b64 v8, v[62:63] offset:48
    v_bfe_u32 v8, v0, 2, 2
    v_lshl_add_u32 v8, v4, 3, v8
    v_mul_u32_u24 v8, 72, v8
    v_lshl_add_u32 v8, v9, 3, v8
    v_add_u32 v8, s27, v8
    v_lshlrev_b32 v32, 16, v56
    v_and_b32 v33, 0xffff0000, v56
    v_lshlrev_b32 v34, 16, v57
    v_and_b32 v35, 0xffff0000, v57
    v_lshlrev_b32 v36, 16, v58
    v_and_b32 v37, 0xffff0000, v58
    v_lshlrev_b32 v38, 16, v59
    v_and_b32 v39, 0xffff0000, v59
    v_lshlrev_b32 v40, 16, v60
    v_and_b32 v41, 0xffff0000, v60
    v_lshlrev_b32 v42, 16, v61
    v_and_b32 v43, 0xffff0000, v61
    v_lshlrev_b32 v44, 16, v62
    v_and_b32 v45, 0xffff0000, v62
    v_lshlrev_b32 v46, 16, v63
    v_and_b32 v47, 0xffff0000, v63
    s_waitcnt lgkmcnt(0)
    ds_read_b64_tr_b16 v[48:49], v8 offset:0
    ds_read_b64_tr_b16 v[50:51], v8 offset:288
    ds_read_b64_tr_b16 v[52:53], v8 offset:32
    ds_read_b64_tr_b16 v[54:55], v8 offset:320
    v_lshlrev_b32 v5, 6, v3
    v_lshl_add_u32 v5, v4, 4, v5
    s_lshl_b32 s27, s25, 15
    s_lshl_b32 s28, s26, 11
    s_add_u32 s27, s27, s28
    s_add_u32 s27, s27, 6422528
    v_pk_add_f32 v[12:13], v[32:33], v[34:35]
    v_pk_mul_f32 v[14:15], v[32:33], v[32:33]
    v_pk_fma_f32 v[14:15], v[34:35], v[34:35], v[14:15]
    v_pk_add_f32 v[12:13], v[12:13], v[36:37]
    v_pk_fma_f32 v[14:15], v[36:37], v[36:37], v[14:15]
    v_pk_add_f32 v[12:13], v[12:13], v[38:39]
    v_pk_fma_f32 v[14:15], v[38:39], v[38:39], v[14:15]
    v_pk_add_f32 v[12:13], v[12:13], v[40:41]
    v_pk_fma_f32 v[14:15], v[40:41], v[40:41], v[14:15]
    s_waitcnt lgkmcnt(2)
    buffer_store_dwordx4 v[48:51], v5, s[4:7], s27 offen sc1
    s_waitcnt lgkmcnt(0)
    buffer_store_dwordx4 v[52:55], v5, s[4:7], s27 offen offset:1024 sc1
    v_pk_add_f32 v[12:13], v[12:13], v[42:43]
    v_pk_fma_f32 v[14:15], v[42:43], v[42:43], v[14:15]
    v_pk_add_f32 v[12:13], v[12:13], v[44:45]
    v_pk_fma_f32 v[14:15], v[44:45], v[44:45], v[14:15]
    v_pk_add_f32 v[12:13], v[12:13], v[46:47]
    v_pk_fma_f32 v[14:15], v[46:47], v[46:47], v[14:15]
    v_add_f32 v12, v12, v13
    v_add_f32 v14, v14, v15
    v_lshlrev_b32 v13, 2, v9
    v_lshl_add_u32 v13, v186, 13, v13
    v_bfe_u32 v15, v0, 2, 1
    v_lshl_add_u32 v13, v15, 12, v13
    v_bfe_u32 v15, v0, 3, 2
    v_lshl_add_u32 v13, v15, 4, v13
    s_lshl_b32 s28, s25, 6
    s_add_u32 s28, s28, 21250048
    v_permlane32_swap_b32 v12, v14
    v_add_f32 v12, v12, v14
    s_lshl_b32 s27, s24, 2
    s_add_u32 s27, s27, 84992
    v_lshl_add_u32 v14, v1, 4, s27
    ds_write_b32 v14, v12
    v_lshlrev_b32 v14, 4, v1
    v_add_u32 v14, 84992, v14
    s_waitcnt lgkmcnt(0)
    s_barrier
    s_cmp_eq_u32 s24, 3
    s_cbranch_scc0 L_ost
    ds_read_b128 v[16:19], v14
    s_waitcnt lgkmcnt(0)
    v_add_f32 v16, v16, v17
    v_add_f32 v18, v18, v19
    v_add_f32 v12, v16, v18
    buffer_atomic_add_f32 v12, v13, s[4:7], s28 offen
L_ost:
    s_waitcnt vmcnt(0) lgkmcnt(0)
    s_barrier
    s_cmp_eq_u32 s24, 1
    s_cbranch_scc0 L_bs4
    v_mov_b32 v188, 31
    v_mov_b32 v189, 0
    s_mov_b64 exec, 1
    buffer_store_byte v188, v189, s[4:7], s38 offen
    s_mov_b64 exec, -1
L_bs4:
    s_cmp_eq_u32 s24, 1
    s_cbranch_scc0 L_wk4_skip
    s_mov_b64 exec, 0
    s_branch L_wk4_0
L_wk4_ret:
    s_mov_b64 exec, -1
L_wk4_skip:
    s_cmp_eq_u32 s33, 1
    s_cbranch_scc0 L_bl4
    v_lshlrev_b32 v188, 4, v191
    v_lshlrev_b32 v189, 2, v1
    s_mov_b32 s23, 0
L_blp4:
    buffer_load_dword v2, v189, s[4:7], s39 offen sc1
    s_add_u32 s23, s23, 1
    s_cmp_gt_u32 s23, 400000
    s_cbranch_scc1 L_blq4
    s_waitcnt vmcnt(0)
    v_and_b32 v2, v2, v188
    v_cmp_ne_u32 vcc, v2, v188
    s_nop 4
    s_cbranch_vccnz L_blp4
L_blq4:
    s_waitcnt vmcnt(0)
    v_mov_b32 v188, 5
    v_mul_u32_u24 v189, 2048, v1
    s_mov_b64 exec, s[36:37]
    buffer_store_dword v188, v189, s[4:7], s40 offen sc1
    s_mov_b64 exec, -1
L_bl4:
    s_lshr_b32 s25, s24, 1
    s_and_b32 s26, s24, 1
    v_lshrrev_b32 v6, 2, v0
    v_lshlrev_b32 v6, 15, v6
    v_and_b32 v7, 3, v0
    v_lshl_add_u32 v6, v7, 4, v6
    s_lshl_b32 s31, s18, 7
    s_add_u32 s31, s31, 6422528
    v_lshlrev_b32 v10, 4, v0
    s_mov_b32 s44, 21250048
    s_mov_b32 s45, 21254144
    s_mov_b32 s46, 21258240
    s_mov_b32 s47, 21262336
    v_lshlrev_b32 v7, 4, v1
    v_mov_b32 v12, 0
    v_mov_b32 v13, 0
    v_mov_b32 v14, 0
    v_mov_b32 v15, 0
    v_lshrrev_b32 v9, 5, v1
    v_mul_u32_u24 v9, 4608, v9
    v_and_b32 v11, 31, v0
    v_lshl_add_u32 v9, v11, 4, v9
    ds_write_b128 v9, v[12:15] offset:33792
    v_lshrrev_b32 v9, 2, v3
    v_mul_u32_u24 v9, 4160, v9
    v_and_b32 v11, 3, v0
    v_lshl_add_u32 v9, v11, 3, v9
    v_lshlrev_b32 v11, 4, v4
    v_sub_u32 v9, v9, v11
    s_mul_i32 s27, s25, 16640
    s_lshl_b32 s28, s26, 8
    s_add_u32 s27, s27, s28
    s_add_u32 s27, s27, 56
    v_add_u32 v9, s27, v9
    v_lshl_add_u32 v11, v3, 5, v11
    s_mul_i32 s27, s25, 4608
    s_sub_u32 s27, s27, s28
    s_add_u32 s27, s27, 34080
    v_add_u32 v11, s27, v11
    ds_read_b64_tr_b16 v[60:61], v9 offset:8
    ds_read_b64_tr_b16 v[62:63], v9 offset:0
    ds_read_b64_tr_b16 v[64:65], v9 offset:520
    ds_read_b64_tr_b16 v[66:67], v9 offset:512
    ds_read_b64_tr_b16 v[68:69], v9 offset:1032
    ds_read_b64_tr_b16 v[70:71], v9 offset:1024
    ds_read_b64_tr_b16 v[72:73], v9 offset:1544
    ds_read_b64_tr_b16 v[74:75], v9 offset:1536
    ds_read_b64_tr_b16 v[76:77], v9 offset:2056
    ds_read_b64_tr_b16 v[78:79], v9 offset:2048
    ds_read_b64_tr_b16 v[80:81], v9 offset:2568
    ds_read_b64_tr_b16 v[82:83], v9 offset:2560
    ds_read_b64_tr_b16 v[84:85], v9 offset:3080
    ds_read_b64_tr_b16 v[86:87], v9 offset:3072
    ds_read_b64_tr_b16 v[88:89], v9 offset:3592
    ds_read_b64_tr_b16 v[90:91], v9 offset:3584
    s_lshl_b32 s27, s24, 11
    s_add_u32 s27, s27, 43008
    v_lshlrev_b32 v8, 5, v3
    v_lshl_add_u32 v8, v4, 3, v8
    v_add_u32 v8, s27, v8
    s_lshl_b32 s27, s24, 12
    s_add_u32 s27, s27, 51200
    v_add_u32 v48, s27, v7
    s_xor_b32 s27, s24, 1
    s_lshl_b32 s27, s27, 12
    s_add_u32 s27, s27, 51200
    v_add_u32 v49, s27, v7
    v_and_b32 v50, 1, v4
    v_lshlrev_b32 v50, 18, v50
    v_lshrrev_b32 v51, 3, v3
    v_lshl_add_u32 v50, v51, 17, v50
    v_and_b32 v51, 7, v3
    v_lshl_add_u32 v50, v51, 5, v50
    v_lshrrev_b32 v51, 1, v4
    v_lshl_add_u32 v50, v51, 4, v50
    s_lshl_b32 s34, s18, 9
    s_lshl_b32 s27, s25, 8
    s_add_u32 s34, s34, s27
    s_lshl_b32 s27, s26, 20
    s_add_u32 s34, s34, s27
    s_add_u32 s34, s34, 8519680
    s_add_u32 s43, s34, 524288
    v_mov_b32 v12, 0x3b000000
    v_mov_b32 v14, 0x3727c5ac
    s_cmp_eq_u32 s24, 0
    s_cbranch_scc0 L_bw4
    v_mul_u32_u24 v189, 256, v1
    s_mov_b32 s23, 0
    s_mov_b64 exec, s[36:37]
L_bwp4:
    buffer_load_dword v2, v189, s[4:7], s41 offen sc1
    s_add_u32 s23, s23, 1
    s_cmp_gt_u32 s23, 400000
    s_cbranch_scc1 L_bwq4
    s_waitcnt vmcnt(0)
    v_cmp_gt_u32 vcc, 5, v2
    s_nop 4
    s_and_b64 exec, exec, vcc
    s_cbranch_execnz L_bwp4
L_bwq4:
    s_waitcnt vmcnt(0)
    s_mov_b64 exec, -1
L_bw4:
    s_waitcnt lgkmcnt(0)
    s_barrier
    buffer_load_dwordx4 v[16:19], v10, s[4:7], s44 offen sc1
    buffer_load_dwordx4 v[20:23], v10, s[4:7], s45 offen sc1
    buffer_load_dwordx4 v[24:27], v10, s[4:7], s46 offen sc1
    buffer_load_dwordx4 v[28:31], v10, s[4:7], s47 offen sc1
    buffer_load_dwordx4 v[32:35], v6, s[4:7], s31 offen sc1
    buffer_load_dwordx4 v[36:39], v6, s[4:7], s31 offen offset:64 sc1
    s_waitcnt vmcnt(2)
    v_pk_mul_f32 v[16:17], v[16:17], v[12:13] op_sel_hi:[1,0]
    v_pk_mul_f32 v[18:19], v[18:19], v[12:13] op_sel_hi:[1,0]
    v_pk_mul_f32 v[20:21], v[20:21], v[12:13] op_sel_hi:[1,0]
    v_pk_mul_f32 v[22:23], v[22:23], v[12:13] op_sel_hi:[1,0]
    v_pk_fma_f32 v[24:25], v[24:25], v[12:13], v[14:15] op_sel_hi:[1,0,0]
    v_pk_fma_f32 v[26:27], v[26:27], v[12:13], v[14:15] op_sel_hi:[1,0,0]
    v_pk_fma_f32 v[28:29], v[28:29], v[12:13], v[14:15] op_sel_hi:[1,0,0]
    v_pk_fma_f32 v[30:31], v[30:31], v[12:13], v[14:15] op_sel_hi:[1,0,0]
    v_pk_fma_f32 v[24:25], v[16:17], v[16:17], v[24:25] neg_lo:[1,0,0] neg_hi:[1,0,0]
    v_pk_fma_f32 v[26:27], v[18:19], v[18:19], v[26:27] neg_lo:[1,0,0] neg_hi:[1,0,0]
    v_pk_fma_f32 v[28:29], v[20:21], v[20:21], v[28:29] neg_lo:[1,0,0] neg_hi:[1,0,0]
    v_pk_fma_f32 v[30:31], v[22:23], v[22:23], v[30:31] neg_lo:[1,0,0] neg_hi:[1,0,0]
    v_max_f32 v24, v14, v24
    v_max_f32 v25, v14, v25
    v_max_f32 v26, v14, v26
    v_max_f32 v27, v14, v27
    v_max_f32 v28, v14, v28
    v_max_f32 v29, v14, v29
    v_max_f32 v30, v14, v30
    v_max_f32 v31, v14, v31
    v_rsq_f32 v24, v24
    v_rsq_f32 v25, v25
    v_rsq_f32 v26, v26
    v_rsq_f32 v27, v27
    v_rsq_f32 v28, v28
    v_rsq_f32 v29, v29
    v_rsq_f32 v30, v30
    v_rsq_f32 v31, v31
    v_pk_mul_f32 v[16:17], v[16:17], v[24:25] neg_lo:[1,0] neg_hi:[1,0]
    v_pk_mul_f32 v[18:19], v[18:19], v[26:27] neg_lo:[1,0] neg_hi:[1,0]
    v_pk_mul_f32 v[20:21], v[20:21], v[28:29] neg_lo:[1,0] neg_hi:[1,0]
    v_pk_mul_f32 v[22:23], v[22:23], v[30:31] neg_lo:[1,0] neg_hi:[1,0]
    s_waitcnt vmcnt(0)
    v_lshlrev_b32 v40, 16, v32
    v_and_b32 v41, 0xffff0000, v32
    v_lshlrev_b32 v42, 16, v33
    v_and_b32 v43, 0xffff0000, v33
    v_lshlrev_b32 v44, 16, v34
    v_and_b32 v45, 0xffff0000, v34
    v_lshlrev_b32 v46, 16, v35
    v_and_b32 v47, 0xffff0000, v35
    v_pk_fma_f32 v[40:41], v[40:41], v[24:25], v[16:17]
    v_pk_fma_f32 v[42:43], v[42:43], v[26:27], v[18:19]
    v_pk_fma_f32 v[44:45], v[44:45], v[28:29], v[20:21]
    v_pk_fma_f32 v[46:47], v[46:47], v[30:31], v[22:23]
    v_cvt_pk_bf16_f32 v52, v40, v41
    v_cvt_pk_bf16_f32 v53, v42, v43
    v_cvt_pk_bf16_f32 v54, v44, v45
    v_cvt_pk_bf16_f32 v55, v46, v47
    ds_write_b128 v10, v[52:55] offset:34304
    v_lshlrev_b32 v40, 16, v36
    v_and_b32 v41, 0xffff0000, v36
    v_lshlrev_b32 v42, 16, v37
    v_and_b32 v43, 0xffff0000, v37
    v_lshlrev_b32 v44, 16, v38
    v_and_b32 v45, 0xffff0000, v38
    v_lshlrev_b32 v46, 16, v39
    v_and_b32 v47, 0xffff0000, v39
    v_pk_fma_f32 v[40:41], v[40:41], v[24:25], v[16:17]
    v_pk_fma_f32 v[42:43], v[42:43], v[26:27], v[18:19]
    v_pk_fma_f32 v[44:45], v[44:45], v[28:29], v[20:21]
    v_pk_fma_f32 v[46:47], v[46:47], v[30:31], v[22:23]
    v_cvt_pk_bf16_f32 v56, v40, v41
    v_cvt_pk_bf16_f32 v57, v42, v43
    v_cvt_pk_bf16_f32 v58, v44, v45
    v_cvt_pk_bf16_f32 v59, v46, v47
    ds_write_b128 v10, v[56:59] offset:38912
    ds_write_b128 v10, v[32:35] offset:43008
    ds_write_b128 v10, v[36:39] offset:47104
    s_waitcnt lgkmcnt(0)
    s_barrier
    ds_read_b128 v[92:95], v11 offset:192
    ds_read_b128 v[96:99], v11 offset:704
    ds_read_b128 v[100:103], v11 offset:1216
    ds_read_b128 v[104:107], v11 offset:1728
    ds_read_b128 v[108:111], v11 offset:2240
    ds_read_b128 v[112:115], v11 offset:2752
    ds_read_b128 v[116:119], v11 offset:3264
    ds_read_b128 v[120:123], v11 offset:3776
    s_waitcnt lgkmcnt(7)
    v_mfma_f32_16x16x32_bf16 v[16:19], v[60:63], v[92:95], 0
    ds_read_b64_tr_b16 v[124:125], v9 offset:72
    s_waitcnt lgkmcnt(7)
    v_mfma_f32_16x16x32_bf16 v[20:23], v[60:63], v[96:99], 0
    ds_read_b64_tr_b16 v[126:127], v9 offset:64
    s_waitcnt lgkmcnt(7)
    v_mfma_f32_16x16x32_bf16 v[24:27], v[60:63], v[100:103], 0
    ds_read_b128 v[156:159], v11 offset:128
    s_waitcnt lgkmcnt(7)
    v_mfma_f32_16x16x32_bf16 v[28:31], v[60:63], v[104:107], 0
    ds_read_b128 v[160:163], v11 offset:640
    s_waitcnt lgkmcnt(7)
    v_mfma_f32_16x16x32_bf16 v[32:35], v[60:63], v[108:111], 0
    ds_read_b128 v[164:167], v11 offset:1152
    s_waitcnt lgkmcnt(7)
    v_mfma_f32_16x16x32_bf16 v[36:39], v[60:63], v[112:115], 0
    ds_read_b128 v[168:171], v11 offset:1664
    s_waitcnt lgkmcnt(7)
    v_mfma_f32_16x16x32_bf16 v[40:43], v[60:63], v[116:119], 0
    ds_read_b128 v[172:175], v11 offset:2176
    s_waitcnt lgkmcnt(7)
    v_mfma_f32_16x16x32_bf16 v[44:47], v[60:63], v[120:123], 0
    ds_read_b128 v[176:179], v11 offset:2688
    v_mfma_f32_16x16x32_bf16 v[20:23], v[64:67], v[92:95], v[20:23]
    ds_read_b128 v[180:183], v11 offset:3200
    v_mfma_f32_16x16x32_bf16 v[24:27], v[64:67], v[96:99], v[24:27]
    ds_read_b128 v[184:187], v11 offset:3712
    v_mfma_f32_16x16x32_bf16 v[28:31], v[64:67], v[100:103], v[28:31]
    ds_read_b64_tr_b16 v[128:129], v9 offset:584
    v_mfma_f32_16x16x32_bf16 v[32:35], v[64:67], v[104:107], v[32:35]
    ds_read_b64_tr_b16 v[130:131], v9 offset:576
    v_mfma_f32_16x16x32_bf16 v[36:39], v[64:67], v[108:111], v[36:39]
    ds_read_b64_tr_b16 v[132:133], v9 offset:1096
    v_mfma_f32_16x16x32_bf16 v[40:43], v[64:67], v[112:115], v[40:43]
    ds_read_b64_tr_b16 v[134:135], v9 offset:1088
    v_mfma_f32_16x16x32_bf16 v[44:47], v[64:67], v[116:119], v[44:47]
    ds_read_b64_tr_b16 v[136:137], v9 offset:1608
    v_mfma_f32_16x16x32_bf16 v[24:27], v[68:71], v[92:95], v[24:27]
    ds_read_b64_tr_b16 v[138:139], v9 offset:1600
    v_mfma_f32_16x16x32_bf16 v[28:31], v[68:71], v[96:99], v[28:31]
    ds_read_b64_tr_b16 v[140:141], v9 offset:2120
    v_mfma_f32_16x16x32_bf16 v[32:35], v[68:71], v[100:103], v[32:35]
    ds_read_b64_tr_b16 v[142:143], v9 offset:2112
    v_mfma_f32_16x16x32_bf16 v[36:39], v[68:71], v[104:107], v[36:39]
    ds_read_b64_tr_b16 v[144:145], v9 offset:2632
    v_mfma_f32_16x16x32_bf16 v[40:43], v[68:71], v[108:111], v[40:43]
    ds_read_b64_tr_b16 v[146:147], v9 offset:2624
    v_mfma_f32_16x16x32_bf16 v[44:47], v[68:71], v[112:115], v[44:47]
    ds_read_b64_tr_b16 v[148:149], v9 offset:3144
    v_mfma_f32_16x16x32_bf16 v[28:31], v[72:75], v[92:95], v[28:31]
    ds_read_b64_tr_b16 v[150:151], v9 offset:3136
    v_mfma_f32_16x16x32_bf16 v[32:35], v[72:75], v[96:99], v[32:35]
    ds_read_b64_tr_b16 v[152:153], v9 offset:3656
    v_mfma_f32_16x16x32_bf16 v[36:39], v[72:75], v[100:103], v[36:39]
    ds_read_b64_tr_b16 v[154:155], v9 offset:3648
    v_mfma_f32_16x16x32_bf16 v[40:43], v[72:75], v[104:107], v[40:43]
    v_mfma_f32_16x16x32_bf16 v[44:47], v[72:75], v[108:111], v[44:47]
    v_mfma_f32_16x16x32_bf16 v[32:35], v[76:79], v[92:95], v[32:35]
    v_mfma_f32_16x16x32_bf16 v[36:39], v[76:79], v[96:99], v[36:39]
    v_mfma_f32_16x16x32_bf16 v[40:43], v[76:79], v[100:103], v[40:43]
    v_mfma_f32_16x16x32_bf16 v[44:47], v[76:79], v[104:107], v[44:47]
    v_mfma_f32_16x16x32_bf16 v[36:39], v[80:83], v[92:95], v[36:39]
    v_mfma_f32_16x16x32_bf16 v[40:43], v[80:83], v[96:99], v[40:43]
    v_mfma_f32_16x16x32_bf16 v[44:47], v[80:83], v[100:103], v[44:47]
    v_mfma_f32_16x16x32_bf16 v[40:43], v[84:87], v[92:95], v[40:43]
    v_mfma_f32_16x16x32_bf16 v[44:47], v[84:87], v[96:99], v[44:47]
    v_mfma_f32_16x16x32_bf16 v[44:47], v[88:91], v[92:95], v[44:47]
    s_waitcnt lgkmcnt(0)
    v_mfma_f32_16x16x32_bf16 v[16:19], v[124:127], v[156:159], v[16:19]
    ds_read_b64_tr_b16 v[60:61], v9 offset:136
    v_mfma_f32_16x16x32_bf16 v[20:23], v[124:127], v[160:163], v[20:23]
    ds_read_b64_tr_b16 v[62:63], v9 offset:128
    v_mfma_f32_16x16x32_bf16 v[24:27], v[124:127], v[164:167], v[24:27]
    ds_read_b128 v[92:95], v11 offset:64
    v_mfma_f32_16x16x32_bf16 v[28:31], v[124:127], v[168:171], v[28:31]
    ds_read_b128 v[96:99], v11 offset:576
    v_mfma_f32_16x16x32_bf16 v[32:35], v[124:127], v[172:175], v[32:35]
    ds_read_b128 v[100:103], v11 offset:1088
    v_mfma_f32_16x16x32_bf16 v[36:39], v[124:127], v[176:179], v[36:39]
    ds_read_b128 v[104:107], v11 offset:1600
    v_mfma_f32_16x16x32_bf16 v[40:43], v[124:127], v[180:183], v[40:43]
    ds_read_b128 v[108:111], v11 offset:2112
    v_mfma_f32_16x16x32_bf16 v[44:47], v[124:127], v[184:187], v[44:47]
    ds_read_b128 v[112:115], v11 offset:2624
    v_mfma_f32_16x16x32_bf16 v[20:23], v[128:131], v[156:159], v[20:23]
    ds_read_b128 v[116:119], v11 offset:3136
    v_mfma_f32_16x16x32_bf16 v[24:27], v[128:131], v[160:163], v[24:27]
    ds_read_b128 v[120:123], v11 offset:3648
    v_mfma_f32_16x16x32_bf16 v[28:31], v[128:131], v[164:167], v[28:31]
    ds_read_b64_tr_b16 v[64:65], v9 offset:648
    v_mfma_f32_16x16x32_bf16 v[32:35], v[128:131], v[168:171], v[32:35]
    ds_read_b64_tr_b16 v[66:67], v9 offset:640
    v_mfma_f32_16x16x32_bf16 v[36:39], v[128:131], v[172:175], v[36:39]
    ds_read_b64_tr_b16 v[68:69], v9 offset:1160
    v_mfma_f32_16x16x32_bf16 v[40:43], v[128:131], v[176:179], v[40:43]
    ds_read_b64_tr_b16 v[70:71], v9 offset:1152
    v_mfma_f32_16x16x32_bf16 v[44:47], v[128:131], v[180:183], v[44:47]
    ds_read_b64_tr_b16 v[72:73], v9 offset:1672
    v_mfma_f32_16x16x32_bf16 v[24:27], v[132:135], v[156:159], v[24:27]
    ds_read_b64_tr_b16 v[74:75], v9 offset:1664
    v_mfma_f32_16x16x32_bf16 v[28:31], v[132:135], v[160:163], v[28:31]
    ds_read_b64_tr_b16 v[76:77], v9 offset:2184
    v_mfma_f32_16x16x32_bf16 v[32:35], v[132:135], v[164:167], v[32:35]
    ds_read_b64_tr_b16 v[78:79], v9 offset:2176
    v_mfma_f32_16x16x32_bf16 v[36:39], v[132:135], v[168:171], v[36:39]
    ds_read_b64_tr_b16 v[80:81], v9 offset:2696
    v_mfma_f32_16x16x32_bf16 v[40:43], v[132:135], v[172:175], v[40:43]
    ds_read_b64_tr_b16 v[82:83], v9 offset:2688
    v_mfma_f32_16x16x32_bf16 v[44:47], v[132:135], v[176:179], v[44:47]
    ds_read_b64_tr_b16 v[84:85], v9 offset:3208
    v_mfma_f32_16x16x32_bf16 v[28:31], v[136:139], v[156:159], v[28:31]
    ds_read_b64_tr_b16 v[86:87], v9 offset:3200
    v_mfma_f32_16x16x32_bf16 v[32:35], v[136:139], v[160:163], v[32:35]
    ds_read_b64_tr_b16 v[88:89], v9 offset:3720
    v_mfma_f32_16x16x32_bf16 v[36:39], v[136:139], v[164:167], v[36:39]
    ds_read_b64_tr_b16 v[90:91], v9 offset:3712
    v_mfma_f32_16x16x32_bf16 v[40:43], v[136:139], v[168:171], v[40:43]
    v_mfma_f32_16x16x32_bf16 v[44:47], v[136:139], v[172:175], v[44:47]
    v_mfma_f32_16x16x32_bf16 v[32:35], v[140:143], v[156:159], v[32:35]
    v_mfma_f32_16x16x32_bf16 v[36:39], v[140:143], v[160:163], v[36:39]
    v_mfma_f32_16x16x32_bf16 v[40:43], v[140:143], v[164:167], v[40:43]
    v_mfma_f32_16x16x32_bf16 v[44:47], v[140:143], v[168:171], v[44:47]
    v_mfma_f32_16x16x32_bf16 v[36:39], v[144:147], v[156:159], v[36:39]
    v_mfma_f32_16x16x32_bf16 v[40:43], v[144:147], v[160:163], v[40:43]
    v_mfma_f32_16x16x32_bf16 v[44:47], v[144:147], v[164:167], v[44:47]
    v_mfma_f32_16x16x32_bf16 v[40:43], v[148:151], v[156:159], v[40:43]
    v_mfma_f32_16x16x32_bf16 v[44:47], v[148:151], v[160:163], v[44:47]
    v_mfma_f32_16x16x32_bf16 v[44:47], v[152:155], v[156:159], v[44:47]
    s_waitcnt lgkmcnt(0)
    v_mfma_f32_16x16x32_bf16 v[16:19], v[60:63], v[92:95], v[16:19]
    ds_read_b64_tr_b16 v[124:125], v9 offset:200
    v_mfma_f32_16x16x32_bf16 v[20:23], v[60:63], v[96:99], v[20:23]
    ds_read_b64_tr_b16 v[126:127], v9 offset:192
    v_mfma_f32_16x16x32_bf16 v[24:27], v[60:63], v[100:103], v[24:27]
    ds_read_b128 v[156:159], v11 offset:0
    v_mfma_f32_16x16x32_bf16 v[28:31], v[60:63], v[104:107], v[28:31]
    ds_read_b128 v[160:163], v11 offset:512
    v_mfma_f32_16x16x32_bf16 v[32:35], v[60:63], v[108:111], v[32:35]
    ds_read_b128 v[164:167], v11 offset:1024
    v_mfma_f32_16x16x32_bf16 v[36:39], v[60:63], v[112:115], v[36:39]
    ds_read_b128 v[168:171], v11 offset:1536
L_wk4_0:
    s_cbranch_execz L_wk4_1
    v_mfma_f32_16x16x32_bf16 v[40:43], v[60:63], v[116:119], v[40:43]
    ds_read_b128 v[172:175], v11 offset:2048
    v_mfma_f32_16x16x32_bf16 v[44:47], v[60:63], v[120:123], v[44:47]
    ds_read_b128 v[176:179], v11 offset:2560
    v_mfma_f32_16x16x32_bf16 v[20:23], v[64:67], v[92:95], v[20:23]
    ds_read_b128 v[180:183], v11 offset:3072
    v_mfma_f32_16x16x32_bf16 v[24:27], v[64:67], v[96:99], v[24:27]
    ds_read_b128 v[184:187], v11 offset:3584
    v_mfma_f32_16x16x32_bf16 v[28:31], v[64:67], v[100:103], v[28:31]
    ds_read_b64_tr_b16 v[128:129], v9 offset:712
    v_mfma_f32_16x16x32_bf16 v[32:35], v[64:67], v[104:107], v[32:35]
    ds_read_b64_tr_b16 v[130:131], v9 offset:704
    v_mfma_f32_16x16x32_bf16 v[36:39], v[64:67], v[108:111], v[36:39]
    ds_read_b64_tr_b16 v[132:133], v9 offset:1224
    v_mfma_f32_16x16x32_bf16 v[40:43], v[64:67], v[112:115], v[40:43]
    ds_read_b64_tr_b16 v[134:135], v9 offset:1216
    v_mfma_f32_16x16x32_bf16 v[44:47], v[64:67], v[116:119], v[44:47]
    ds_read_b64_tr_b16 v[136:137], v9 offset:1736
    v_mfma_f32_16x16x32_bf16 v[24:27], v[68:71], v[92:95], v[24:27]
    ds_read_b64_tr_b16 v[138:139], v9 offset:1728
    v_mfma_f32_16x16x32_bf16 v[28:31], v[68:71], v[96:99], v[28:31]
    ds_read_b64_tr_b16 v[140:141], v9 offset:2248
    v_mfma_f32_16x16x32_bf16 v[32:35], v[68:71], v[100:103], v[32:35]
    ds_read_b64_tr_b16 v[142:143], v9 offset:2240
    v_mfma_f32_16x16x32_bf16 v[36:39], v[68:71], v[104:107], v[36:39]
    ds_read_b64_tr_b16 v[144:145], v9 offset:2760
    v_mfma_f32_16x16x32_bf16 v[40:43], v[68:71], v[108:111], v[40:43]
    ds_read_b64_tr_b16 v[146:147], v9 offset:2752
    v_mfma_f32_16x16x32_bf16 v[44:47], v[68:71], v[112:115], v[44:47]
    ds_read_b64_tr_b16 v[148:149], v9 offset:3272
    v_mfma_f32_16x16x32_bf16 v[28:31], v[72:75], v[92:95], v[28:31]
    ds_read_b64_tr_b16 v[150:151], v9 offset:3264
    v_mfma_f32_16x16x32_bf16 v[32:35], v[72:75], v[96:99], v[32:35]
    ds_read_b64_tr_b16 v[152:153], v9 offset:3784
    v_mfma_f32_16x16x32_bf16 v[36:39], v[72:75], v[100:103], v[36:39]
    ds_read_b64_tr_b16 v[154:155], v9 offset:3776
    v_mfma_f32_16x16x32_bf16 v[40:43], v[72:75], v[104:107], v[40:43]
    v_mfma_f32_16x16x32_bf16 v[44:47], v[72:75], v[108:111], v[44:47]
    v_mfma_f32_16x16x32_bf16 v[32:35], v[76:79], v[92:95], v[32:35]
    v_mfma_f32_16x16x32_bf16 v[36:39], v[76:79], v[96:99], v[36:39]
    v_mfma_f32_16x16x32_bf16 v[40:43], v[76:79], v[100:103], v[40:43]
    v_mfma_f32_16x16x32_bf16 v[44:47], v[76:79], v[104:107], v[44:47]
    v_mfma_f32_16x16x32_bf16 v[36:39], v[80:83], v[92:95], v[36:39]
    v_mfma_f32_16x16x32_bf16 v[40:43], v[80:83], v[96:99], v[40:43]
    v_mfma_f32_16x16x32_bf16 v[44:47], v[80:83], v[100:103], v[44:47]
    v_mfma_f32_16x16x32_bf16 v[40:43], v[84:87], v[92:95], v[40:43]
    v_mfma_f32_16x16x32_bf16 v[44:47], v[84:87], v[96:99], v[44:47]
    v_mfma_f32_16x16x32_bf16 v[44:47], v[88:91], v[92:95], v[44:47]
    s_waitcnt lgkmcnt(0)
    s_cmp_eq_u32 s26, 0
    s_cbranch_scc0 L_c1h1
    v_mfma_f32_16x16x32_bf16 v[32:35], v[124:127], v[172:175], v[32:35]
    ds_read_b64 v[60:61], v8 offset:0
    v_mfma_f32_16x16x32_bf16 v[36:39], v[124:127], v[176:179], v[36:39]
    ds_read_b64 v[62:63], v8 offset:512
    v_mfma_f32_16x16x32_bf16 v[40:43], v[124:127], v[180:183], v[40:43]
    ds_read_b64 v[64:65], v8 offset:1024
    v_mfma_f32_16x16x32_bf16 v[44:47], v[124:127], v[184:187], v[44:47]
    ds_read_b64 v[66:67], v8 offset:1536
    v_mfma_f32_16x16x32_bf16 v[32:35], v[128:131], v[168:171], v[32:35]
    v_mfma_f32_16x16x32_bf16 v[36:39], v[128:131], v[172:175], v[36:39]
    v_mfma_f32_16x16x32_bf16 v[40:43], v[128:131], v[176:179], v[40:43]
    v_mfma_f32_16x16x32_bf16 v[44:47], v[128:131], v[180:183], v[44:47]
    s_waitcnt lgkmcnt(0)
    v_mfma_f32_16x16x32_bf16 v[32:35], v[132:135], v[164:167], v[32:35]
    v_lshlrev_b32 v68, 16, v60
    v_mfma_f32_16x16x32_bf16 v[36:39], v[132:135], v[168:171], v[36:39]
    v_and_b32 v69, 0xffff0000, v60
    v_mfma_f32_16x16x32_bf16 v[40:43], v[132:135], v[172:175], v[40:43]
    v_lshlrev_b32 v70, 16, v61
    v_mfma_f32_16x16x32_bf16 v[44:47], v[132:135], v[176:179], v[44:47]
    v_and_b32 v71, 0xffff0000, v61
    v_mfma_f32_16x16x32_bf16 v[32:35], v[136:139], v[160:163], v[32:35]
    v_lshlrev_b32 v72, 16, v62
    v_mfma_f32_16x16x32_bf16 v[36:39], v[136:139], v[164:167], v[36:39]
    v_and_b32 v73, 0xffff0000, v62
    v_mfma_f32_16x16x32_bf16 v[40:43], v[136:139], v[168:171], v[40:43]
    v_lshlrev_b32 v74, 16, v63
    v_mfma_f32_16x16x32_bf16 v[44:47], v[136:139], v[172:175], v[44:47]
    v_and_b32 v75, 0xffff0000, v63
    v_mfma_f32_16x16x32_bf16 v[32:35], v[140:143], v[156:159], v[32:35]
    v_lshlrev_b32 v76, 16, v64
    v_mfma_f32_16x16x32_bf16 v[36:39], v[140:143], v[160:163], v[36:39]
    v_and_b32 v77, 0xffff0000, v64
    v_mfma_f32_16x16x32_bf16 v[40:43], v[140:143], v[164:167], v[40:43]
    v_lshlrev_b32 v78, 16, v65
    v_mfma_f32_16x16x32_bf16 v[44:47], v[140:143], v[168:171], v[44:47]
    v_and_b32 v79, 0xffff0000, v65
    v_mfma_f32_16x16x32_bf16 v[36:39], v[144:147], v[156:159], v[36:39]
    v_lshlrev_b32 v80, 16, v66
    v_mfma_f32_16x16x32_bf16 v[40:43], v[144:147], v[160:163], v[40:43]
    v_and_b32 v81, 0xffff0000, v66
    v_mfma_f32_16x16x32_bf16 v[44:47], v[144:147], v[164:167], v[44:47]
    v_lshlrev_b32 v82, 16, v67
    v_mfma_f32_16x16x32_bf16 v[40:43], v[148:151], v[156:159], v[40:43]
    v_and_b32 v83, 0xffff0000, v67
    v_mfma_f32_16x16x32_bf16 v[44:47], v[148:151], v[160:163], v[44:47]
    ds_write_b128 v48, v[32:35] offset:0
    v_mfma_f32_16x16x32_bf16 v[44:47], v[152:155], v[156:159], v[44:47]
    v_mfma_f32_16x16x32_bf16 v[16:19], v[124:127], v[156:159], v[16:19]
    v_mfma_f32_16x16x32_bf16 v[20:23], v[124:127], v[160:163], v[20:23]
    v_mfma_f32_16x16x32_bf16 v[24:27], v[124:127], v[164:167], v[24:27]
    ds_write_b128 v48, v[36:39] offset:1024
    v_mfma_f32_16x16x32_bf16 v[28:31], v[124:127], v[168:171], v[28:31]
    v_mfma_f32_16x16x32_bf16 v[20:23], v[128:131], v[156:159], v[20:23]
    v_mfma_f32_16x16x32_bf16 v[24:27], v[128:131], v[160:163], v[24:27]
    ds_write_b128 v48, v[40:43] offset:2048
    v_mfma_f32_16x16x32_bf16 v[28:31], v[128:131], v[164:167], v[28:31]
    v_mfma_f32_16x16x32_bf16 v[24:27], v[132:135], v[156:159], v[24:27]
    ds_write_b128 v48, v[44:47] offset:3072
    v_mfma_f32_16x16x32_bf16 v[28:31], v[132:135], v[160:163], v[28:31]
    v_mfma_f32_16x16x32_bf16 v[28:31], v[136:139], v[156:159], v[28:31]
    s_waitcnt lgkmcnt(0)
    s_barrier
    ds_read_b128 v[84:87], v49 offset:0
    ds_read_b128 v[88:91], v49 offset:1024
    ds_read_b128 v[92:95], v49 offset:2048
    ds_read_b128 v[96:99], v49 offset:3072
    v_pk_add_f32 v[16:17], v[16:17], v[68:69]
    v_pk_add_f32 v[18:19], v[18:19], v[70:71]
    v_pk_add_f32 v[20:21], v[20:21], v[72:73]
    v_pk_add_f32 v[22:23], v[22:23], v[74:75]
    v_pk_add_f32 v[24:25], v[24:25], v[76:77]
    v_pk_add_f32 v[26:27], v[26:27], v[78:79]
    v_pk_add_f32 v[28:29], v[28:29], v[80:81]
    v_pk_add_f32 v[30:31], v[30:31], v[82:83]
    s_waitcnt lgkmcnt(2)
    v_pk_add_f32 v[16:17], v[16:17], v[84:85]
    v_pk_add_f32 v[18:19], v[18:19], v[86:87]
    v_pk_add_f32 v[20:21], v[20:21], v[88:89]
    v_pk_add_f32 v[22:23], v[22:23], v[90:91]
    v_cvt_pk_bf16_f32 v100, v16, v17
    v_cvt_pk_bf16_f32 v101, v18, v19
    v_cvt_pk_bf16_f32 v102, v20, v21
    v_cvt_pk_bf16_f32 v103, v22, v23
    s_nop 0
    v_permlane16_swap_b32 v100, v102
    v_permlane16_swap_b32 v101, v103
    buffer_store_dwordx4 v[100:103], v50, s[4:7], s34 offen sc1
    s_waitcnt lgkmcnt(0)
    v_pk_add_f32 v[24:25], v[24:25], v[92:93]
    v_pk_add_f32 v[26:27], v[26:27], v[94:95]
    v_pk_add_f32 v[28:29], v[28:29], v[96:97]
    v_pk_add_f32 v[30:31], v[30:31], v[98:99]
    v_cvt_pk_bf16_f32 v104, v24, v25
    v_cvt_pk_bf16_f32 v105, v26, v27
    v_cvt_pk_bf16_f32 v106, v28, v29
    v_cvt_pk_bf16_f32 v107, v30, v31
    s_nop 0
    v_permlane16_swap_b32 v104, v106
    v_permlane16_swap_b32 v105, v107
    buffer_store_dwordx4 v[104:107], v50, s[4:7], s43 offen sc1
    s_branch L_c1e
L_c1h1:
L_wk4_1:
    s_cbranch_execz L_wk4_ret
    v_mfma_f32_16x16x32_bf16 v[16:19], v[124:127], v[156:159], v[16:19]
    ds_read_b64 v[60:61], v8 offset:0
    v_mfma_f32_16x16x32_bf16 v[20:23], v[124:127], v[160:163], v[20:23]
    ds_read_b64 v[62:63], v8 offset:512
    v_mfma_f32_16x16x32_bf16 v[24:27], v[124:127], v[164:167], v[24:27]
    ds_read_b64 v[64:65], v8 offset:1024
    v_mfma_f32_16x16x32_bf16 v[28:31], v[124:127], v[168:171], v[28:31]
    ds_read_b64 v[66:67], v8 offset:1536
    v_mfma_f32_16x16x32_bf16 v[20:23], v[128:131], v[156:159], v[20:23]
    v_mfma_f32_16x16x32_bf16 v[24:27], v[128:131], v[160:163], v[24:27]
    v_mfma_f32_16x16x32_bf16 v[28:31], v[128:131], v[164:167], v[28:31]
    v_mfma_f32_16x16x32_bf16 v[24:27], v[132:135], v[156:159], v[24:27]
    s_waitcnt lgkmcnt(0)
    v_mfma_f32_16x16x32_bf16 v[28:31], v[132:135], v[160:163], v[28:31]
    v_lshlrev_b32 v68, 16, v60
    ds_write_b128 v48, v[16:19] offset:0
    v_mfma_f32_16x16x32_bf16 v[28:31], v[136:139], v[156:159], v[28:31]
    v_and_b32 v69, 0xffff0000, v60
    v_mfma_f32_16x16x32_bf16 v[32:35], v[124:127], v[172:175], v[32:35]
    v_lshlrev_b32 v70, 16, v61
    v_mfma_f32_16x16x32_bf16 v[36:39], v[124:127], v[176:179], v[36:39]
    v_and_b32 v71, 0xffff0000, v61
    v_mfma_f32_16x16x32_bf16 v[40:43], v[124:127], v[180:183], v[40:43]
    v_lshlrev_b32 v72, 16, v62
    ds_write_b128 v48, v[20:23] offset:1024
    v_mfma_f32_16x16x32_bf16 v[44:47], v[124:127], v[184:187], v[44:47]
    v_and_b32 v73, 0xffff0000, v62
    v_mfma_f32_16x16x32_bf16 v[32:35], v[128:131], v[168:171], v[32:35]
    v_lshlrev_b32 v74, 16, v63
    v_mfma_f32_16x16x32_bf16 v[36:39], v[128:131], v[172:175], v[36:39]
    v_and_b32 v75, 0xffff0000, v63
    ds_write_b128 v48, v[24:27] offset:2048
    v_mfma_f32_16x16x32_bf16 v[40:43], v[128:131], v[176:179], v[40:43]
    v_lshlrev_b32 v76, 16, v64
    v_mfma_f32_16x16x32_bf16 v[44:47], v[128:131], v[180:183], v[44:47]
    v_and_b32 v77, 0xffff0000, v64
    ds_write_b128 v48, v[28:31] offset:3072
    v_mfma_f32_16x16x32_bf16 v[32:35], v[132:135], v[164:167], v[32:35]
    v_lshlrev_b32 v78, 16, v65
    v_mfma_f32_16x16x32_bf16 v[36:39], v[132:135], v[168:171], v[36:39]
    v_and_b32 v79, 0xffff0000, v65
    v_mfma_f32_16x16x32_bf16 v[40:43], v[132:135], v[172:175], v[40:43]
    v_lshlrev_b32 v80, 16, v66
    v_mfma_f32_16x16x32_bf16 v[44:47], v[132:135], v[176:179], v[44:47]
    v_and_b32 v81, 0xffff0000, v66
    v_mfma_f32_16x16x32_bf16 v[32:35], v[136:139], v[160:163], v[32:35]
    v_lshlrev_b32 v82, 16, v67
    v_mfma_f32_16x16x32_bf16 v[36:39], v[136:139], v[164:167], v[36:39]
    v_and_b32 v83, 0xffff0000, v67
    v_mfma_f32_16x16x32_bf16 v[40:43], v[136:139], v[168:171], v[40:43]
    v_mfma_f32_16x16x32_bf16 v[44:47], v[136:139], v[172:175], v[44:47]
    v_mfma_f32_16x16x32_bf16 v[32:35], v[140:143], v[156:159], v[32:35]
    v_mfma_f32_16x16x32_bf16 v[36:39], v[140:143], v[160:163], v[36:39]
    v_mfma_f32_16x16x32_bf16 v[40:43], v[140:143], v[164:167], v[40:43]
    v_mfma_f32_16x16x32_bf16 v[44:47], v[140:143], v[168:171], v[44:47]
    v_mfma_f32_16x16x32_bf16 v[36:39], v[144:147], v[156:159], v[36:39]
    v_mfma_f32_16x16x32_bf16 v[40:43], v[144:147], v[160:163], v[40:43]
    v_mfma_f32_16x16x32_bf16 v[44:47], v[144:147], v[164:167], v[44:47]
    v_mfma_f32_16x16x32_bf16 v[40:43], v[148:151], v[156:159], v[40:43]
    v_mfma_f32_16x16x32_bf16 v[44:47], v[148:151], v[160:163], v[44:47]
    v_mfma_f32_16x16x32_bf16 v[44:47], v[152:155], v[156:159], v[44:47]
    s_waitcnt lgkmcnt(0)
    s_barrier
    ds_read_b128 v[84:87], v49 offset:0
    ds_read_b128 v[88:91], v49 offset:1024
    ds_read_b128 v[92:95], v49 offset:2048
    ds_read_b128 v[96:99], v49 offset:3072
    v_pk_add_f32 v[32:33], v[32:33], v[68:69]
    v_pk_add_f32 v[34:35], v[34:35], v[70:71]
    v_pk_add_f32 v[36:37], v[36:37], v[72:73]
    v_pk_add_f32 v[38:39], v[38:39], v[74:75]
    v_pk_add_f32 v[40:41], v[40:41], v[76:77]
    v_pk_add_f32 v[42:43], v[42:43], v[78:79]
    v_pk_add_f32 v[44:45], v[44:45], v[80:81]
    v_pk_add_f32 v[46:47], v[46:47], v[82:83]
    s_waitcnt lgkmcnt(2)
    v_pk_add_f32 v[32:33], v[32:33], v[84:85]
    v_pk_add_f32 v[34:35], v[34:35], v[86:87]
    v_pk_add_f32 v[36:37], v[36:37], v[88:89]
    v_pk_add_f32 v[38:39], v[38:39], v[90:91]
    v_cvt_pk_bf16_f32 v100, v32, v33
    v_cvt_pk_bf16_f32 v101, v34, v35
    v_cvt_pk_bf16_f32 v102, v36, v37
    v_cvt_pk_bf16_f32 v103, v38, v39
    s_nop 0
    v_permlane16_swap_b32 v100, v102
    v_permlane16_swap_b32 v101, v103
    buffer_store_dwordx4 v[100:103], v50, s[4:7], s34 offen sc1
    s_waitcnt lgkmcnt(0)
    v_pk_add_f32 v[40:41], v[40:41], v[92:93]
    v_pk_add_f32 v[42:43], v[42:43], v[94:95]
    v_pk_add_f32 v[44:45], v[44:45], v[96:97]
    v_pk_add_f32 v[46:47], v[46:47], v[98:99]
    v_cvt_pk_bf16_f32 v104, v40, v41
    v_cvt_pk_bf16_f32 v105, v42, v43
    v_cvt_pk_bf16_f32 v106, v44, v45
    v_cvt_pk_bf16_f32 v107, v46, v47
    s_nop 0
    v_permlane16_swap_b32 v104, v106
    v_permlane16_swap_b32 v105, v107
    buffer_store_dwordx4 v[104:107], v50, s[4:7], s43 offen sc1
L_c1e:
    s_waitcnt vmcnt(0) lgkmcnt(0)
    s_barrier
    s_cmp_eq_u32 s24, 1
    s_cbranch_scc0 L_bs5
    v_mov_b32 v188, 63
    v_mov_b32 v189, 0
    s_mov_b64 exec, 1
    buffer_store_byte v188, v189, s[4:7], s38 offen
    s_mov_b64 exec, -1
L_bs5:
    s_cmp_eq_u32 s24, 1
    s_cbranch_scc0 L_wk5_skip
    s_mov_b64 exec, 0
    s_branch L_wk5_0
L_wk5_ret:
    s_mov_b64 exec, -1
L_wk5_skip:
    s_cmp_eq_u32 s33, 1
    s_cbranch_scc0 L_bl5
    v_lshlrev_b32 v188, 5, v191
    v_lshlrev_b32 v189, 2, v1
    s_mov_b32 s23, 0
L_blp5:
    buffer_load_dword v2, v189, s[4:7], s39 offen sc1
    s_add_u32 s23, s23, 1
    s_cmp_gt_u32 s23, 400000
    s_cbranch_scc1 L_blq5
    s_waitcnt vmcnt(0)
    v_and_b32 v2, v2, v188
    v_cmp_ne_u32 vcc, v2, v188
    s_nop 4
    s_cbranch_vccnz L_blp5
L_blq5:
    s_waitcnt vmcnt(0)
    v_mov_b32 v188, 6
    v_mul_u32_u24 v189, 2048, v1
    s_mov_b64 exec, s[36:37]
    buffer_store_dword v188, v189, s[4:7], s40 offen sc1
    s_mov_b64 exec, -1
L_bl5:
    s_and_b32 s20, s24, 1
    s_lshr_b32 s21, s24, 1
    s_and_b32 s25, s2, 7
    s_lshl_b32 s25, s25, 1
    s_bfe_u32 s26, s2, 0x10003
    s_add_u32 s25, s25, s26
    s_lshr_b32 s26, s2, 4
    v_lshrrev_b32 v5, 1, v3
    v_xor_b32 v5, v5, v4
    v_lshlrev_b32 v5, 5, v5
    v_lshl_add_u32 v5, v4, 8, v5
    v_and_b32 v6, 1, v0
    v_lshl_add_u32 v5, v6, 4, v5
    v_xor_b32 v6, 0x80, v5
    s_lshl_b32 s28, s24, 12
    s_lshl_b32 s27, s25, 17
    s_add_u32 s28, s28, s27
    s_add_u32 s28, s28, 8519680
    s_lshl_b32 s34, s24, 12
    s_add_u32 s34, s34, 33792
    v_lshlrev_b32 v7, 4, v1
    v_lshrrev_b32 v8, 2, v1
    v_and_b32 v9, 7, v8
    s_lshl_b32 s27, s24, 1
    v_xor_b32 v9, s27, v9
    v_lshlrev_b32 v9, 5, v9
    v_lshl_add_u32 v8, v8, 8, v9
    v_and_b32 v9, 3, v0
    v_lshl_add_u32 v8, v9, 3, v8
    v_add_u32 v8, 33792, v8
    v_xor_b32 v9, 32, v8
    v_xor_b32 v10, 64, v8
    v_xor_b32 v11, 96, v8
    v_add_u32 v12, 49152, v8
    v_add_u32 v13, 49152, v9
    v_add_u32 v14, 49152, v10
    v_add_u32 v15, 49152, v11
    s_lshl_b32 s27, s24, 7
    s_add_u32 s27, s27, 160768
    v_lshl_add_u32 v184, v3, 2, s27
    s_lshl_b32 s27, s20, 5
    v_xor_b32 v185, s27, v1
    s_lshl_b32 s27, s21, 6
    v_add_u32 v185, s27, v185
    v_lshlrev_b32 v186, 2, v185
    v_add_u32 v186, 160768, v186
    s_mul_i32 s27, s20, 192
    s_add_u32 s27, s27, 33280
    v_mov_b32 v187, s27
    s_mov_b32 s56, 0xcccccccc
    s_mov_b32 s57, s56
    s_mov_b32 s58, 0xaaaaaaaa
    s_mov_b32 s59, s58
    s_cmp_eq_u32 s24, 0
    s_cbranch_scc0 L_bw5
    v_mul_u32_u24 v189, 256, v1
    s_mov_b32 s23, 0
    s_mov_b64 exec, s[36:37]
L_bwp5:
    buffer_load_dword v2, v189, s[4:7], s41 offen sc1
    s_add_u32 s23, s23, 1
    s_cmp_gt_u32 s23, 400000
    s_cbranch_scc1 L_bwq5
    s_waitcnt vmcnt(0)
    v_cmp_gt_u32 vcc, 6, v2
    s_nop 4
    s_and_b64 exec, exec, vcc
    s_cbranch_execnz L_bwp5
L_bwq5:
    s_waitcnt vmcnt(0)
    s_mov_b64 exec, -1
L_bw5:
    s_waitcnt lgkmcnt(0)
    s_barrier
    s_add_u32 m0, s34, 0
    s_nop 0
    buffer_load_dwordx4 v5, s[4:7], s28 offen offset:0 sc1 lds
    buffer_load_dwordx4 v6, s[4:7], s28 offen offset:1024 sc1 lds
    buffer_load_dwordx4 v5, s[4:7], s28 offen offset:2048 sc1 lds
    buffer_load_dwordx4 v6, s[4:7], s28 offen offset:3072 sc1 lds
    s_add_u32 s28, s28, 16384
    s_add_u32 m0, s34, 16384
    s_nop 0
    buffer_load_dwordx4 v5, s[4:7], s28 offen offset:0 sc1 lds
    buffer_load_dwordx4 v6, s[4:7], s28 offen offset:1024 sc1 lds
    buffer_load_dwordx4 v5, s[4:7], s28 offen offset:2048 sc1 lds
    buffer_load_dwordx4 v6, s[4:7], s28 offen offset:3072 sc1 lds
    s_add_u32 s28, s28, 16384
    s_add_u32 m0, s34, 32768
    s_nop 0
    buffer_load_dwordx4 v5, s[4:7], s28 offen offset:0 sc1 lds
    buffer_load_dwordx4 v6, s[4:7], s28 offen offset:1024 sc1 lds
    buffer_load_dwordx4 v5, s[4:7], s28 offen offset:2048 sc1 lds
    buffer_load_dwordx4 v6, s[4:7], s28 offen offset:3072 sc1 lds
    s_add_u32 s28, s28, 16384
    s_waitcnt vmcnt(8)
    s_barrier
    ds_read_b64_tr_b16 v[72:73], v8 offset:0
    ds_read_b64_tr_b16 v[74:75], v8 offset:4096
    ds_read_b64_tr_b16 v[76:77], v9 offset:0
    ds_read_b64_tr_b16 v[78:79], v9 offset:4096
    ds_read_b64_tr_b16 v[80:81], v10 offset:0
    ds_read_b64_tr_b16 v[82:83], v10 offset:4096
    ds_read_b64_tr_b16 v[84:85], v11 offset:0
    ds_read_b64_tr_b16 v[86:87], v11 offset:4096
    s_waitcnt lgkmcnt(6)
    v_mfma_f32_16x16x32_bf16 v[64:67], v[72:75], v[72:75], 0
    ds_read_b64_tr_b16 v[88:89], v8 offset:8192
    v_mfma_f32_16x16x32_bf16 v[16:19], a[0:3], v[72:75], 0
    ds_read_b64_tr_b16 v[90:91], v8 offset:12288
    v_mfma_f32_16x16x32_bf16 v[32:35], a[4:7], v[72:75], 0
    ds_read_b64_tr_b16 v[92:93], v9 offset:8192
    s_add_u32 m0, s34, 49152
    s_nop 0
    buffer_load_dwordx4 v5, s[4:7], s28 offen offset:0 sc1 lds
    v_mfma_f32_16x16x32_bf16 v[48:51], a[8:11], v[72:75], 0
    ds_read_b64_tr_b16 v[94:95], v9 offset:12288
    s_waitcnt lgkmcnt(8)
    v_mfma_f32_16x16x32_bf16 v[68:71], v[76:79], v[76:79], 0
    ds_read_b64_tr_b16 v[96:97], v10 offset:8192
    v_mfma_f32_16x16x32_bf16 v[20:23], a[0:3], v[76:79], 0
    ds_read_b64_tr_b16 v[98:99], v10 offset:12288
    buffer_load_dwordx4 v6, s[4:7], s28 offen offset:1024 sc1 lds
    v_mfma_f32_16x16x32_bf16 v[36:39], a[4:7], v[76:79], 0
    ds_read_b64_tr_b16 v[100:101], v11 offset:8192
    v_mfma_f32_16x16x32_bf16 v[52:55], a[8:11], v[76:79], 0
    ds_read_b64_tr_b16 v[102:103], v11 offset:12288
    s_waitcnt lgkmcnt(10)
    v_mfma_f32_16x16x32_bf16 v[24:27], a[0:3], v[80:83], 0
    buffer_load_dwordx4 v5, s[4:7], s28 offen offset:2048 sc1 lds
    v_mfma_f32_16x16x32_bf16 v[40:43], a[4:7], v[80:83], 0
    v_mfma_f32_16x16x32_bf16 v[56:59], a[8:11], v[80:83], 0
    s_waitcnt lgkmcnt(8)
    v_mfma_f32_16x16x32_bf16 v[28:31], a[0:3], v[84:87], 0
    buffer_load_dwordx4 v6, s[4:7], s28 offen offset:3072 sc1 lds
    s_add_u32 s28, s28, 16384
    v_mfma_f32_16x16x32_bf16 v[44:47], a[4:7], v[84:87], 0
    v_mfma_f32_16x16x32_bf16 v[60:63], a[8:11], v[84:87], 0
    s_waitcnt lgkmcnt(0)
    v_mfma_f32_16x16x32_bf16 v[64:67], v[88:91], v[88:91], v[64:67]
    v_mfma_f32_16x16x32_bf16 v[16:19], a[12:15], v[88:91], v[16:19]
    s_waitcnt vmcnt(8)
    s_barrier
    ds_read_b64_tr_b16 v[72:73], v8 offset:16384
    v_mfma_f32_16x16x32_bf16 v[32:35], a[16:19], v[88:91], v[32:35]
    ds_read_b64_tr_b16 v[74:75], v8 offset:20480
    v_mfma_f32_16x16x32_bf16 v[48:51], a[20:23], v[88:91], v[48:51]
    ds_read_b64_tr_b16 v[76:77], v9 offset:16384
    v_mfma_f32_16x16x32_bf16 v[68:71], v[92:95], v[92:95], v[68:71]
    ds_read_b64_tr_b16 v[78:79], v9 offset:20480
    v_mfma_f32_16x16x32_bf16 v[20:23], a[12:15], v[92:95], v[20:23]
    ds_read_b64_tr_b16 v[80:81], v10 offset:16384
    v_mfma_f32_16x16x32_bf16 v[36:39], a[16:19], v[92:95], v[36:39]
    ds_read_b64_tr_b16 v[82:83], v10 offset:20480
    v_mfma_f32_16x16x32_bf16 v[52:55], a[20:23], v[92:95], v[52:55]
    ds_read_b64_tr_b16 v[84:85], v11 offset:16384
    v_mfma_f32_16x16x32_bf16 v[24:27], a[12:15], v[96:99], v[24:27]
    ds_read_b64_tr_b16 v[86:87], v11 offset:20480
    v_mfma_f32_16x16x32_bf16 v[40:43], a[16:19], v[96:99], v[40:43]
    v_mfma_f32_16x16x32_bf16 v[56:59], a[20:23], v[96:99], v[56:59]
    v_mfma_f32_16x16x32_bf16 v[28:31], a[12:15], v[100:103], v[28:31]
    v_mfma_f32_16x16x32_bf16 v[44:47], a[16:19], v[100:103], v[44:47]
    v_mfma_f32_16x16x32_bf16 v[60:63], a[20:23], v[100:103], v[60:63]
    s_waitcnt lgkmcnt(0)
    v_mfma_f32_16x16x32_bf16 v[64:67], v[72:75], v[72:75], v[64:67]
    ds_read_b64_tr_b16 v[88:89], v8 offset:24576
    v_mfma_f32_16x16x32_bf16 v[16:19], a[24:27], v[72:75], v[16:19]
    ds_read_b64_tr_b16 v[90:91], v8 offset:28672
    v_mfma_f32_16x16x32_bf16 v[32:35], a[28:31], v[72:75], v[32:35]
    ds_read_b64_tr_b16 v[92:93], v9 offset:24576
    s_add_u32 m0, s34, 65536
    s_nop 0
    buffer_load_dwordx4 v5, s[4:7], s28 offen offset:0 sc1 lds
    v_mfma_f32_16x16x32_bf16 v[48:51], a[32:35], v[72:75], v[48:51]
    ds_read_b64_tr_b16 v[94:95], v9 offset:28672
    v_mfma_f32_16x16x32_bf16 v[68:71], v[76:79], v[76:79], v[68:71]
    ds_read_b64_tr_b16 v[96:97], v10 offset:24576
    v_mfma_f32_16x16x32_bf16 v[20:23], a[24:27], v[76:79], v[20:23]
    ds_read_b64_tr_b16 v[98:99], v10 offset:28672
    buffer_load_dwordx4 v6, s[4:7], s28 offen offset:1024 sc1 lds
    v_mfma_f32_16x16x32_bf16 v[36:39], a[28:31], v[76:79], v[36:39]
    ds_read_b64_tr_b16 v[100:101], v11 offset:24576
    v_mfma_f32_16x16x32_bf16 v[52:55], a[32:35], v[76:79], v[52:55]
    ds_read_b64_tr_b16 v[102:103], v11 offset:28672
    v_mfma_f32_16x16x32_bf16 v[24:27], a[24:27], v[80:83], v[24:27]
    buffer_load_dwordx4 v5, s[4:7], s28 offen offset:2048 sc1 lds
    v_mfma_f32_16x16x32_bf16 v[40:43], a[28:31], v[80:83], v[40:43]
    v_mfma_f32_16x16x32_bf16 v[56:59], a[32:35], v[80:83], v[56:59]
    v_mfma_f32_16x16x32_bf16 v[28:31], a[24:27], v[84:87], v[28:31]
    buffer_load_dwordx4 v6, s[4:7], s28 offen offset:3072 sc1 lds
    s_add_u32 s28, s28, 16384
    v_mfma_f32_16x16x32_bf16 v[44:47], a[28:31], v[84:87], v[44:47]
    v_mfma_f32_16x16x32_bf16 v[60:63], a[32:35], v[84:87], v[60:63]
    s_waitcnt lgkmcnt(0)
    v_mfma_f32_16x16x32_bf16 v[64:67], v[88:91], v[88:91], v[64:67]
    v_mfma_f32_16x16x32_bf16 v[16:19], a[36:39], v[88:91], v[16:19]
    s_waitcnt vmcnt(8)
    s_barrier
    ds_read_b64_tr_b16 v[72:73], v8 offset:32768
    v_mfma_f32_16x16x32_bf16 v[32:35], a[40:43], v[88:91], v[32:35]
    ds_read_b64_tr_b16 v[74:75], v8 offset:36864
    v_mfma_f32_16x16x32_bf16 v[48:51], a[44:47], v[88:91], v[48:51]
    ds_read_b64_tr_b16 v[76:77], v9 offset:32768
    v_mfma_f32_16x16x32_bf16 v[68:71], v[92:95], v[92:95], v[68:71]
    ds_read_b64_tr_b16 v[78:79], v9 offset:36864
    v_mfma_f32_16x16x32_bf16 v[20:23], a[36:39], v[92:95], v[20:23]
    ds_read_b64_tr_b16 v[80:81], v10 offset:32768
    v_mfma_f32_16x16x32_bf16 v[36:39], a[40:43], v[92:95], v[36:39]
    ds_read_b64_tr_b16 v[82:83], v10 offset:36864
    v_mfma_f32_16x16x32_bf16 v[52:55], a[44:47], v[92:95], v[52:55]
    ds_read_b64_tr_b16 v[84:85], v11 offset:32768
    v_mfma_f32_16x16x32_bf16 v[24:27], a[36:39], v[96:99], v[24:27]
    ds_read_b64_tr_b16 v[86:87], v11 offset:36864
    v_mfma_f32_16x16x32_bf16 v[40:43], a[40:43], v[96:99], v[40:43]
    v_mfma_f32_16x16x32_bf16 v[56:59], a[44:47], v[96:99], v[56:59]
    v_mfma_f32_16x16x32_bf16 v[28:31], a[36:39], v[100:103], v[28:31]
    v_mfma_f32_16x16x32_bf16 v[44:47], a[40:43], v[100:103], v[44:47]
    v_mfma_f32_16x16x32_bf16 v[60:63], a[44:47], v[100:103], v[60:63]
    s_waitcnt lgkmcnt(0)
    v_mfma_f32_16x16x32_bf16 v[64:67], v[72:75], v[72:75], v[64:67]
    ds_read_b64_tr_b16 v[88:89], v8 offset:40960
    v_mfma_f32_16x16x32_bf16 v[32:35], a[52:55], v[72:75], v[32:35]
    ds_read_b64_tr_b16 v[90:91], v8 offset:45056
    v_mfma_f32_16x16x32_bf16 v[48:51], a[56:59], v[72:75], v[48:51]
    ds_read_b64_tr_b16 v[92:93], v9 offset:40960
    s_add_u32 m0, s34, 81920
    s_nop 0
    buffer_load_dwordx4 v5, s[4:7], s28 offen offset:0 sc1 lds
    v_mfma_f32_16x16x32_bf16 v[68:71], v[76:79], v[76:79], v[68:71]
    ds_read_b64_tr_b16 v[94:95], v9 offset:45056
    v_mfma_f32_16x16x32_bf16 v[36:39], a[52:55], v[76:79], v[36:39]
    ds_read_b64_tr_b16 v[96:97], v10 offset:40960
    buffer_load_dwordx4 v6, s[4:7], s28 offen offset:1024 sc1 lds
    v_mfma_f32_16x16x32_bf16 v[52:55], a[56:59], v[76:79], v[52:55]
    ds_read_b64_tr_b16 v[98:99], v10 offset:45056
    v_mfma_f32_16x16x32_bf16 v[40:43], a[52:55], v[80:83], v[40:43]
    ds_read_b64_tr_b16 v[100:101], v11 offset:40960
    buffer_load_dwordx4 v5, s[4:7], s28 offen offset:2048 sc1 lds
    v_mfma_f32_16x16x32_bf16 v[56:59], a[56:59], v[80:83], v[56:59]
    ds_read_b64_tr_b16 v[102:103], v11 offset:45056
    v_mfma_f32_16x16x32_bf16 v[44:47], a[52:55], v[84:87], v[44:47]
    buffer_load_dwordx4 v6, s[4:7], s28 offen offset:3072 sc1 lds
    s_add_u32 s28, s28, 16384
    v_mfma_f32_16x16x32_bf16 v[60:63], a[56:59], v[84:87], v[60:63]
    s_waitcnt lgkmcnt(0)
    v_mfma_f32_16x16x32_bf16 v[64:67], v[88:91], v[88:91], v[64:67]
    v_mfma_f32_16x16x32_bf16 v[32:35], a[64:67], v[88:91], v[32:35]
    s_waitcnt vmcnt(8)
    s_barrier
    ds_read_b64_tr_b16 v[72:73], v12 offset:0
    v_mfma_f32_16x16x32_bf16 v[48:51], a[68:71], v[88:91], v[48:51]
    ds_read_b64_tr_b16 v[74:75], v12 offset:4096
    v_mfma_f32_16x16x32_bf16 v[68:71], v[92:95], v[92:95], v[68:71]
    ds_read_b64_tr_b16 v[76:77], v13 offset:0
    v_mfma_f32_16x16x32_bf16 v[36:39], a[64:67], v[92:95], v[36:39]
    ds_read_b64_tr_b16 v[78:79], v13 offset:4096
    v_mfma_f32_16x16x32_bf16 v[52:55], a[68:71], v[92:95], v[52:55]
    ds_read_b64_tr_b16 v[80:81], v14 offset:0
    v_mfma_f32_16x16x32_bf16 v[40:43], a[64:67], v[96:99], v[40:43]
    ds_read_b64_tr_b16 v[82:83], v14 offset:4096
    v_mfma_f32_16x16x32_bf16 v[56:59], a[68:71], v[96:99], v[56:59]
    ds_read_b64_tr_b16 v[84:85], v15 offset:0
    v_mfma_f32_16x16x32_bf16 v[44:47], a[64:67], v[100:103], v[44:47]
    ds_read_b64_tr_b16 v[86:87], v15 offset:4096
    v_mfma_f32_16x16x32_bf16 v[60:63], a[68:71], v[100:103], v[60:63]
    s_waitcnt lgkmcnt(0)
    v_mfma_f32_16x16x32_bf16 v[64:67], v[72:75], v[72:75], v[64:67]
    ds_read_b64_tr_b16 v[88:89], v12 offset:8192
    v_mfma_f32_16x16x32_bf16 v[32:35], a[76:79], v[72:75], v[32:35]
    ds_read_b64_tr_b16 v[90:91], v12 offset:12288
    v_mfma_f32_16x16x32_bf16 v[48:51], a[80:83], v[72:75], v[48:51]
    ds_read_b64_tr_b16 v[92:93], v13 offset:8192
    s_add_u32 m0, s34, 0
    s_nop 0
    buffer_load_dwordx4 v5, s[4:7], s28 offen offset:0 sc1 lds
    v_mfma_f32_16x16x32_bf16 v[68:71], v[76:79], v[76:79], v[68:71]
    ds_read_b64_tr_b16 v[94:95], v13 offset:12288
    v_mfma_f32_16x16x32_bf16 v[36:39], a[76:79], v[76:79], v[36:39]
    ds_read_b64_tr_b16 v[96:97], v14 offset:8192
    buffer_load_dwordx4 v6, s[4:7], s28 offen offset:1024 sc1 lds
    v_mfma_f32_16x16x32_bf16 v[52:55], a[80:83], v[76:79], v[52:55]
    ds_read_b64_tr_b16 v[98:99], v14 offset:12288
    v_mfma_f32_16x16x32_bf16 v[40:43], a[76:79], v[80:83], v[40:43]
    ds_read_b64_tr_b16 v[100:101], v15 offset:8192
    buffer_load_dwordx4 v5, s[4:7], s28 offen offset:2048 sc1 lds
    v_mfma_f32_16x16x32_bf16 v[56:59], a[80:83], v[80:83], v[56:59]
    ds_read_b64_tr_b16 v[102:103], v15 offset:12288
    v_mfma_f32_16x16x32_bf16 v[44:47], a[76:79], v[84:87], v[44:47]
    buffer_load_dwordx4 v6, s[4:7], s28 offen offset:3072 sc1 lds
    s_add_u32 s28, s28, 16384
    v_mfma_f32_16x16x32_bf16 v[60:63], a[80:83], v[84:87], v[60:63]
    s_waitcnt lgkmcnt(0)
    v_mfma_f32_16x16x32_bf16 v[64:67], v[88:91], v[88:91], v[64:67]
    v_mfma_f32_16x16x32_bf16 v[32:35], a[88:91], v[88:91], v[32:35]
    s_waitcnt vmcnt(8)
    s_barrier
    ds_read_b64_tr_b16 v[72:73], v12 offset:16384
    v_mfma_f32_16x16x32_bf16 v[48:51], a[92:95], v[88:91], v[48:51]
    ds_read_b64_tr_b16 v[74:75], v12 offset:20480
    v_mfma_f32_16x16x32_bf16 v[68:71], v[92:95], v[92:95], v[68:71]
L_wk5_0:
    s_cbranch_execz L_wk5_1
    ds_read_b64_tr_b16 v[76:77], v13 offset:16384
    v_mfma_f32_16x16x32_bf16 v[36:39], a[88:91], v[92:95], v[36:39]
    ds_read_b64_tr_b16 v[78:79], v13 offset:20480
    v_mfma_f32_16x16x32_bf16 v[52:55], a[92:95], v[92:95], v[52:55]
    ds_read_b64_tr_b16 v[80:81], v14 offset:16384
    v_mfma_f32_16x16x32_bf16 v[40:43], a[88:91], v[96:99], v[40:43]
    ds_read_b64_tr_b16 v[82:83], v14 offset:20480
    v_mfma_f32_16x16x32_bf16 v[56:59], a[92:95], v[96:99], v[56:59]
    ds_read_b64_tr_b16 v[84:85], v15 offset:16384
    v_mfma_f32_16x16x32_bf16 v[44:47], a[88:91], v[100:103], v[44:47]
    ds_read_b64_tr_b16 v[86:87], v15 offset:20480
    v_mfma_f32_16x16x32_bf16 v[60:63], a[92:95], v[100:103], v[60:63]
    s_waitcnt lgkmcnt(0)
    v_mfma_f32_16x16x32_bf16 v[64:67], v[72:75], v[72:75], v[64:67]
    ds_read_b64_tr_b16 v[88:89], v12 offset:24576
    v_mfma_f32_16x16x32_bf16 v[32:35], a[100:103], v[72:75], v[32:35]
    ds_read_b64_tr_b16 v[90:91], v12 offset:28672
    v_mfma_f32_16x16x32_bf16 v[48:51], a[104:107], v[72:75], v[48:51]
    ds_read_b64_tr_b16 v[92:93], v13 offset:24576
    s_add_u32 m0, s34, 16384
    s_nop 0
    buffer_load_dwordx4 v5, s[4:7], s28 offen offset:0 sc1 lds
    v_mfma_f32_16x16x32_bf16 v[68:71], v[76:79], v[76:79], v[68:71]
    ds_read_b64_tr_b16 v[94:95], v13 offset:28672
    v_mfma_f32_16x16x32_bf16 v[36:39], a[100:103], v[76:79], v[36:39]
    ds_read_b64_tr_b16 v[96:97], v14 offset:24576
    buffer_load_dwordx4 v6, s[4:7], s28 offen offset:1024 sc1 lds
    v_mfma_f32_16x16x32_bf16 v[52:55], a[104:107], v[76:79], v[52:55]
    ds_read_b64_tr_b16 v[98:99], v14 offset:28672
    v_mfma_f32_16x16x32_bf16 v[40:43], a[100:103], v[80:83], v[40:43]
    ds_read_b64_tr_b16 v[100:101], v15 offset:24576
    buffer_load_dwordx4 v5, s[4:7], s28 offen offset:2048 sc1 lds
    v_mfma_f32_16x16x32_bf16 v[56:59], a[104:107], v[80:83], v[56:59]
    ds_read_b64_tr_b16 v[102:103], v15 offset:28672
    v_mfma_f32_16x16x32_bf16 v[44:47], a[100:103], v[84:87], v[44:47]
    buffer_load_dwordx4 v6, s[4:7], s28 offen offset:3072 sc1 lds
    v_mfma_f32_16x16x32_bf16 v[60:63], a[104:107], v[84:87], v[60:63]
    s_waitcnt lgkmcnt(0)
    v_mfma_f32_16x16x32_bf16 v[64:67], v[88:91], v[88:91], v[64:67]
    v_mfma_f32_16x16x32_bf16 v[32:35], a[112:115], v[88:91], v[32:35]
    s_waitcnt vmcnt(8)
    s_barrier
    ds_read_b64_tr_b16 v[72:73], v12 offset:32768
    v_mfma_f32_16x16x32_bf16 v[48:51], a[116:119], v[88:91], v[48:51]
    ds_read_b64_tr_b16 v[74:75], v12 offset:36864
    v_mfma_f32_16x16x32_bf16 v[68:71], v[92:95], v[92:95], v[68:71]
    ds_read_b64_tr_b16 v[76:77], v13 offset:32768
    v_mfma_f32_16x16x32_bf16 v[36:39], a[112:115], v[92:95], v[36:39]
    ds_read_b64_tr_b16 v[78:79], v13 offset:36864
    v_mfma_f32_16x16x32_bf16 v[52:55], a[116:119], v[92:95], v[52:55]
    ds_read_b64_tr_b16 v[80:81], v14 offset:32768
    v_mfma_f32_16x16x32_bf16 v[40:43], a[112:115], v[96:99], v[40:43]
    ds_read_b64_tr_b16 v[82:83], v14 offset:36864
    v_mfma_f32_16x16x32_bf16 v[56:59], a[116:119], v[96:99], v[56:59]
    ds_read_b64_tr_b16 v[84:85], v15 offset:32768
    v_mfma_f32_16x16x32_bf16 v[44:47], a[112:115], v[100:103], v[44:47]
    ds_read_b64_tr_b16 v[86:87], v15 offset:36864
    v_mfma_f32_16x16x32_bf16 v[60:63], a[116:119], v[100:103], v[60:63]
    s_waitcnt lgkmcnt(0)
    v_mfma_f32_16x16x32_bf16 v[64:67], v[72:75], v[72:75], v[64:67]
    ds_read_b64_tr_b16 v[88:89], v12 offset:40960
    v_mfma_f32_16x16x32_bf16 v[32:35], a[124:127], v[72:75], v[32:35]
    ds_read_b64_tr_b16 v[90:91], v12 offset:45056
    v_mfma_f32_16x16x32_bf16 v[48:51], a[128:131], v[72:75], v[48:51]
    ds_read_b64_tr_b16 v[92:93], v13 offset:40960
    v_mfma_f32_16x16x32_bf16 v[68:71], v[76:79], v[76:79], v[68:71]
    ds_read_b64_tr_b16 v[94:95], v13 offset:45056
    v_mfma_f32_16x16x32_bf16 v[36:39], a[124:127], v[76:79], v[36:39]
    ds_read_b64_tr_b16 v[96:97], v14 offset:40960
    v_mfma_f32_16x16x32_bf16 v[52:55], a[128:131], v[76:79], v[52:55]
    ds_read_b64_tr_b16 v[98:99], v14 offset:45056
    v_mfma_f32_16x16x32_bf16 v[40:43], a[124:127], v[80:83], v[40:43]
    ds_read_b64_tr_b16 v[100:101], v15 offset:40960
    v_mfma_f32_16x16x32_bf16 v[56:59], a[128:131], v[80:83], v[56:59]
    ds_read_b64_tr_b16 v[102:103], v15 offset:45056
    v_mfma_f32_16x16x32_bf16 v[44:47], a[124:127], v[84:87], v[44:47]
    v_mfma_f32_16x16x32_bf16 v[60:63], a[128:131], v[84:87], v[60:63]
    s_waitcnt lgkmcnt(0)
    v_mfma_f32_16x16x32_bf16 v[64:67], v[88:91], v[88:91], v[64:67]
    v_mfma_f32_16x16x32_bf16 v[32:35], a[136:139], v[88:91], v[32:35]
    s_waitcnt vmcnt(4)
    s_barrier
    ds_read_b64_tr_b16 v[72:73], v8 offset:0
    v_mfma_f32_16x16x32_bf16 v[48:51], a[140:143], v[88:91], v[48:51]
    ds_read_b64_tr_b16 v[74:75], v8 offset:4096
    v_mfma_f32_16x16x32_bf16 v[68:71], v[92:95], v[92:95], v[68:71]
    ds_read_b64_tr_b16 v[76:77], v9 offset:0
    v_mfma_f32_16x16x32_bf16 v[36:39], a[136:139], v[92:95], v[36:39]
    ds_read_b64_tr_b16 v[78:79], v9 offset:4096
    v_mfma_f32_16x16x32_bf16 v[52:55], a[140:143], v[92:95], v[52:55]
    ds_read_b64_tr_b16 v[80:81], v10 offset:0
    v_mfma_f32_16x16x32_bf16 v[40:43], a[136:139], v[96:99], v[40:43]
    ds_read_b64_tr_b16 v[82:83], v10 offset:4096
    v_mfma_f32_16x16x32_bf16 v[56:59], a[140:143], v[96:99], v[56:59]
    ds_read_b64_tr_b16 v[84:85], v11 offset:0
    v_mfma_f32_16x16x32_bf16 v[44:47], a[136:139], v[100:103], v[44:47]
    ds_read_b64_tr_b16 v[86:87], v11 offset:4096
    v_mfma_f32_16x16x32_bf16 v[60:63], a[140:143], v[100:103], v[60:63]
    s_waitcnt lgkmcnt(0)
    v_mfma_f32_16x16x32_bf16 v[64:67], v[72:75], v[72:75], v[64:67]
    ds_read_b64_tr_b16 v[88:89], v8 offset:8192
    v_mfma_f32_16x16x32_bf16 v[32:35], a[148:151], v[72:75], v[32:35]
    ds_read_b64_tr_b16 v[90:91], v8 offset:12288
    v_mfma_f32_16x16x32_bf16 v[48:51], a[152:155], v[72:75], v[48:51]
    ds_read_b64_tr_b16 v[92:93], v9 offset:8192
    v_mfma_f32_16x16x32_bf16 v[68:71], v[76:79], v[76:79], v[68:71]
    ds_read_b64_tr_b16 v[94:95], v9 offset:12288
    v_mfma_f32_16x16x32_bf16 v[36:39], a[148:151], v[76:79], v[36:39]
    ds_read_b64_tr_b16 v[96:97], v10 offset:8192
    v_mfma_f32_16x16x32_bf16 v[52:55], a[152:155], v[76:79], v[52:55]
    ds_read_b64_tr_b16 v[98:99], v10 offset:12288
    v_mfma_f32_16x16x32_bf16 v[40:43], a[148:151], v[80:83], v[40:43]
    ds_read_b64_tr_b16 v[100:101], v11 offset:8192
    v_mfma_f32_16x16x32_bf16 v[56:59], a[152:155], v[80:83], v[56:59]
    ds_read_b64_tr_b16 v[102:103], v11 offset:12288
    v_mfma_f32_16x16x32_bf16 v[44:47], a[148:151], v[84:87], v[44:47]
    v_mfma_f32_16x16x32_bf16 v[60:63], a[152:155], v[84:87], v[60:63]
    s_waitcnt lgkmcnt(0)
    v_mfma_f32_16x16x32_bf16 v[64:67], v[88:91], v[88:91], v[64:67]
    v_mfma_f32_16x16x32_bf16 v[32:35], a[160:163], v[88:91], v[32:35]
    s_waitcnt vmcnt(0)
    s_barrier
    ds_read_b64_tr_b16 v[72:73], v8 offset:16384
    v_mfma_f32_16x16x32_bf16 v[48:51], a[164:167], v[88:91], v[48:51]
    ds_read_b64_tr_b16 v[74:75], v8 offset:20480
    v_mfma_f32_16x16x32_bf16 v[68:71], v[92:95], v[92:95], v[68:71]
    ds_read_b64_tr_b16 v[76:77], v9 offset:16384
    v_mfma_f32_16x16x32_bf16 v[36:39], a[160:163], v[92:95], v[36:39]
    ds_read_b64_tr_b16 v[78:79], v9 offset:20480
    v_mfma_f32_16x16x32_bf16 v[52:55], a[164:167], v[92:95], v[52:55]
    ds_read_b64_tr_b16 v[80:81], v10 offset:16384
    v_mfma_f32_16x16x32_bf16 v[40:43], a[160:163], v[96:99], v[40:43]
    ds_read_b64_tr_b16 v[82:83], v10 offset:20480
    v_mfma_f32_16x16x32_bf16 v[56:59], a[164:167], v[96:99], v[56:59]
    ds_read_b64_tr_b16 v[84:85], v11 offset:16384
    v_mfma_f32_16x16x32_bf16 v[44:47], a[160:163], v[100:103], v[44:47]
    ds_read_b64_tr_b16 v[86:87], v11 offset:20480
    v_mfma_f32_16x16x32_bf16 v[60:63], a[164:167], v[100:103], v[60:63]
    s_waitcnt lgkmcnt(0)
    v_mfma_f32_16x16x32_bf16 v[64:67], v[72:75], v[72:75], v[64:67]
    ds_read_b64_tr_b16 v[88:89], v8 offset:24576
    v_mfma_f32_16x16x32_bf16 v[32:35], a[172:175], v[72:75], v[32:35]
    ds_read_b64_tr_b16 v[90:91], v8 offset:28672
    v_mfma_f32_16x16x32_bf16 v[48:51], a[176:179], v[72:75], v[48:51]
    ds_read_b64_tr_b16 v[92:93], v9 offset:24576
    v_mfma_f32_16x16x32_bf16 v[68:71], v[76:79], v[76:79], v[68:71]
    ds_read_b64_tr_b16 v[94:95], v9 offset:28672
    v_mfma_f32_16x16x32_bf16 v[36:39], a[172:175], v[76:79], v[36:39]
    ds_read_b64_tr_b16 v[96:97], v10 offset:24576
    v_mfma_f32_16x16x32_bf16 v[52:55], a[176:179], v[76:79], v[52:55]
    ds_read_b64_tr_b16 v[98:99], v10 offset:28672
    v_mfma_f32_16x16x32_bf16 v[40:43], a[172:175], v[80:83], v[40:43]
    ds_read_b64_tr_b16 v[100:101], v11 offset:24576
    v_mfma_f32_16x16x32_bf16 v[56:59], a[176:179], v[80:83], v[56:59]
    ds_read_b64_tr_b16 v[102:103], v11 offset:28672
    v_mfma_f32_16x16x32_bf16 v[44:47], a[172:175], v[84:87], v[44:47]
    v_mfma_f32_16x16x32_bf16 v[60:63], a[176:179], v[84:87], v[60:63]
    s_waitcnt lgkmcnt(0)
    v_mfma_f32_16x16x32_bf16 v[64:67], v[88:91], v[88:91], v[64:67]
    ds_read_b128 v[136:139], v187 offset:64
    v_mfma_f32_16x16x32_bf16 v[32:35], a[184:187], v[88:91], v[32:35]
    ds_read_b128 v[140:143], v187 offset:80
    v_mfma_f32_16x16x32_bf16 v[48:51], a[188:191], v[88:91], v[48:51]
    ds_read_b128 v[144:147], v187 offset:96
    v_mfma_f32_16x16x32_bf16 v[68:71], v[92:95], v[92:95], v[68:71]
    ds_read_b128 v[148:151], v187 offset:112
    v_mfma_f32_16x16x32_bf16 v[36:39], a[184:187], v[92:95], v[36:39]
    ds_read_b128 v[152:155], v187 offset:128
    v_mfma_f32_16x16x32_bf16 v[52:55], a[188:191], v[92:95], v[52:55]
    ds_read_b128 v[156:159], v187 offset:144
    v_mfma_f32_16x16x32_bf16 v[40:43], a[184:187], v[96:99], v[40:43]
    ds_read_b128 v[160:163], v187 offset:160
    v_mfma_f32_16x16x32_bf16 v[56:59], a[188:191], v[96:99], v[56:59]
    ds_read_b128 v[164:167], v187 offset:176
    v_mfma_f32_16x16x32_bf16 v[44:47], a[184:187], v[100:103], v[44:47]
    v_mfma_f32_16x16x32_bf16 v[60:63], a[188:191], v[100:103], v[60:63]
    v_cndmask_b32 v64, v64, v66, s[56:57]
    v_cndmask_b32 v65, v65, v67, s[56:57]
    v_cndmask_b32 v64, v64, v65, s[58:59]
    v_cndmask_b32 v68, v68, v70, s[56:57]
    v_cndmask_b32 v69, v69, v71, s[56:57]
    v_cndmask_b32 v68, v68, v69, s[58:59]
    s_mov_b32 exec_lo, 0x00f0000f
    s_mov_b32 exec_hi, 0xf0000f00
    ds_write_b32 v184, v64
    ds_write_b32 v184, v68 offset:64
    s_mov_b64 exec, -1
    v_permlane32_swap_b32 v32, v40
    v_permlane32_swap_b32 v36, v44
    v_permlane32_swap_b32 v33, v41
    v_permlane32_swap_b32 v37, v45
    v_permlane32_swap_b32 v34, v42
    v_permlane32_swap_b32 v38, v46
    v_permlane32_swap_b32 v35, v43
    v_permlane32_swap_b32 v39, v47
    v_permlane16_swap_b32 v32, v36
    v_permlane16_swap_b32 v40, v44
    v_permlane16_swap_b32 v33, v37
    v_permlane16_swap_b32 v41, v45
    v_permlane16_swap_b32 v34, v38
    v_permlane16_swap_b32 v42, v46
    v_permlane16_swap_b32 v35, v39
    v_permlane16_swap_b32 v43, v47
    s_waitcnt lgkmcnt(0)
    s_barrier
    ds_read_b32 v66, v186
    v_mul_f32 v64, 0x3b000000, v32
    v_pk_fma_f32 v[32:33], v[136:137], v[64:65], v[32:33] op_sel_hi:[1,0,1] neg_lo:[0,1,0] neg_hi:[0,1,0]
    v_pk_fma_f32 v[34:35], v[138:139], v[64:65], v[34:35] op_sel_hi:[1,0,1] neg_lo:[0,1,0] neg_hi:[0,1,0]
    v_pk_fma_f32 v[36:37], v[140:141], v[64:65], v[36:37] op_sel_hi:[1,0,1] neg_lo:[0,1,0] neg_hi:[0,1,0]
    v_pk_fma_f32 v[38:39], v[142:143], v[64:65], v[38:39] op_sel_hi:[1,0,1] neg_lo:[0,1,0] neg_hi:[0,1,0]
    v_pk_fma_f32 v[40:41], v[144:145], v[64:65], v[40:41] op_sel_hi:[1,0,1] neg_lo:[0,1,0] neg_hi:[0,1,0]
    v_pk_fma_f32 v[42:43], v[146:147], v[64:65], v[42:43] op_sel_hi:[1,0,1] neg_lo:[0,1,0] neg_hi:[0,1,0]
    v_pk_fma_f32 v[44:45], v[148:149], v[64:65], v[44:45] op_sel_hi:[1,0,1] neg_lo:[0,1,0] neg_hi:[0,1,0]
    v_pk_fma_f32 v[46:47], v[150:151], v[64:65], v[46:47] op_sel_hi:[1,0,1] neg_lo:[0,1,0] neg_hi:[0,1,0]
    v_max3_f32 v68, v32, v33, v34
    v_min3_f32 v70, v32, v33, v34
    v_max3_f32 v68, v68, v35, v36
    v_min3_f32 v70, v70, v35, v36
    v_max3_f32 v68, v68, v37, v38
    v_min3_f32 v70, v70, v37, v38
    v_max3_f32 v68, v68, v39, v40
    v_min3_f32 v70, v70, v39, v40
    v_max3_f32 v68, v68, v41, v42
    v_min3_f32 v70, v70, v41, v42
    v_max3_f32 v68, v68, v43, v44
    v_min3_f32 v70, v70, v43, v44
    v_max3_f32 v68, v68, v45, v46
    v_min3_f32 v70, v70, v45, v46
    v_max_f32 v68, v68, v47
    v_min_f32 v70, v70, v47
    s_waitcnt lgkmcnt(0)
    v_mov_b32 v76, 0x3727c5ac
    v_fmac_f32 v76, 0x3b000000, v66
    v_fma_f32 v66, -v64, v64, v76
    v_max_f32 v66, 0x3727c5ac, v66
    v_rsq_f32 v66, v66
    v_mul_u32_u24 v5, 224, v185
    s_lshl_b32 s27, s20, 6
    s_add_u32 s27, s27, 132096
    v_add_u32 v180, s27, v5
    s_lshl_b32 s27, s20, 5
    s_add_u32 s27, s27, 132224
    v_add_u32 v181, s27, v5
    v_mul_f32 v76, 0x3fb8aa3b, v66
    v_mul_f32 v68, v68, v76
    v_mul_f32 v70, v70, v76
    v_pk_fma_f32 v[80:81], v[32:33], v[76:77], v[68:69] op_sel_hi:[1,0,0] neg_lo:[0,0,1] neg_hi:[0,0,1]
    v_pk_fma_f32 v[96:97], v[32:33], v[76:77], v[70:71] op_sel_hi:[1,0,0] neg_lo:[1,0,0] neg_hi:[1,0,0]
    v_pk_fma_f32 v[82:83], v[34:35], v[76:77], v[68:69] op_sel_hi:[1,0,0] neg_lo:[0,0,1] neg_hi:[0,0,1]
    v_pk_fma_f32 v[98:99], v[34:35], v[76:77], v[70:71] op_sel_hi:[1,0,0] neg_lo:[1,0,0] neg_hi:[1,0,0]
    v_pk_fma_f32 v[84:85], v[36:37], v[76:77], v[68:69] op_sel_hi:[1,0,0] neg_lo:[0,0,1] neg_hi:[0,0,1]
    v_pk_fma_f32 v[100:101], v[36:37], v[76:77], v[70:71] op_sel_hi:[1,0,0] neg_lo:[1,0,0] neg_hi:[1,0,0]
    v_pk_fma_f32 v[86:87], v[38:39], v[76:77], v[68:69] op_sel_hi:[1,0,0] neg_lo:[0,0,1] neg_hi:[0,0,1]
    v_pk_fma_f32 v[102:103], v[38:39], v[76:77], v[70:71] op_sel_hi:[1,0,0] neg_lo:[1,0,0] neg_hi:[1,0,0]
    v_pk_fma_f32 v[88:89], v[40:41], v[76:77], v[68:69] op_sel_hi:[1,0,0] neg_lo:[0,0,1] neg_hi:[0,0,1]
    v_pk_fma_f32 v[104:105], v[40:41], v[76:77], v[70:71] op_sel_hi:[1,0,0] neg_lo:[1,0,0] neg_hi:[1,0,0]
    v_pk_fma_f32 v[90:91], v[42:43], v[76:77], v[68:69] op_sel_hi:[1,0,0] neg_lo:[0,0,1] neg_hi:[0,0,1]
    v_pk_fma_f32 v[106:107], v[42:43], v[76:77], v[70:71] op_sel_hi:[1,0,0] neg_lo:[1,0,0] neg_hi:[1,0,0]
    v_pk_fma_f32 v[92:93], v[44:45], v[76:77], v[68:69] op_sel_hi:[1,0,0] neg_lo:[0,0,1] neg_hi:[0,0,1]
    v_pk_fma_f32 v[108:109], v[44:45], v[76:77], v[70:71] op_sel_hi:[1,0,0] neg_lo:[1,0,0] neg_hi:[1,0,0]
    v_pk_fma_f32 v[94:95], v[46:47], v[76:77], v[68:69] op_sel_hi:[1,0,0] neg_lo:[0,0,1] neg_hi:[0,0,1]
    v_pk_fma_f32 v[110:111], v[46:47], v[76:77], v[70:71] op_sel_hi:[1,0,0] neg_lo:[1,0,0] neg_hi:[1,0,0]
    v_exp_f32 v80, v80
    v_exp_f32 v81, v81
    v_exp_f32 v82, v82
    v_exp_f32 v83, v83
    v_exp_f32 v84, v84
    v_exp_f32 v85, v85
    v_exp_f32 v86, v86
    v_exp_f32 v87, v87
    v_exp_f32 v88, v88
    v_exp_f32 v89, v89
    v_exp_f32 v90, v90
    v_exp_f32 v91, v91
    v_exp_f32 v92, v92
    v_exp_f32 v93, v93
    v_exp_f32 v94, v94
    v_exp_f32 v95, v95
    v_exp_f32 v96, v96
    v_exp_f32 v97, v97
    v_exp_f32 v98, v98
    v_exp_f32 v99, v99
    v_exp_f32 v100, v100
    v_exp_f32 v101, v101
    v_exp_f32 v102, v102
    v_exp_f32 v103, v103
    v_exp_f32 v104, v104
    v_exp_f32 v105, v105
    v_exp_f32 v106, v106
    v_exp_f32 v107, v107
    v_exp_f32 v108, v108
    v_exp_f32 v109, v109
    v_exp_f32 v110, v110
    v_exp_f32 v111, v111
    v_pk_add_f32 v[68:69], v[80:81], v[82:83]
    v_pk_add_f32 v[70:71], v[96:97], v[98:99]
    v_pk_add_f32 v[68:69], v[68:69], v[84:85]
    v_pk_add_f32 v[70:71], v[70:71], v[100:101]
    v_pk_add_f32 v[68:69], v[68:69], v[86:87]
    v_pk_add_f32 v[70:71], v[70:71], v[102:103]
    v_pk_add_f32 v[68:69], v[68:69], v[88:89]
    v_pk_add_f32 v[70:71], v[70:71], v[104:105]
    v_pk_add_f32 v[68:69], v[68:69], v[90:91]
    v_pk_add_f32 v[70:71], v[70:71], v[106:107]
    v_pk_add_f32 v[68:69], v[68:69], v[92:93]
    v_pk_add_f32 v[70:71], v[70:71], v[108:109]
    v_pk_add_f32 v[68:69], v[68:69], v[94:95]
    v_pk_add_f32 v[70:71], v[70:71], v[110:111]
    v_add_f32 v68, v68, v69
    v_add_f32 v70, v70, v71
    v_rcp_f32 v68, v68
    v_rcp_f32 v70, v70
    v_pk_mul_f32 v[80:81], v[80:81], v[68:69] op_sel_hi:[1,0]
    v_pk_mul_f32 v[96:97], v[96:97], v[70:71] op_sel_hi:[1,0]
    v_pk_mul_f32 v[82:83], v[82:83], v[68:69] op_sel_hi:[1,0]
    v_pk_mul_f32 v[98:99], v[98:99], v[70:71] op_sel_hi:[1,0]
    v_pk_mul_f32 v[84:85], v[84:85], v[68:69] op_sel_hi:[1,0]
    v_pk_mul_f32 v[100:101], v[100:101], v[70:71] op_sel_hi:[1,0]
    v_pk_mul_f32 v[86:87], v[86:87], v[68:69] op_sel_hi:[1,0]
    v_pk_mul_f32 v[102:103], v[102:103], v[70:71] op_sel_hi:[1,0]
    v_pk_mul_f32 v[88:89], v[88:89], v[68:69] op_sel_hi:[1,0]
    v_pk_mul_f32 v[104:105], v[104:105], v[70:71] op_sel_hi:[1,0]
    v_pk_mul_f32 v[90:91], v[90:91], v[68:69] op_sel_hi:[1,0]
    v_pk_mul_f32 v[106:107], v[106:107], v[70:71] op_sel_hi:[1,0]
    v_pk_mul_f32 v[92:93], v[92:93], v[68:69] op_sel_hi:[1,0]
    v_pk_mul_f32 v[108:109], v[108:109], v[70:71] op_sel_hi:[1,0]
    v_pk_mul_f32 v[94:95], v[94:95], v[68:69] op_sel_hi:[1,0]
    v_pk_mul_f32 v[110:111], v[110:111], v[70:71] op_sel_hi:[1,0]
    v_cvt_pk_bf16_f32 v32, v80, v81
    v_cvt_pk_bf16_f32 v33, v82, v83
    v_cvt_pk_bf16_f32 v34, v84, v85
    v_cvt_pk_bf16_f32 v35, v86, v87
    ds_write_b128 v180, v[32:35] offset:0
    v_cvt_pk_bf16_f32 v36, v88, v89
    v_cvt_pk_bf16_f32 v37, v90, v91
    v_cvt_pk_bf16_f32 v38, v92, v93
    v_cvt_pk_bf16_f32 v39, v94, v95
    ds_write_b128 v180, v[36:39] offset:16
    v_cvt_pk_bf16_f32 v40, v96, v97
    v_cvt_pk_bf16_f32 v41, v98, v99
    v_cvt_pk_bf16_f32 v42, v100, v101
    v_cvt_pk_bf16_f32 v43, v102, v103
    ds_write_b128 v180, v[40:43] offset:32
    v_cvt_pk_bf16_f32 v44, v104, v105
    v_cvt_pk_bf16_f32 v45, v106, v107
    v_cvt_pk_bf16_f32 v46, v108, v109
    v_cvt_pk_bf16_f32 v47, v110, v111
    ds_write_b128 v180, v[44:47] offset:48
    v_permlane32_swap_b32 v48, v56
    v_permlane32_swap_b32 v52, v60
    v_permlane32_swap_b32 v49, v57
    v_permlane32_swap_b32 v53, v61
    v_permlane32_swap_b32 v50, v58
    v_permlane32_swap_b32 v54, v62
    v_permlane32_swap_b32 v51, v59
    v_permlane32_swap_b32 v55, v63
    v_permlane16_swap_b32 v48, v52
    v_permlane16_swap_b32 v56, v60
    v_permlane16_swap_b32 v49, v53
    v_permlane16_swap_b32 v57, v61
    v_permlane16_swap_b32 v50, v54
    v_permlane16_swap_b32 v58, v62
    v_permlane16_swap_b32 v51, v55
    v_permlane16_swap_b32 v59, v63
    v_pk_fma_f32 v[48:49], v[152:153], v[64:65], v[48:49] op_sel_hi:[1,0,1] neg_lo:[0,1,0] neg_hi:[0,1,0]
    v_pk_fma_f32 v[50:51], v[154:155], v[64:65], v[50:51] op_sel_hi:[1,0,1] neg_lo:[0,1,0] neg_hi:[0,1,0]
    v_pk_fma_f32 v[52:53], v[156:157], v[64:65], v[52:53] op_sel_hi:[1,0,1] neg_lo:[0,1,0] neg_hi:[0,1,0]
    v_pk_fma_f32 v[54:55], v[158:159], v[64:65], v[54:55] op_sel_hi:[1,0,1] neg_lo:[0,1,0] neg_hi:[0,1,0]
    v_pk_fma_f32 v[56:57], v[160:161], v[64:65], v[56:57] op_sel_hi:[1,0,1] neg_lo:[0,1,0] neg_hi:[0,1,0]
    v_pk_fma_f32 v[58:59], v[162:163], v[64:65], v[58:59] op_sel_hi:[1,0,1] neg_lo:[0,1,0] neg_hi:[0,1,0]
    v_pk_fma_f32 v[60:61], v[164:165], v[64:65], v[60:61] op_sel_hi:[1,0,1] neg_lo:[0,1,0] neg_hi:[0,1,0]
    v_pk_fma_f32 v[62:63], v[166:167], v[64:65], v[62:63] op_sel_hi:[1,0,1] neg_lo:[0,1,0] neg_hi:[0,1,0]
    v_pk_mul_f32 v[48:49], v[48:49], v[66:67] op_sel_hi:[1,0]
    v_pk_mul_f32 v[50:51], v[50:51], v[66:67] op_sel_hi:[1,0]
    v_pk_mul_f32 v[52:53], v[52:53], v[66:67] op_sel_hi:[1,0]
    v_pk_mul_f32 v[54:55], v[54:55], v[66:67] op_sel_hi:[1,0]
    v_pk_mul_f32 v[56:57], v[56:57], v[66:67] op_sel_hi:[1,0]
    v_pk_mul_f32 v[58:59], v[58:59], v[66:67] op_sel_hi:[1,0]
    v_pk_mul_f32 v[60:61], v[60:61], v[66:67] op_sel_hi:[1,0]
    v_pk_mul_f32 v[62:63], v[62:63], v[66:67] op_sel_hi:[1,0]
    v_cvt_pk_bf16_f32 v128, v48, v49
    v_cvt_pk_bf16_f32 v129, v50, v51
    v_cvt_pk_bf16_f32 v130, v52, v53
    v_cvt_pk_bf16_f32 v131, v54, v55
    ds_write_b128 v181, v[128:131] offset:0
    v_cvt_pk_bf16_f32 v132, v56, v57
    v_cvt_pk_bf16_f32 v133, v58, v59
    v_cvt_pk_bf16_f32 v134, v60, v61
    v_cvt_pk_bf16_f32 v135, v62, v63
    ds_write_b128 v181, v[132:135] offset:16
    v_lshrrev_b32 v5, 2, v1
    v_mul_u32_u24 v5, 224, v5
    v_and_b32 v6, 3, v0
    v_lshl_add_u32 v5, v6, 3, v5
    v_add_u32 v180, s27, v5
    s_lshl_b32 s27, s20, 6
    s_lshl_b32 s28, s21, 5
    s_add_u32 s27, s27, s28
    s_add_u32 s27, s27, 132096
    v_add_u32 v181, s27, v5
    v_mov_b32 v48, 0x3f803f80
    v_mov_b32 v49, 0x3f803f80
    v_mov_b32 v50, 0x3f803f80
    v_mov_b32 v51, 0x3f803f80
    s_lshl_b32 s30, s26, 1
    s_add_u32 s30, s30, s20
    s_lshl_b32 s30, s30, 1
    s_add_u32 s30, s30, s21
    s_mul_i32 s30, s30, 1152
    s_add_u32 s30, s30, 21176320
    v_lshlrev_b32 v182, 2, v3
    v_lshl_add_u32 v183, v4, 8, v182
    s_waitcnt lgkmcnt(0)
    s_barrier
    ds_read_b64_tr_b16 v[136:137], v180 offset:0
    ds_read_b64_tr_b16 v[152:153], v181 offset:0
    ds_read_b64_tr_b16 v[138:139], v180 offset:3584
    ds_read_b64_tr_b16 v[154:155], v181 offset:3584
    ds_read_b64_tr_b16 v[140:141], v180 offset:7168
    ds_read_b64_tr_b16 v[156:157], v181 offset:7168
    ds_read_b64_tr_b16 v[142:143], v180 offset:10752
    ds_read_b64_tr_b16 v[158:159], v181 offset:10752
    ds_read_b64_tr_b16 v[144:145], v180 offset:14336
    ds_read_b64_tr_b16 v[160:161], v181 offset:14336
    ds_read_b64_tr_b16 v[146:147], v180 offset:17920
    ds_read_b64_tr_b16 v[162:163], v181 offset:17920
    ds_read_b64_tr_b16 v[148:149], v180 offset:21504
    ds_read_b64_tr_b16 v[164:165], v181 offset:21504
    ds_read_b64_tr_b16 v[150:151], v180 offset:25088
    ds_read_b64_tr_b16 v[166:167], v181 offset:25088
    s_waitcnt lgkmcnt(12)
    v_mfma_f32_16x16x32_bf16 v[168:171], v[136:139], v[152:155], 0
    v_mfma_f32_16x16x32_bf16 v[172:175], v[48:51], v[152:155], 0
    ds_read_b64_tr_b16 v[80:81], v8 offset:32768
    ds_read_b64_tr_b16 v[82:83], v8 offset:36864
    ds_read_b64_tr_b16 v[84:85], v9 offset:32768
    ds_read_b64_tr_b16 v[86:87], v9 offset:36864
    s_waitcnt lgkmcnt(12)
    v_mfma_f32_16x16x32_bf16 v[168:171], v[140:143], v[156:159], v[168:171]
    v_mfma_f32_16x16x32_bf16 v[172:175], v[48:51], v[156:159], v[172:175]
    ds_read_b64_tr_b16 v[88:89], v10 offset:32768
    ds_read_b64_tr_b16 v[90:91], v10 offset:36864
    ds_read_b64_tr_b16 v[92:93], v11 offset:32768
    ds_read_b64_tr_b16 v[94:95], v11 offset:36864
    s_waitcnt lgkmcnt(12)
    v_mfma_f32_16x16x32_bf16 v[168:171], v[144:147], v[160:163], v[168:171]
    v_mfma_f32_16x16x32_bf16 v[172:175], v[48:51], v[160:163], v[172:175]
    ds_read_b64_tr_b16 v[96:97], v8 offset:40960
    ds_read_b64_tr_b16 v[98:99], v8 offset:45056
    ds_read_b64_tr_b16 v[100:101], v9 offset:40960
    ds_read_b64_tr_b16 v[102:103], v9 offset:45056
    s_waitcnt lgkmcnt(12)
    v_mfma_f32_16x16x32_bf16 v[168:171], v[148:151], v[164:167], v[168:171]
    v_mfma_f32_16x16x32_bf16 v[172:175], v[48:51], v[164:167], v[172:175]
    ds_read_b64_tr_b16 v[104:105], v10 offset:40960
    ds_read_b64_tr_b16 v[106:107], v10 offset:45056
    ds_read_b64_tr_b16 v[108:109], v11 offset:40960
    ds_read_b64_tr_b16 v[110:111], v11 offset:45056
    s_nop 2
    buffer_atomic_add_f32 v168, v183, s[4:7], s30 offen offset:0
    buffer_atomic_add_f32 v169, v183, s[4:7], s30 offen offset:64
    buffer_atomic_add_f32 v170, v183, s[4:7], s30 offen offset:128
    buffer_atomic_add_f32 v171, v183, s[4:7], s30 offen offset:192
    s_mov_b64 exec, 0xffff
    buffer_atomic_add_f32 v172, v182, s[4:7], s30 offen offset:1024
    s_mov_b64 exec, -1
    s_waitcnt lgkmcnt(8)
    v_mfma_f32_16x16x32_bf16 v[16:19], a[48:51], v[80:83], v[16:19]
    ds_read_b64_tr_b16 v[112:113], v12 offset:0
    ds_read_b64_tr_b16 v[114:115], v12 offset:4096
    v_mfma_f32_16x16x32_bf16 v[20:23], a[48:51], v[84:87], v[20:23]
    ds_read_b64_tr_b16 v[116:117], v13 offset:0
    ds_read_b64_tr_b16 v[118:119], v13 offset:4096
    v_mfma_f32_16x16x32_bf16 v[24:27], a[48:51], v[88:91], v[24:27]
    ds_read_b64_tr_b16 v[120:121], v14 offset:0
    ds_read_b64_tr_b16 v[122:123], v14 offset:4096
    v_mfma_f32_16x16x32_bf16 v[28:31], a[48:51], v[92:95], v[28:31]
    ds_read_b64_tr_b16 v[124:125], v15 offset:0
    ds_read_b64_tr_b16 v[126:127], v15 offset:4096
    s_waitcnt lgkmcnt(8)
    v_mfma_f32_16x16x32_bf16 v[16:19], a[60:63], v[96:99], v[16:19]
    ds_read_b64_tr_b16 v[80:81], v12 offset:8192
    ds_read_b64_tr_b16 v[82:83], v12 offset:12288
    v_mfma_f32_16x16x32_bf16 v[20:23], a[60:63], v[100:103], v[20:23]
    ds_read_b64_tr_b16 v[84:85], v13 offset:8192
    ds_read_b64_tr_b16 v[86:87], v13 offset:12288
    v_mfma_f32_16x16x32_bf16 v[24:27], a[60:63], v[104:107], v[24:27]
    ds_read_b64_tr_b16 v[88:89], v14 offset:8192
    ds_read_b64_tr_b16 v[90:91], v14 offset:12288
    v_mfma_f32_16x16x32_bf16 v[28:31], a[60:63], v[108:111], v[28:31]
    ds_read_b64_tr_b16 v[92:93], v15 offset:8192
    ds_read_b64_tr_b16 v[94:95], v15 offset:12288
    s_waitcnt lgkmcnt(8)
    v_mfma_f32_16x16x32_bf16 v[16:19], a[72:75], v[112:115], v[16:19]
    ds_read_b64_tr_b16 v[96:97], v12 offset:16384
    ds_read_b64_tr_b16 v[98:99], v12 offset:20480
    v_mfma_f32_16x16x32_bf16 v[20:23], a[72:75], v[116:119], v[20:23]
    ds_read_b64_tr_b16 v[100:101], v13 offset:16384
    ds_read_b64_tr_b16 v[102:103], v13 offset:20480
    v_mfma_f32_16x16x32_bf16 v[24:27], a[72:75], v[120:123], v[24:27]
    ds_read_b64_tr_b16 v[104:105], v14 offset:16384
    ds_read_b64_tr_b16 v[106:107], v14 offset:20480
    v_mfma_f32_16x16x32_bf16 v[28:31], a[72:75], v[124:127], v[28:31]
    ds_read_b64_tr_b16 v[108:109], v15 offset:16384
    ds_read_b64_tr_b16 v[110:111], v15 offset:20480
    s_waitcnt lgkmcnt(8)
    v_mfma_f32_16x16x32_bf16 v[16:19], a[84:87], v[80:83], v[16:19]
    ds_read_b64_tr_b16 v[112:113], v12 offset:24576
    ds_read_b64_tr_b16 v[114:115], v12 offset:28672
    v_mfma_f32_16x16x32_bf16 v[20:23], a[84:87], v[84:87], v[20:23]
    ds_read_b64_tr_b16 v[116:117], v13 offset:24576
    ds_read_b64_tr_b16 v[118:119], v13 offset:28672
    v_mfma_f32_16x16x32_bf16 v[24:27], a[84:87], v[88:91], v[24:27]
    ds_read_b64_tr_b16 v[120:121], v14 offset:24576
    ds_read_b64_tr_b16 v[122:123], v14 offset:28672
    v_mfma_f32_16x16x32_bf16 v[28:31], a[84:87], v[92:95], v[28:31]
    ds_read_b64_tr_b16 v[124:125], v15 offset:24576
    ds_read_b64_tr_b16 v[126:127], v15 offset:28672
    s_waitcnt lgkmcnt(8)
    v_mfma_f32_16x16x32_bf16 v[16:19], a[96:99], v[96:99], v[16:19]
    ds_read_b64_tr_b16 v[80:81], v12 offset:32768
    ds_read_b64_tr_b16 v[82:83], v12 offset:36864
    v_mfma_f32_16x16x32_bf16 v[20:23], a[96:99], v[100:103], v[20:23]
    ds_read_b64_tr_b16 v[84:85], v13 offset:32768
    ds_read_b64_tr_b16 v[86:87], v13 offset:36864
    v_mfma_f32_16x16x32_bf16 v[24:27], a[96:99], v[104:107], v[24:27]
    ds_read_b64_tr_b16 v[88:89], v14 offset:32768
    ds_read_b64_tr_b16 v[90:91], v14 offset:36864
    v_mfma_f32_16x16x32_bf16 v[28:31], a[96:99], v[108:111], v[28:31]
    ds_read_b64_tr_b16 v[92:93], v15 offset:32768
    ds_read_b64_tr_b16 v[94:95], v15 offset:36864
    s_waitcnt lgkmcnt(8)
    v_mfma_f32_16x16x32_bf16 v[16:19], a[108:111], v[112:115], v[16:19]
    ds_read_b64_tr_b16 v[96:97], v12 offset:40960
    ds_read_b64_tr_b16 v[98:99], v12 offset:45056
    v_mfma_f32_16x16x32_bf16 v[20:23], a[108:111], v[116:119], v[20:23]
    ds_read_b64_tr_b16 v[100:101], v13 offset:40960
    ds_read_b64_tr_b16 v[102:103], v13 offset:45056
    v_mfma_f32_16x16x32_bf16 v[24:27], a[108:111], v[120:123], v[24:27]
    ds_read_b64_tr_b16 v[104:105], v14 offset:40960
    ds_read_b64_tr_b16 v[106:107], v14 offset:45056
    v_mfma_f32_16x16x32_bf16 v[28:31], a[108:111], v[124:127], v[28:31]
    ds_read_b64_tr_b16 v[108:109], v15 offset:40960
    ds_read_b64_tr_b16 v[110:111], v15 offset:45056
    s_waitcnt lgkmcnt(8)
    v_mfma_f32_16x16x32_bf16 v[16:19], a[120:123], v[80:83], v[16:19]
    ds_read_b64_tr_b16 v[112:113], v8 offset:0
    ds_read_b64_tr_b16 v[114:115], v8 offset:4096
    v_mfma_f32_16x16x32_bf16 v[20:23], a[120:123], v[84:87], v[20:23]
    ds_read_b64_tr_b16 v[116:117], v9 offset:0
    ds_read_b64_tr_b16 v[118:119], v9 offset:4096
    v_mfma_f32_16x16x32_bf16 v[24:27], a[120:123], v[88:91], v[24:27]
    ds_read_b64_tr_b16 v[120:121], v10 offset:0
    ds_read_b64_tr_b16 v[122:123], v10 offset:4096
    v_mfma_f32_16x16x32_bf16 v[28:31], a[120:123], v[92:95], v[28:31]
    ds_read_b64_tr_b16 v[124:125], v11 offset:0
    ds_read_b64_tr_b16 v[126:127], v11 offset:4096
    s_waitcnt lgkmcnt(8)
    v_mfma_f32_16x16x32_bf16 v[16:19], a[132:135], v[96:99], v[16:19]
    ds_read_b64_tr_b16 v[80:81], v8 offset:8192
    ds_read_b64_tr_b16 v[82:83], v8 offset:12288
    v_mfma_f32_16x16x32_bf16 v[20:23], a[132:135], v[100:103], v[20:23]
    ds_read_b64_tr_b16 v[84:85], v9 offset:8192
    ds_read_b64_tr_b16 v[86:87], v9 offset:12288
    v_mfma_f32_16x16x32_bf16 v[24:27], a[132:135], v[104:107], v[24:27]
    ds_read_b64_tr_b16 v[88:89], v10 offset:8192
    ds_read_b64_tr_b16 v[90:91], v10 offset:12288
    v_mfma_f32_16x16x32_bf16 v[28:31], a[132:135], v[108:111], v[28:31]
    ds_read_b64_tr_b16 v[92:93], v11 offset:8192
    ds_read_b64_tr_b16 v[94:95], v11 offset:12288
    s_waitcnt lgkmcnt(8)
    v_mfma_f32_16x16x32_bf16 v[16:19], a[144:147], v[112:115], v[16:19]
    ds_read_b64_tr_b16 v[96:97], v8 offset:16384
L_wk5_1:
    s_cbranch_execz L_wk5_ret
    ds_read_b64_tr_b16 v[98:99], v8 offset:20480
    v_mfma_f32_16x16x32_bf16 v[20:23], a[144:147], v[116:119], v[20:23]
    ds_read_b64_tr_b16 v[100:101], v9 offset:16384
    ds_read_b64_tr_b16 v[102:103], v9 offset:20480
    v_mfma_f32_16x16x32_bf16 v[24:27], a[144:147], v[120:123], v[24:27]
    ds_read_b64_tr_b16 v[104:105], v10 offset:16384
    ds_read_b64_tr_b16 v[106:107], v10 offset:20480
    v_mfma_f32_16x16x32_bf16 v[28:31], a[144:147], v[124:127], v[28:31]
    ds_read_b64_tr_b16 v[108:109], v11 offset:16384
    ds_read_b64_tr_b16 v[110:111], v11 offset:20480
    s_waitcnt lgkmcnt(8)
    v_mfma_f32_16x16x32_bf16 v[16:19], a[156:159], v[80:83], v[16:19]
    ds_read_b64_tr_b16 v[112:113], v8 offset:24576
    ds_read_b64_tr_b16 v[114:115], v8 offset:28672
    v_mfma_f32_16x16x32_bf16 v[20:23], a[156:159], v[84:87], v[20:23]
    ds_read_b64_tr_b16 v[116:117], v9 offset:24576
    ds_read_b64_tr_b16 v[118:119], v9 offset:28672
    v_mfma_f32_16x16x32_bf16 v[24:27], a[156:159], v[88:91], v[24:27]
    ds_read_b64_tr_b16 v[120:121], v10 offset:24576
    ds_read_b64_tr_b16 v[122:123], v10 offset:28672
    v_mfma_f32_16x16x32_bf16 v[28:31], a[156:159], v[92:95], v[28:31]
    ds_read_b64_tr_b16 v[124:125], v11 offset:24576
    ds_read_b64_tr_b16 v[126:127], v11 offset:28672
    s_waitcnt lgkmcnt(8)
    v_mfma_f32_16x16x32_bf16 v[16:19], a[168:171], v[96:99], v[16:19]
    ds_read_b128 v[32:35], v187 offset:0
    ds_read_b128 v[36:39], v187 offset:16
    v_mfma_f32_16x16x32_bf16 v[20:23], a[168:171], v[100:103], v[20:23]
    ds_read_b128 v[40:43], v187 offset:32
    ds_read_b128 v[44:47], v187 offset:48
    v_mfma_f32_16x16x32_bf16 v[24:27], a[168:171], v[104:107], v[24:27]
    v_mfma_f32_16x16x32_bf16 v[28:31], a[168:171], v[108:111], v[28:31]
    s_waitcnt lgkmcnt(4)
    v_mfma_f32_16x16x32_bf16 v[16:19], a[180:183], v[112:115], v[16:19]
    v_mfma_f32_16x16x32_bf16 v[20:23], a[180:183], v[116:119], v[20:23]
    v_mfma_f32_16x16x32_bf16 v[24:27], a[180:183], v[120:123], v[24:27]
    v_mfma_f32_16x16x32_bf16 v[28:31], a[180:183], v[124:127], v[28:31]
    s_nop 6
    v_permlane32_swap_b32 v16, v24
    v_permlane32_swap_b32 v20, v28
    v_permlane32_swap_b32 v17, v25
    v_permlane32_swap_b32 v21, v29
    v_permlane32_swap_b32 v18, v26
    v_permlane32_swap_b32 v22, v30
    v_permlane32_swap_b32 v19, v27
    v_permlane32_swap_b32 v23, v31
    v_permlane16_swap_b32 v16, v20
    v_permlane16_swap_b32 v24, v28
    v_permlane16_swap_b32 v17, v21
    v_permlane16_swap_b32 v25, v29
    v_permlane16_swap_b32 v18, v22
    v_permlane16_swap_b32 v26, v30
    v_permlane16_swap_b32 v19, v23
    v_permlane16_swap_b32 v27, v31
    s_waitcnt lgkmcnt(0)
    v_pk_fma_f32 v[16:17], v[32:33], v[64:65], v[16:17] op_sel_hi:[1,0,1] neg_lo:[0,1,0] neg_hi:[0,1,0]
    v_pk_fma_f32 v[18:19], v[34:35], v[64:65], v[18:19] op_sel_hi:[1,0,1] neg_lo:[0,1,0] neg_hi:[0,1,0]
    v_pk_fma_f32 v[20:21], v[36:37], v[64:65], v[20:21] op_sel_hi:[1,0,1] neg_lo:[0,1,0] neg_hi:[0,1,0]
    v_pk_fma_f32 v[22:23], v[38:39], v[64:65], v[22:23] op_sel_hi:[1,0,1] neg_lo:[0,1,0] neg_hi:[0,1,0]
    v_pk_fma_f32 v[24:25], v[40:41], v[64:65], v[24:25] op_sel_hi:[1,0,1] neg_lo:[0,1,0] neg_hi:[0,1,0]
    v_pk_fma_f32 v[26:27], v[42:43], v[64:65], v[26:27] op_sel_hi:[1,0,1] neg_lo:[0,1,0] neg_hi:[0,1,0]
    v_pk_fma_f32 v[28:29], v[44:45], v[64:65], v[28:29] op_sel_hi:[1,0,1] neg_lo:[0,1,0] neg_hi:[0,1,0]
    v_pk_fma_f32 v[30:31], v[46:47], v[64:65], v[30:31] op_sel_hi:[1,0,1] neg_lo:[0,1,0] neg_hi:[0,1,0]
    v_max3_f32 v72, v16, v17, v18
    v_min3_f32 v74, v16, v17, v18
    v_max3_f32 v72, v72, v19, v20
    v_min3_f32 v74, v74, v19, v20
    v_max3_f32 v72, v72, v21, v22
    v_min3_f32 v74, v74, v21, v22
    v_max3_f32 v72, v72, v23, v24
    v_min3_f32 v74, v74, v23, v24
    v_max3_f32 v72, v72, v25, v26
    v_min3_f32 v74, v74, v25, v26
    v_max3_f32 v72, v72, v27, v28
    v_min3_f32 v74, v74, v27, v28
    v_max3_f32 v72, v72, v29, v30
    v_min3_f32 v74, v74, v29, v30
    v_max_f32 v72, v72, v31
    v_min_f32 v74, v74, v31
    s_waitcnt vmcnt(0)
    s_barrier
    s_cmp_eq_u32 s24, 1
    s_cbranch_scc0 L_gs1
    v_mov_b32 v188, 2
    v_lshlrev_b32 v189, 11, v1
    s_mov_b64 exec, 0xff
    buffer_store_dword v188, v189, s[4:7], s79 offen sc1
    s_mov_b64 exec, -1
L_gs1:
    v_mul_f32 v72, v72, v76
    v_mul_f32 v74, v74, v76
    v_pk_fma_f32 v[80:81], v[16:17], v[76:77], v[72:73] op_sel_hi:[1,0,0] neg_lo:[0,0,1] neg_hi:[0,0,1]
    v_pk_fma_f32 v[96:97], v[16:17], v[76:77], v[74:75] op_sel_hi:[1,0,0] neg_lo:[1,0,0] neg_hi:[1,0,0]
    v_pk_fma_f32 v[82:83], v[18:19], v[76:77], v[72:73] op_sel_hi:[1,0,0] neg_lo:[0,0,1] neg_hi:[0,0,1]
    v_pk_fma_f32 v[98:99], v[18:19], v[76:77], v[74:75] op_sel_hi:[1,0,0] neg_lo:[1,0,0] neg_hi:[1,0,0]
    v_pk_fma_f32 v[84:85], v[20:21], v[76:77], v[72:73] op_sel_hi:[1,0,0] neg_lo:[0,0,1] neg_hi:[0,0,1]
    v_pk_fma_f32 v[100:101], v[20:21], v[76:77], v[74:75] op_sel_hi:[1,0,0] neg_lo:[1,0,0] neg_hi:[1,0,0]
    v_pk_fma_f32 v[86:87], v[22:23], v[76:77], v[72:73] op_sel_hi:[1,0,0] neg_lo:[0,0,1] neg_hi:[0,0,1]
    v_pk_fma_f32 v[102:103], v[22:23], v[76:77], v[74:75] op_sel_hi:[1,0,0] neg_lo:[1,0,0] neg_hi:[1,0,0]
    v_pk_fma_f32 v[88:89], v[24:25], v[76:77], v[72:73] op_sel_hi:[1,0,0] neg_lo:[0,0,1] neg_hi:[0,0,1]
    v_pk_fma_f32 v[104:105], v[24:25], v[76:77], v[74:75] op_sel_hi:[1,0,0] neg_lo:[1,0,0] neg_hi:[1,0,0]
    v_pk_fma_f32 v[90:91], v[26:27], v[76:77], v[72:73] op_sel_hi:[1,0,0] neg_lo:[0,0,1] neg_hi:[0,0,1]
    v_pk_fma_f32 v[106:107], v[26:27], v[76:77], v[74:75] op_sel_hi:[1,0,0] neg_lo:[1,0,0] neg_hi:[1,0,0]
    v_pk_fma_f32 v[92:93], v[28:29], v[76:77], v[72:73] op_sel_hi:[1,0,0] neg_lo:[0,0,1] neg_hi:[0,0,1]
    v_pk_fma_f32 v[108:109], v[28:29], v[76:77], v[74:75] op_sel_hi:[1,0,0] neg_lo:[1,0,0] neg_hi:[1,0,0]
    v_pk_fma_f32 v[94:95], v[30:31], v[76:77], v[72:73] op_sel_hi:[1,0,0] neg_lo:[0,0,1] neg_hi:[0,0,1]
    v_pk_fma_f32 v[110:111], v[30:31], v[76:77], v[74:75] op_sel_hi:[1,0,0] neg_lo:[1,0,0] neg_hi:[1,0,0]
    v_exp_f32 v80, v80
    v_exp_f32 v81, v81
    v_exp_f32 v82, v82
    v_exp_f32 v83, v83
    v_exp_f32 v84, v84
    v_exp_f32 v85, v85
    v_exp_f32 v86, v86
    v_exp_f32 v87, v87
    v_exp_f32 v88, v88
    v_exp_f32 v89, v89
    v_exp_f32 v90, v90
    v_exp_f32 v91, v91
    v_exp_f32 v92, v92
    v_exp_f32 v93, v93
    v_exp_f32 v94, v94
    v_exp_f32 v95, v95
    v_exp_f32 v96, v96
    v_exp_f32 v97, v97
    v_exp_f32 v98, v98
    v_exp_f32 v99, v99
    v_exp_f32 v100, v100
    v_exp_f32 v101, v101
    v_exp_f32 v102, v102
    v_exp_f32 v103, v103
    v_exp_f32 v104, v104
    v_exp_f32 v105, v105
    v_exp_f32 v106, v106
    v_exp_f32 v107, v107
    v_exp_f32 v108, v108
    v_exp_f32 v109, v109
    v_exp_f32 v110, v110
    v_exp_f32 v111, v111
    v_pk_add_f32 v[72:73], v[80:81], v[82:83]
    v_pk_add_f32 v[74:75], v[96:97], v[98:99]
    v_pk_add_f32 v[72:73], v[72:73], v[84:85]
    v_pk_add_f32 v[74:75], v[74:75], v[100:101]
    v_pk_add_f32 v[72:73], v[72:73], v[86:87]
    v_pk_add_f32 v[74:75], v[74:75], v[102:103]
    v_pk_add_f32 v[72:73], v[72:73], v[88:89]
    v_pk_add_f32 v[74:75], v[74:75], v[104:105]
    v_pk_add_f32 v[72:73], v[72:73], v[90:91]
    v_pk_add_f32 v[74:75], v[74:75], v[106:107]
    v_pk_add_f32 v[72:73], v[72:73], v[92:93]
    v_pk_add_f32 v[74:75], v[74:75], v[108:109]
    v_pk_add_f32 v[72:73], v[72:73], v[94:95]
    v_pk_add_f32 v[74:75], v[74:75], v[110:111]
    v_add_f32 v72, v72, v73
    v_add_f32 v74, v74, v75
    v_rcp_f32 v72, v72
    v_rcp_f32 v74, v74
    v_pk_mul_f32 v[80:81], v[80:81], v[72:73] op_sel_hi:[1,0]
    v_pk_mul_f32 v[96:97], v[96:97], v[74:75] op_sel_hi:[1,0]
    v_pk_mul_f32 v[82:83], v[82:83], v[72:73] op_sel_hi:[1,0]
    v_pk_mul_f32 v[98:99], v[98:99], v[74:75] op_sel_hi:[1,0]
    v_pk_mul_f32 v[84:85], v[84:85], v[72:73] op_sel_hi:[1,0]
    v_pk_mul_f32 v[100:101], v[100:101], v[74:75] op_sel_hi:[1,0]
    v_pk_mul_f32 v[86:87], v[86:87], v[72:73] op_sel_hi:[1,0]
    v_pk_mul_f32 v[102:103], v[102:103], v[74:75] op_sel_hi:[1,0]
    v_pk_mul_f32 v[88:89], v[88:89], v[72:73] op_sel_hi:[1,0]
    v_pk_mul_f32 v[104:105], v[104:105], v[74:75] op_sel_hi:[1,0]
    v_pk_mul_f32 v[90:91], v[90:91], v[72:73] op_sel_hi:[1,0]
    v_pk_mul_f32 v[106:107], v[106:107], v[74:75] op_sel_hi:[1,0]
    v_pk_mul_f32 v[92:93], v[92:93], v[72:73] op_sel_hi:[1,0]
    v_pk_mul_f32 v[108:109], v[108:109], v[74:75] op_sel_hi:[1,0]
    v_pk_mul_f32 v[94:95], v[94:95], v[72:73] op_sel_hi:[1,0]
    v_pk_mul_f32 v[110:111], v[110:111], v[74:75] op_sel_hi:[1,0]
    v_cvt_pk_bf16_f32 v112, v80, v81
    v_cvt_pk_bf16_f32 v113, v82, v83
    v_cvt_pk_bf16_f32 v114, v84, v85
    v_cvt_pk_bf16_f32 v115, v86, v87
    v_cvt_pk_bf16_f32 v116, v88, v89
    v_cvt_pk_bf16_f32 v117, v90, v91
    v_cvt_pk_bf16_f32 v118, v92, v93
    v_cvt_pk_bf16_f32 v119, v94, v95
    v_cvt_pk_bf16_f32 v120, v96, v97
    v_cvt_pk_bf16_f32 v121, v98, v99
    v_cvt_pk_bf16_f32 v122, v100, v101
    v_cvt_pk_bf16_f32 v123, v102, v103
    v_cvt_pk_bf16_f32 v124, v104, v105
    v_cvt_pk_bf16_f32 v125, v106, v107
    v_cvt_pk_bf16_f32 v126, v108, v109
    v_cvt_pk_bf16_f32 v127, v110, v111
    v_permlane32_swap_b32 v112, v116
    v_permlane32_swap_b32 v113, v117
    v_permlane32_swap_b32 v114, v118
    v_permlane32_swap_b32 v115, v119
    v_permlane32_swap_b32 v120, v124
    v_permlane32_swap_b32 v121, v125
    v_permlane32_swap_b32 v122, v126
    v_permlane32_swap_b32 v123, v127
    v_and_b32 v5, 31, v0
    v_min_u32 v5, 16, v5
    v_lshlrev_b32 v5, 6, v5
    v_lshrrev_b32 v6, 5, v1
    v_lshl_add_u32 v5, v6, 5, v5
    s_lshl_b32 s29, s26, 1
    s_add_u32 s29, s29, s20
    s_mul_i32 s30, s29, 2304
    s_add_u32 s30, s30, 21176320
    s_lshl_b32 s29, s29, 10
    s_lshl_b32 s22, s25, 2
    s_add_u32 s22, s22, s24
    s_lshl_b32 s28, s22, 15
    s_add_u32 s28, s28, s29
    s_add_u32 s28, s28, 12713984
    s_xor_b32 s22, s22, 1
    s_lshl_b32 s22, s22, 15
    s_add_u32 s29, s29, s22
    s_add_u32 s29, s29, 12713984
    s_mov_b32 s31, 0x358637bd
    s_cmp_eq_u32 s24, 3
    s_cbranch_scc0 L_wk6_skip
    s_mov_b64 exec, 0
    s_branch L_wk6_ret
L_wk6_ret:
    s_mov_b64 exec, -1
L_wk6_skip:
    s_cmp_eq_u32 s24, 0
    s_cbranch_scc0 L_gw1
    v_lshlrev_b32 v189, 7, v1
    s_mov_b32 s23, 0
    s_mov_b64 exec, 0xffff
L_gwp1:
    buffer_load_dword v2, v189, s[4:7], s80 offen sc1
    s_add_u32 s23, s23, 1
    s_cmp_gt_u32 s23, 400000
    s_cbranch_scc1 L_gwq1
    s_waitcnt vmcnt(0)
    v_cmp_gt_u32 vcc, 2, v2
    s_nop 4
    s_and_b64 exec, exec, vcc
    s_cbranch_execnz L_gwp1
L_gwq1:
    s_waitcnt vmcnt(0)
    s_mov_b64 exec, -1
L_gw1:
    s_waitcnt lgkmcnt(0)
    s_barrier
    buffer_load_dwordx4 v[136:139], v5, s[4:7], s30 offen offset:0 sc1
    buffer_load_dwordx4 v[140:143], v5, s[4:7], s30 offen offset:16 sc1
    buffer_load_dwordx4 v[144:147], v5, s[4:7], s30 offen offset:1152 sc1
    buffer_load_dwordx4 v[148:151], v5, s[4:7], s30 offen offset:1168 sc1
    s_and_b32 s25, s2, 7
    s_lshl_b32 s25, s25, 3
    s_lshr_b32 s26, s2, 5
    s_add_u32 s25, s25, s26
    s_bfe_u32 s26, s2, 0x20003
    s_lshl_b32 s26, s26, 2
    s_add_u32 s26, s26, s24
    v_lshrrev_b32 v9, 2, v1
    v_lshlrev_b32 v9, 8, v9
    v_and_b32 v10, 3, v0
    v_lshl_add_u32 v9, v10, 4, v9
    s_lshr_b32 s44, s25, 2
    s_lshl_b32 s44, s44, 17
    s_and_b32 s45, s25, 3
    s_lshl_b32 s45, s45, 6
    s_add_u32 s44, s44, s45
    s_lshl_b32 s45, s26, 13
    s_add_u32 s44, s44, s45
    s_add_u32 s44, s44, 8519680
    s_add_u32 s45, s44, 3072
    s_lshl_b32 s34, s24, 11
    s_add_u32 s34, s34, 66560
    s_mov_b32 m0, s34
    s_nop 0
    buffer_load_dwordx4 v9, s[4:7], s44 offen sc1 lds
    buffer_load_dwordx4 v9, s[4:7], s45 offen offset:1024 sc1 lds
    s_lshl_b32 s47, s24, 12
    s_lshl_b32 s46, s25, 15
    s_add_u32 s46, s46, s47
    s_add_u32 s46, s46, 12713984
    s_add_u32 s43, s46, 16384
    s_add_u32 s47, s47, 33792
    v_and_b32 v184, 31, v0
    v_add_u32 v185, 33792, v7
    v_lshrrev_b32 v186, 5, v1
    v_bfe_u32 v8, v0, 2, 2
    v_lshlrev_b32 v8, 6, v8
    v_lshl_add_u32 v8, v186, 8, v8
    v_and_b32 v9, 1, v4
    v_lshl_add_u32 v8, v9, 5, v8
    v_and_b32 v9, 3, v0
    v_lshl_add_u32 v8, v9, 3, v8
    v_add_u32 v8, s34, v8
    s_waitcnt vmcnt(4)
    v_cvt_pk_bf16_f32 v136, v136, v137
    v_cvt_pk_bf16_f32 v137, v138, v139
    v_cvt_pk_bf16_f32 v138, v140, v141
    v_cvt_pk_bf16_f32 v139, v142, v143
    s_nop 1
    v_mfma_f32_32x32x16_bf16 v[16:31], v[136:139], v[112:115], 0
    v_mfma_f32_32x32x16_bf16 v[32:47], v[136:139], v[116:119], 0
    s_waitcnt vmcnt(2)
    v_cvt_pk_bf16_f32 v144, v144, v145
    v_cvt_pk_bf16_f32 v145, v146, v147
    v_cvt_pk_bf16_f32 v146, v148, v149
    v_cvt_pk_bf16_f32 v147, v150, v151
    s_nop 1
    v_mfma_f32_32x32x16_bf16 v[16:31], v[144:147], v[120:123], v[16:31]
    v_mfma_f32_32x32x16_bf16 v[32:47], v[144:147], v[124:127], v[32:47]
    s_nop 10
    v_add_f32 v24, s31, v24
    v_rcp_f32 v24, v24
    s_nop 0
    v_pk_mul_f32 v[16:17], v[16:17], v[24:25] op_sel_hi:[1,0]
    v_pk_mul_f32 v[18:19], v[18:19], v[24:25] op_sel_hi:[1,0]
    v_pk_mul_f32 v[20:21], v[20:21], v[24:25] op_sel_hi:[1,0]
    v_pk_mul_f32 v[22:23], v[22:23], v[24:25] op_sel_hi:[1,0]
    v_cvt_pk_bf16_f32 v28, v16, v17
    v_cvt_pk_bf16_f32 v29, v18, v19
    v_cvt_pk_bf16_f32 v30, v20, v21
    v_cvt_pk_bf16_f32 v31, v22, v23
    s_cmp_eq_u32 s3, 1
    s_cbranch_scc1 L_q1p0
    buffer_store_dwordx4 v[28:31], v7, s[4:7], s28 offen sc1
    s_branch L_q1q0
L_q1p0:
    buffer_store_dwordx4 v[28:31], v7, s[4:7], s28 offen
L_q1q0:
    v_add_f32 v40, s31, v40
    v_rcp_f32 v40, v40
    s_nop 0
    v_pk_mul_f32 v[32:33], v[32:33], v[40:41] op_sel_hi:[1,0]
    v_pk_mul_f32 v[34:35], v[34:35], v[40:41] op_sel_hi:[1,0]
    v_pk_mul_f32 v[36:37], v[36:37], v[40:41] op_sel_hi:[1,0]
    v_pk_mul_f32 v[38:39], v[38:39], v[40:41] op_sel_hi:[1,0]
    v_cvt_pk_bf16_f32 v44, v32, v33
    v_cvt_pk_bf16_f32 v45, v34, v35
    v_cvt_pk_bf16_f32 v46, v36, v37
    v_cvt_pk_bf16_f32 v47, v38, v39
    s_cmp_eq_u32 s3, 1
    s_cbranch_scc1 L_q1p1
    buffer_store_dwordx4 v[44:47], v7, s[4:7], s29 offen sc1
    s_branch L_q1q1
L_q1p1:
    buffer_store_dwordx4 v[44:47], v7, s[4:7], s29 offen
L_q1q1:
    s_waitcnt vmcnt(0) lgkmcnt(0)
    s_barrier
    s_cmp_eq_u32 s24, 1
    s_cbranch_scc0 L_bs7
    v_mov_b32 v188, 255
    v_mov_b32 v189, 0
    s_mov_b64 exec, 1
    buffer_store_byte v188, v189, s[4:7], s38 offen
    s_mov_b64 exec, -1
L_bs7:
    s_cmp_eq_u32 s33, 1
    s_cbranch_scc0 L_bl7
    v_lshlrev_b32 v188, 7, v191
    v_lshlrev_b32 v189, 2, v1
    s_mov_b32 s23, 0
L_blp7:
    buffer_load_dword v2, v189, s[4:7], s39 offen sc1
    s_add_u32 s23, s23, 1
    s_cmp_gt_u32 s23, 400000
    s_cbranch_scc1 L_blq7
    s_waitcnt vmcnt(0)
    v_and_b32 v2, v2, v188
    v_cmp_ne_u32 vcc, v2, v188
    s_nop 4
    s_cbranch_vccnz L_blp7
L_blq7:
    s_waitcnt vmcnt(0)
    v_mov_b32 v188, 8
    v_mul_u32_u24 v189, 2048, v1
    s_mov_b64 exec, s[36:37]
    buffer_store_dword v188, v189, s[4:7], s40 offen sc1
    s_mov_b64 exec, -1
L_bl7:
    s_cmp_eq_u32 s3, 1
    s_cbranch_scc0 L_bg7
    s_cmp_eq_u32 s24, 0
    s_cbranch_scc0 L_bwx7
    s_cmp_eq_u32 s33, 1
    s_cbranch_scc1 L_bwx7
    s_and_b32 s23, s2, 3
    s_lshl_b32 s23, s23, 3
    s_lshl_b32 s23, 1, s23
    v_mov_b32 v188, s23
    s_bfe_u32 s23, s2, 0x10002
    v_and_b32 v189, 1, v1
    v_cmp_eq_u32 vcc, s23, v189
    s_nop 1
    v_cndmask_b32 v188, 0, v188, vcc
    s_lshr_b32 s23, s2, 7
    v_bfe_u32 v189, v1, 1, 1
    v_cmp_eq_u32 vcc, s23, v189
    s_nop 1
    v_cndmask_b32 v188, 0, v188, vcc
    v_lshlrev_b32 v188, 7, v188
    v_lshlrev_b32 v189, 2, v1
    s_mov_b32 s23, 0
L_bcp7:
    buffer_load_dword v2, v189, s[4:7], s39 offen sc1
    s_add_u32 s23, s23, 1
    s_cmp_gt_u32 s23, 400000
    s_cbranch_scc1 L_bcq7
    s_waitcnt vmcnt(0)
    v_and_b32 v2, v2, v188
    v_cmp_ne_u32 vcc, v2, v188
    s_nop 4
    s_cbranch_vccnz L_bcp7
L_bcq7:
    s_waitcnt vmcnt(0)
    s_branch L_bwx7
L_bg7:
    s_cmp_eq_u32 s24, 0
    s_cbranch_scc0 L_bwx7
    v_mul_u32_u24 v189, 256, v1
    s_mov_b32 s23, 0
    s_mov_b64 exec, s[36:37]
L_bwpx7:
    buffer_load_dword v2, v189, s[4:7], s41 offen sc1
    s_add_u32 s23, s23, 1
    s_cmp_gt_u32 s23, 400000
    s_cbranch_scc1 L_bwqx7
    s_waitcnt vmcnt(0)
    v_cmp_gt_u32 vcc, 8, v2
    s_nop 4
    s_and_b64 exec, exec, vcc
    s_cbranch_execnz L_bwpx7
L_bwqx7:
    s_waitcnt vmcnt(0)
    s_mov_b64 exec, -1
L_bwx7:
    s_waitcnt lgkmcnt(0)
    s_barrier
    s_add_u32 m0, s47, 0
    s_nop 0
    buffer_load_dwordx4 v7, s[4:7], s46 offen offset:0 sc1 lds
    buffer_load_dwordx4 v7, s[4:7], s46 offen offset:1024 sc1 lds
    buffer_load_dwordx4 v7, s[4:7], s46 offen offset:2048 sc1 lds
    buffer_load_dwordx4 v7, s[4:7], s46 offen offset:3072 sc1 lds
    s_add_u32 m0, s47, 16384
    s_nop 0
    buffer_load_dwordx4 v7, s[4:7], s43 offen offset:0 sc1 lds
    buffer_load_dwordx4 v7, s[4:7], s43 offen offset:1024 sc1 lds
    buffer_load_dwordx4 v7, s[4:7], s43 offen offset:2048 sc1 lds
    buffer_load_dwordx4 v7, s[4:7], s43 offen offset:3072 sc1 lds
    ds_read_b64_tr_b16 v[48:49], v8 offset:0
    ds_read_b64_tr_b16 v[50:51], v8 offset:512
    ds_read_b64_tr_b16 v[52:53], v8 offset:1024
    ds_read_b64_tr_b16 v[54:55], v8 offset:1536
    s_waitcnt lgkmcnt(0)
    v_lshlrev_b32 v32, 16, v48
    v_and_b32 v33, 0xffff0000, v48
    v_lshlrev_b32 v34, 16, v49
    v_and_b32 v35, 0xffff0000, v49
    v_lshlrev_b32 v36, 16, v50
    v_and_b32 v37, 0xffff0000, v50
    v_lshlrev_b32 v38, 16, v51
    v_and_b32 v39, 0xffff0000, v51
    v_lshlrev_b32 v40, 16, v52
    v_and_b32 v41, 0xffff0000, v52
    v_lshlrev_b32 v42, 16, v53
    v_and_b32 v43, 0xffff0000, v53
    v_lshlrev_b32 v44, 16, v54
    v_and_b32 v45, 0xffff0000, v54
    v_lshlrev_b32 v46, 16, v55
    v_and_b32 v47, 0xffff0000, v55
    s_waitcnt vmcnt(4)
    s_barrier
    ds_read_b128 v[56:59], v185 offset:0
    ds_read_b128 v[60:63], v185 offset:1024
    ds_read_b128 v[64:67], v185 offset:2048
    ds_read_b128 v[68:71], v185 offset:3072
    ds_read_b128 v[72:75], v185 offset:4096
    ds_read_b128 v[76:79], v185 offset:5120
    ds_read_b128 v[80:83], v185 offset:6144
    ds_read_b128 v[84:87], v185 offset:7168
    s_waitcnt lgkmcnt(7)
    v_mfma_f32_32x32x16_bf16 v[16:31], a[192:195], v[56:59], v[32:47]
    ds_read_b128 v[88:91], v185 offset:8192
    s_waitcnt lgkmcnt(7)
    v_mfma_f32_32x32x16_bf16 v[16:31], a[196:199], v[60:63], v[16:31]
    ds_read_b128 v[92:95], v185 offset:9216
    s_waitcnt lgkmcnt(7)
    v_mfma_f32_32x32x16_bf16 v[16:31], a[200:203], v[64:67], v[16:31]
    ds_read_b128 v[96:99], v185 offset:10240
    s_waitcnt lgkmcnt(7)
    v_mfma_f32_32x32x16_bf16 v[16:31], a[204:207], v[68:71], v[16:31]
    ds_read_b128 v[100:103], v185 offset:11264
    s_waitcnt lgkmcnt(7)
    v_mfma_f32_32x32x16_bf16 v[16:31], a[208:211], v[72:75], v[16:31]
    ds_read_b128 v[104:107], v185 offset:12288
    s_waitcnt lgkmcnt(7)
    v_mfma_f32_32x32x16_bf16 v[16:31], a[212:215], v[76:79], v[16:31]
    ds_read_b128 v[108:111], v185 offset:13312
    s_waitcnt lgkmcnt(7)
    v_mfma_f32_32x32x16_bf16 v[16:31], a[216:219], v[80:83], v[16:31]
    ds_read_b128 v[112:115], v185 offset:14336
    s_waitcnt lgkmcnt(7)
    v_mfma_f32_32x32x16_bf16 v[16:31], a[220:223], v[84:87], v[16:31]
    ds_read_b128 v[116:119], v185 offset:15360
    s_waitcnt lgkmcnt(7)
    v_mfma_f32_32x32x16_bf16 v[16:31], a[224:227], v[88:91], v[16:31]
    s_waitcnt vmcnt(0)
    s_barrier
    ds_read_b128 v[120:123], v185 offset:16384
    s_waitcnt lgkmcnt(7)
    v_mfma_f32_32x32x16_bf16 v[16:31], a[228:231], v[92:95], v[16:31]
    ds_read_b128 v[124:127], v185 offset:17408
    s_waitcnt lgkmcnt(7)
    v_mfma_f32_32x32x16_bf16 v[16:31], a[232:235], v[96:99], v[16:31]
    ds_read_b128 v[128:131], v185 offset:18432
    s_waitcnt lgkmcnt(7)
    v_mfma_f32_32x32x16_bf16 v[16:31], a[236:239], v[100:103], v[16:31]
    ds_read_b128 v[132:135], v185 offset:19456
    s_waitcnt lgkmcnt(7)
    v_mfma_f32_32x32x16_bf16 v[16:31], a[240:243], v[104:107], v[16:31]
    ds_read_b128 v[136:139], v185 offset:20480
    s_waitcnt lgkmcnt(7)
    v_mfma_f32_32x32x16_bf16 v[16:31], a[244:247], v[108:111], v[16:31]
    ds_read_b128 v[140:143], v185 offset:21504
    s_waitcnt lgkmcnt(7)
    v_mfma_f32_32x32x16_bf16 v[16:31], a[248:251], v[112:115], v[16:31]
    ds_read_b128 v[144:147], v185 offset:22528
    s_waitcnt lgkmcnt(7)
    v_mfma_f32_32x32x16_bf16 v[16:31], a[252:255], v[116:119], v[16:31]
    ds_read_b128 v[148:151], v185 offset:23552
    s_waitcnt lgkmcnt(7)
    v_mfma_f32_32x32x16_bf16 v[16:31], v[192:195], v[120:123], v[16:31]
    ds_read_b128 v[152:155], v185 offset:24576
    s_waitcnt lgkmcnt(7)
    v_mfma_f32_32x32x16_bf16 v[16:31], v[196:199], v[124:127], v[16:31]
    ds_read_b128 v[156:159], v185 offset:25600
    s_waitcnt lgkmcnt(7)
    v_mfma_f32_32x32x16_bf16 v[16:31], v[200:203], v[128:131], v[16:31]
    ds_read_b128 v[160:163], v185 offset:26624
    s_waitcnt lgkmcnt(7)
    v_mfma_f32_32x32x16_bf16 v[16:31], v[204:207], v[132:135], v[16:31]
    ds_read_b128 v[164:167], v185 offset:27648
    s_waitcnt lgkmcnt(7)
    v_mfma_f32_32x32x16_bf16 v[16:31], v[208:211], v[136:139], v[16:31]
    ds_read_b128 v[168:171], v185 offset:28672
    s_waitcnt lgkmcnt(7)
    v_mfma_f32_32x32x16_bf16 v[16:31], v[212:215], v[140:143], v[16:31]
    ds_read_b128 v[172:175], v185 offset:29696
    s_waitcnt lgkmcnt(7)
    v_mfma_f32_32x32x16_bf16 v[16:31], v[216:219], v[144:147], v[16:31]
    ds_read_b128 v[176:179], v185 offset:30720
    s_waitcnt lgkmcnt(7)
    v_mfma_f32_32x32x16_bf16 v[16:31], v[220:223], v[148:151], v[16:31]
    ds_read_b128 v[180:183], v185 offset:31744
    s_waitcnt lgkmcnt(7)
    v_mfma_f32_32x32x16_bf16 v[16:31], v[224:227], v[152:155], v[16:31]
    s_waitcnt lgkmcnt(6)
    v_mfma_f32_32x32x16_bf16 v[16:31], v[228:231], v[156:159], v[16:31]
    s_waitcnt lgkmcnt(5)
    v_mfma_f32_32x32x16_bf16 v[16:31], v[232:235], v[160:163], v[16:31]
    s_waitcnt lgkmcnt(4)
    v_mfma_f32_32x32x16_bf16 v[16:31], v[236:239], v[164:167], v[16:31]
    s_waitcnt lgkmcnt(3)
    v_mfma_f32_32x32x16_bf16 v[16:31], v[240:243], v[168:171], v[16:31]
    s_waitcnt lgkmcnt(2)
    v_mfma_f32_32x32x16_bf16 v[16:31], v[244:247], v[172:175], v[16:31]
    s_waitcnt lgkmcnt(1)
    v_mfma_f32_32x32x16_bf16 v[16:31], v[248:251], v[176:179], v[16:31]
    s_waitcnt lgkmcnt(0)
    v_mfma_f32_32x32x16_bf16 v[16:31], v[252:255], v[180:183], v[16:31]
    s_nop 11
    v_cvt_pk_bf16_f32 v56, v16, v17
    v_cvt_pk_bf16_f32 v57, v18, v19
    v_cvt_pk_bf16_f32 v58, v20, v21
    v_cvt_pk_bf16_f32 v59, v22, v23
    v_cvt_pk_bf16_f32 v60, v24, v25
    v_cvt_pk_bf16_f32 v61, v26, v27
    v_cvt_pk_bf16_f32 v62, v28, v29
    v_cvt_pk_bf16_f32 v63, v30, v31
    s_mul_i32 s27, s24, 2560
    s_add_u32 s27, s27, 74752
    v_mul_u32_u24 v8, 80, v184
    v_lshl_add_u32 v8, v186, 3, v8
    v_add_u32 v8, s27, v8
    ds_write_b64 v8, v[56:57] offset:0
    ds_write_b64 v8, v[58:59] offset:16
    ds_write_b64 v8, v[60:61] offset:32
    ds_write_b64 v8, v[62:63] offset:48
    v_lshrrev_b32 v5, 2, v1
    v_mul_u32_u24 v8, 80, v5
    v_lshl_add_u32 v8, v9, 4, v8
    v_add_u32 v8, s27, v8
    v_lshlrev_b32 v5, 10, v5
    v_lshl_add_u32 v5, v9, 4, v5
    s_lshl_b32 s27, s25, 15
    s_lshl_b32 s28, s26, 6
    s_add_u32 s27, s27, s28
    s_add_u32 s28, s27, 16384
    s_waitcnt lgkmcnt(0)
    ds_read_b128 v[48:51], v8 offset:0
    ds_read_b128 v[52:55], v8 offset:1280
    s_waitcnt lgkmcnt(1)
    buffer_store_dwordx4 v[48:51], v5, s[8:11], s27 offen
    s_waitcnt lgkmcnt(0)
    buffer_store_dwordx4 v[52:55], v5, s[8:11], s28 offen
L_end:
    s_endpgm
.section .rodata,"a"
.p2align 6
.amdhsa_kernel interleave_layers__ssm_conv_s4d__linear_kernel_hedgehog__prompt_kernel
  .amdhsa_next_free_vgpr 512
  .amdhsa_next_free_sgpr 102
  .amdhsa_accum_offset 256
  .amdhsa_group_segment_fixed_size 0
  .amdhsa_kernarg_size 112
  .amdhsa_user_sgpr_count 2
  .amdhsa_user_sgpr_kernarg_segment_ptr 1
  .amdhsa_system_sgpr_workgroup_id_x 1
.end_amdhsa_kernel
.text
```
